```python
import torch

def _softmax(x, axis=-1):
    return torch.softmax(x, dim=axis)
def _gelu(x):
    return torch.nn.functional.gelu(x, approximate="tanh")
def _silu(x):
    return torch.nn.functional.silu(x)
def _sigmoid(x):
    return torch.sigmoid(x)
def _layernorm(x, axis=-1, eps=1e-5):
    m = x.mean(dim=axis, keepdim=True)
    v = x.var(dim=axis, keepdim=True, unbiased=False)
    return (x - m) / torch.sqrt(v + eps)
def _scatter_add(tgt, idx, src, axis=0):
    return tgt.clone().index_add_(axis, idx, src)
def _segment_sum(src, seg, n):
    out = torch.zeros((n,) + src.shape[1:], dtype=src.dtype)
    return out.index_add_(0, seg, src)
def _pad(x, pw):
    flat = tuple(v for pair in reversed(pw) for v in pair)
    return torch.nn.functional.pad(x, flat)

kernel_name = 'recurrent_scan__sliding_local_dilated__swiglu_ffn__prompt'

def setup_inputs():

    _w = (lambda a: (lambda t: t.to(torch.bfloat16) if t.is_floating_point() else t)(torch.as_tensor(a)))
    def _A_setup():
        B, S, D = 1, 2048, 640
        return {
            "x": _w((lambda *s: torch.randn(*s, dtype=torch.bfloat16) * 0.05)(B, S, D)),
            "wqkv": _w((lambda *s: torch.randn(*s, dtype=torch.bfloat16) * 0.05)(D, 3 * D)),
            "wo": _w((lambda *s: torch.randn(*s, dtype=torch.bfloat16) * 0.05)(D, D)),
        }
    _A_in = _A_setup()

    def _B_setup():
        B, S, D, F = 1, 2048, 640, 1536
        return {
            "x": _w((lambda *s: torch.randn(*s, dtype=torch.bfloat16) * 0.05)(B, S, D)),
            "w_gate": _w((lambda *s: torch.randn(*s, dtype=torch.bfloat16) * 0.05)(D, F)),
            "w_up": _w((lambda *s: torch.randn(*s, dtype=torch.bfloat16) * 0.05)(D, F)),
            "w_down": _w((lambda *s: torch.randn(*s, dtype=torch.bfloat16) * 0.05)(F, D)),
        }
    _B_in = _B_setup()

    return {
        "A_x": _A_in["x"],
        "A_wqkv": _A_in["wqkv"],
        "A_wo": _A_in["wo"],
        "B_x": _B_in["x"],
        "B_w_gate": _B_in["w_gate"],
        "B_w_up": _B_in["w_up"],
        "B_w_down": _B_in["w_down"],
    }

def reference(A_x, A_wqkv, A_wo, B_x, B_w_gate, B_w_up, B_w_down):
    def _A_ref(x, wqkv, wo):
        B, S, D = x.shape
        H = 32; Dh = D // H
        W, dil = 8, 2
        qkv = (lambda x, *d: x.permute(*d))((x @ wqkv).reshape(B, S, 3, H, Dh), 2, 0, 3, 1, 4)
        q, k, v = qkv[0], qkv[1], qkv[2]
        scale = Dh ** -0.5
        pos = torch.arange(S)
        off = torch.arange(W) * dil
        idx = pos[:, None] - off[None, :]
        mask = idx >= 0
        idx_c = torch.where(mask, idx, 0).reshape(-1)
        kg = k[:, :, idx_c, :].reshape(B, H, S, W, Dh)
        vg = v[:, :, idx_c, :].reshape(B, H, S, W, Dh)
        logits = torch.einsum("bhsd,bhswd->bhsw", q, kg) * scale
        logits = torch.where(mask[None, None, :, :], logits, -1e9)
        attn = _softmax(logits, axis=-1)
        o = torch.einsum("bhsw,bhswd->bhsd", attn, vg)
        return (lambda x, *d: x.permute(*d))(o, 0, 2, 1, 3).reshape(B, S, D) @ wo

    def _B_ref(x, w_gate, w_up, w_down):
        g = _silu(x @ w_gate)
        u = x @ w_up
        return (g * u) @ w_down

    x = A_x
    xn = _layernorm(x, axis=-1)
    s = _A_ref(xn, A_wqkv, A_wo)
    g = _silu(_B_ref(xn, B_w_gate, B_w_up, B_w_down))
    return x + s * g
```

```asm
; @launch grid=(256,1,1) block=(256,1,1) lds=163840
.amdgcn_target "amdgcn-amd-amdhsa--gfx950"
.text
.globl recurrent_scan__sliding_local_dilated__swiglu_ffn__prompt_kernel
.p2align 12
.fill 832, 4, 0xbf810000
.p2align 8
.type recurrent_scan__sliding_local_dilated__swiglu_ffn__prompt_kernel,@function
recurrent_scan__sliding_local_dilated__swiglu_ffn__prompt_kernel:
    s_cmp_ge_u32 s2, 256
    s_cbranch_scc1 K_END
    s_load_dwordx16 s[4:19], s[0:1], 0
    s_load_dwordx4 s[20:23], s[0:1], 64
    v_lshrrev_b32 v2, 6, v0
    v_and_b32 v1, 63, v0
    v_readfirstlane_b32 s56, v2
    s_lshr_b32 s71, s2, 3
    s_getpc_b64 s[24:25]
K_PC:
    v_lshrrev_b32 v2, 4, v0
    v_lshl_add_u32 v2, s71, 4, v2
    v_lshlrev_b32 v2, 7, v2
    v_min_u32 v2, K_LAST-4-K_PC, v2
    global_load_dword v255, v2, s[24:25]
    s_add_u32 s71, s71, 31
    s_and_b32 s71, s71, 31
    s_and_b32 s73, s2, 1
    s_bfe_u32 s58, s2, 0x20001
    s_cmp_lt_u32 s71, 12
    s_cbranch_scc0 K_NOTQ
    s_mul_i32 s57, s73, 6
    s_lshr_b32 s74, s71, 1
    s_add_u32 s57, s57, s74
    s_and_b32 s74, s71, 1
    s_lshl1_add_u32 s58, s58, s74
    s_mul_i32 s80, s57, 176
    s_sub_u32 s80, s80, 16
    s_mul_i32 s62, s56, 48
    s_mov_b32 s79, 8
    s_branch K_X
K_NOTQ:
    s_sub_u32 s71, s71, 12
    s_mul_i32 s74, s71, 86
    s_lshr_b32 s74, s74, 8
    s_mul_i32 s75, s74, 3
    s_sub_u32 s75, s71, s75
    s_mul_i32 s57, s73, 7
    s_add_u32 s57, s57, s74
    s_cmp_eq_u32 s57, 13
    s_cselect_b32 s57, 6, s57
    s_cselect_b32 s74, 2, 0
    s_add_u32 s75, s75, s74
    s_cmp_eq_u32 s75, 3
    s_cbranch_scc1 I_PRO
    s_mul_i32 s58, s58, 3
    s_add_u32 s58, s58, s75
    s_mul_i32 s78, s57, 158
    s_sub_u32 s79, 0, s78
    s_and_b32 s79, s79, 7
    s_add_u32 s80, s78, s79
    s_mul_i32 s62, s56, 40
K_X:
    v_lshrrev_b32 v20, 3, v1
    s_add_u32 s75, s62, s80
    v_add_u32 v21, s75, v20
    v_bfe_u32 v23, v21, 2, 1
    v_and_or_b32 v23, v21, -8, v23
    v_and_b32 v22, 3, v21
    v_lshl_add_u32 v22, v22, 1, v23
    v_mul_i32_i24 v22, 1280, v22
    v_lshrrev_b32 v26, 4, v1
    v_and_b32 v27, 7, v1
    v_xor_b32 v27, v26, v27
    s_lshr_b32 s72, s62, 1
    s_and_b32 s72, s72, 4
    v_xor_b32 v27, s72, v27
    v_xor_b32 v28, 4, v27
    v_lshl_add_u32 v10, v27, 4, v22
    v_lshl_add_u32 v28, v28, 4, v22
    v_add_u32 v11, 9216, v28
    v_add_u32 v12, 20480, v10
    v_add_u32 v13, 29696, v28
    s_add_u32 s72, s58, s57
    s_mul_i32 s71, s72, 86
    s_lshr_b32 s71, s71, 8
    s_mul_i32 s71, s71, 3
    s_sub_u32 s72, s72, s71
    s_lshr_b32 s71, s2, 1
    s_xor_b32 s71, s71, s2
    s_bitcmp1_b32 s71, 0
    s_cselect_b32 s71, 3, 0
    s_add_u32 s59, s71, s72
    s_lshl_b32 s71, s59, 2
    s_lshr_b32 s77, 0x1001, s71
    s_and_b32 s76, s57, 1
    s_lshl_b32 s81, s76, 6
    s_add_u32 s71, s75, 32
    s_cmp_eq_u32 s62, 120
    s_cselect_b32 s71, s78, s71
    s_cselect_b32 s72, 152, 0
    s_lshl_b32 s62, s62, 7
    s_lshr_b32 s73, s79, 3
    s_lshl_b32 s73, s73, 14
    s_sub_u32 s73, s62, s73
    s_add_u32 m0, s73, 98304
    s_bfe_u32 s64, s77, 0x40000
    s_lshl_b32 s64, s64, 7
    s_waitcnt lgkmcnt(0)
    s_mov_b64 s[24:25], s[4:5]
    s_mov_b32 s26, 2621440
    s_mov_b32 s27, 0x20000
    buffer_load_dwordx4 v10, s[24:27], s64 offen offset:0 lds
    buffer_load_dwordx4 v11, s[24:27], s64 offen offset:1024 lds
    s_add_u32 m0, s73, 100352
    s_lshl_b32 s63, s56, 12
    buffer_load_dwordx4 v12, s[24:27], s64 offen offset:0 lds
    buffer_load_dwordx4 v13, s[24:27], s64 offen offset:1024 lds
    v_mov_b32 v24, s72
    v_cmp_le_u32 vcc, s79, v20
    v_add_u32 v27, -128, v27
    v_add_u32 v20, s71, v20
    v_cndmask_b32 v24, 0, v24, vcc
    v_add_u32 v24, v24, v20
    v_bfe_u32 v23, v24, 2, 1
    v_and_or_b32 v23, v24, -8, v23
    v_and_b32 v25, 3, v24
    v_lshl_add_u32 v25, v25, 1, v23
    v_mul_u32_u24 v25, 1280, v25
    v_lshl_add_u32 v14, v27, 4, v25
    s_cmp_eq_u32 s79, 8
    buffer_load_dwordx4 v14, s[24:27], s64 offen offset:2048 lds
    s_cbranch_scc1 Q_PRO
F_PRO:
    s_and_b32 s71, s56, 1
    s_lshl_b32 s71, s71, 4
    s_lshr_b32 s72, s56, 1
    s_lshl_b32 s72, s72, 2
    s_add_u32 s71, s71, s72
    v_add_u32 v20, s71, v26
    v_mul_u32_u24 v20, 3072, v20
    s_lshl_b32 s71, s58, 8
    v_add_u32 v20, s71, v20
    v_and_b32 v21, 15, v1
    v_lshlrev_b32 v22, 1, v26
    v_xor_b32 v21, v21, v22
    v_lshl_add_u32 v17, v21, 4, v20
    v_xor_b32 v21, 8, v21
    v_lshl_add_u32 v21, v21, 4, v20
    v_add_u32 v18, 23552, v21
    s_mov_b64 s[28:29], s[12:13]
    s_mov_b32 s30, 1966080
    s_mov_b32 s31, 0x20000
    s_sub_u32 s32, s14, 2048
    s_subb_u32 s33, s15, 0
    s_mov_b32 s34, 1968128
    s_mov_b32 s35, 0x20000
    s_mul_i32 s101, s76, -196608
    s_add_u32 s101, s101, 98304
    s_bfe_u32 s65, s77, 0x40000
    s_lshl1_add_u32 s65, s65, s76
    s_mul_i32 s65, s65, 98304
    s_add_u32 m0, s63, 0
    s_nop 0
    buffer_load_dwordx4 v17, s[28:31], s65 offen offset:0 lds
    buffer_load_dwordx4 v18, s[28:31], s65 offen offset:1024 lds
    buffer_load_dwordx4 v17, s[32:35], s65 offen offset:2048 lds
    buffer_load_dwordx4 v18, s[32:35], s65 offen offset:3072 lds
    s_branch F_BODY
Q_PRO:
    v_add_u32 v15, 18432, v13
    s_mov_b32 s78, s75
    buffer_load_dwordx4 v15, s[24:27], s64 offen offset:3072 lds
    s_lshl_b32 s71, s56, 8
    s_mul_i32 s72, s58, 160
    s_movk_i32 s73, 1120
    v_add3_u32 v20, v1, s71, 0
    v_mul_u32_u24 v21, 2185, v20
    v_lshrrev_b32 v21, 16, v21
    v_mad_i32_i24 v22, v21, -15, v20
    v_mad_i32_i24 v22, v21, -15, v22
    v_bfe_u32 v23, v21, 2, 2
    v_and_b32 v24, 3, v21
    v_lshl_add_u32 v23, v23, 3, v24
    v_bfe_u32 v24, v21, 4, 1
    v_lshl_add_u32 v23, v24, 2, v23
    v_mul_u32_u24 v23, 3840, v23
    v_mul_u32_u24 v24, 26, v22
    v_lshrrev_b32 v24, 8, v24
    v_mad_u32_u24 v23, v24, s73, v23
    v_lshl_add_u32 v23, v22, 4, v23
    v_add_u32 v16, s72, v23
    s_sub_u32 s72, s72, 1024
    v_add_u32 v20, 64, v20
    v_mul_u32_u24 v21, 2185, v20
    v_lshrrev_b32 v21, 16, v21
    v_mad_i32_i24 v22, v21, -15, v20
    v_mad_i32_i24 v22, v21, -15, v22
    v_bfe_u32 v23, v21, 2, 2
    v_and_b32 v24, 3, v21
    v_lshl_add_u32 v23, v23, 3, v24
    v_bfe_u32 v24, v21, 4, 1
    v_lshl_add_u32 v23, v24, 2, v23
    v_mul_u32_u24 v23, 3840, v23
    v_mul_u32_u24 v24, 26, v22
    v_lshrrev_b32 v24, 8, v24
    v_mad_u32_u24 v23, v24, s73, v23
    v_lshl_add_u32 v23, v22, 4, v23
    v_add_u32 v17, s72, v23
    s_sub_u32 s72, s72, 1024
    v_add_u32 v20, 64, v20
    v_mul_u32_u24 v21, 2185, v20
    v_lshrrev_b32 v21, 16, v21
    v_mad_i32_i24 v22, v21, -15, v20
    v_mad_i32_i24 v22, v21, -15, v22
    v_bfe_u32 v23, v21, 2, 2
    v_and_b32 v24, 3, v21
    v_lshl_add_u32 v23, v23, 3, v24
    v_bfe_u32 v24, v21, 4, 1
    v_lshl_add_u32 v23, v24, 2, v23
    v_mul_u32_u24 v23, 3840, v23
    v_mul_u32_u24 v24, 26, v22
    v_lshrrev_b32 v24, 8, v24
    v_mad_u32_u24 v23, v24, s73, v23
    v_lshl_add_u32 v23, v22, 4, v23
    v_add_u32 v18, s72, v23
    s_sub_u32 s72, s72, 1024
    v_add_u32 v20, 64, v20
    v_mul_u32_u24 v21, 2185, v20
    v_lshrrev_b32 v21, 16, v21
    v_mad_i32_i24 v22, v21, -15, v20
    v_mad_i32_i24 v22, v21, -15, v22
    v_bfe_u32 v23, v21, 2, 2
    v_and_b32 v24, 3, v21
    v_lshl_add_u32 v23, v23, 3, v24
    v_bfe_u32 v24, v21, 4, 1
    v_lshl_add_u32 v23, v24, 2, v23
    v_mul_u32_u24 v23, 3840, v23
    v_mul_u32_u24 v24, 26, v22
    v_lshrrev_b32 v24, 8, v24
    v_mad_u32_u24 v23, v24, s73, v23
    v_lshl_add_u32 v23, v22, 4, v23
    v_lshrrev_b32 v24, 5, v21
    v_lshl_add_u32 v23, v24, 30, v23
    v_add_u32 v19, s72, v23
    s_mov_b64 s[28:29], s[6:7]
    s_mov_b32 s30, 2457600
    s_mov_b32 s31, 0x20000
    s_mul_i32 s101, s76, -245760
    s_add_u32 s101, s101, 122880
    s_bfe_u32 s65, s77, 0x40000
    s_lshl1_add_u32 s65, s65, s76
    s_mul_i32 s65, s65, 122880
    s_add_u32 m0, s63, 0
    s_nop 0
    buffer_load_dwordx4 v16, s[28:31], s65 offen offset:0 lds
    buffer_load_dwordx4 v17, s[28:31], s65 offen offset:1024 lds
    buffer_load_dwordx4 v18, s[28:31], s65 offen offset:2048 lds
    buffer_load_dwordx4 v19, s[28:31], s65 offen offset:3072 lds
    s_mov_b64 s[36:37], s[22:23]
    s_mov_b32 s38, 8912896
    s_mov_b32 s39, 0x20000
    s_add_u32 s40, s22, 9437184
    s_addc_u32 s41, s23, 0
    s_mov_b32 s42, 3310592
    s_mov_b32 s43, 0x20000
    s_mov_b64 s[44:45], s[18:19]
    s_mov_b32 s46, 2621440
    s_mov_b32 s47, 0x20000
    s_mov_b64 s[52:53], s[20:21]
    s_mov_b32 s54, 256
    s_mov_b32 s55, 0x20000
    s_mov_b32 s68, 200000
    s_mov_b32 s77, 0x67534021
    s_cmp_eq_u32 s59, 1
    s_cselect_b32 s77, 0x86452310, s77
    s_cmp_eq_u32 s59, 2
    s_cselect_b32 s77, 0x75642310, s77
    s_cmp_eq_u32 s59, 3
    s_cselect_b32 s77, 0x89352041, s77
    s_cmp_eq_u32 s59, 4
    s_cselect_b32 s77, 0x68234510, s77
    s_cmp_eq_u32 s59, 5
    s_cselect_b32 s77, 0x93824510, s77
    s_mov_b32 s72, 0x76899798
    s_mov_b32 s73, 0x6779
    s_lshl_b32 s59, s59, 3
    s_lshr_b64 s[72:73], s[72:73], s59
    s_mov_b32 s59, s72
    s_and_b32 s72, s2, 7
    s_lshr_b32 s60, s2, 6
    s_bfe_u32 s61, s2, 0x30003
    s_lshl2_add_u32 s60, s72, s60
    s_mul_i32 s71, s61, 68
    s_mul_i32 s72, s56, 12
    s_add_u32 s72, s72, s71
    s_mul_i32 s83, s72, 5120
    s_and_b32 s82, s60, 3
    s_mul_i32 s72, s56, 5
    s_add_u32 s72, s72, s71
    s_add_u32 s72, s72, 48
    s_mul_i32 s67, s72, 5120
    v_lshlrev_b32 v2, 4, v1
    v_min_u32 v3, 1, v1
    v_lshlrev_b32 v3, 30, v3
    s_mov_b64 s[32:33], s[22:23]
    s_mov_b32 s34, 8912896
    s_mov_b32 s35, 0x20000
    v_lshrrev_b32 v28, 4, v1
    v_and_b32 v29, 15, v1
    v_lshrrev_b32 v20, 1, v29
    v_xor_b32 v20, v20, v28
    v_lshlrev_b32 v20, 4, v20
    v_lshl_add_u32 v20, v29, 7, v20
    v_xor_b32 v20, s81, v20
    s_add_u32 s71, s62, 81920
    v_add_u32 v4, s71, v20
    v_xor_b32 v5, 64, v4
    s_cmp_eq_u32 s56, 0
    s_cselect_b32 s71, 24576, 0
    v_cmp_eq_u32 vcc, 0, v29
    v_add_u32 v20, s71, v4
    v_lshrrev_b32 v21, 2, v1
    v_cndmask_b32 v6, v4, v20, vcc
    v_xor_b32 v7, 64, v6
    v_mul_u32_u24 v21, 480, v21
    v_and_b32 v20, 3, v1
    v_mad_u32_u24 v8, v20, 40, v21
    v_add_u32 v9, 0x10000, v8
    v_min_u32 v20, 2, v28
    v_mul_u32_u24 v20, 24832, v20
    v_lshl_add_u32 v20, v29, 4, v20
    v_add_u32 v20, 73728, v20
    v_mov_b32 v56, 0x3f803f80
    v_mov_b32 v57, 0x3f803f80
    v_mov_b32 v58, 0x3f803f80
    v_mov_b32 v59, 0x3f803f80
    ds_write_b128 v20, v[56:59] offset:32768
    s_mov_b64 exec, 0
    s_cmp_eq_u32 s56, 0
    s_cbranch_scc1 Q_PG1
    s_cmp_eq_u32 s56, 1
    s_cbranch_scc1 Q_PG2
    s_cmp_eq_u32 s56, 2
    s_cbranch_scc1 Q_PG3
    s_cmp_eq_u32 s56, 3
    s_cbranch_scc1 Q_PG4
Q_TRET:
    s_mov_b64 exec, -1
    s_add_u32 s65, s65, s101
    s_add_u32 m0, s63, 16384
    s_nop 0
    buffer_load_dwordx4 v16, s[28:31], s65 offen offset:0 lds
    buffer_load_dwordx4 v17, s[28:31], s65 offen offset:1024 lds
    buffer_load_dwordx4 v18, s[28:31], s65 offen offset:2048 lds
    buffer_load_dwordx4 v19, s[28:31], s65 offen offset:3072 lds
    s_bfe_u32 s64, s77, 0x40004
    s_lshl_b32 s64, s64, 7
    s_add_u32 m0, s62, 106752
    s_nop 0
    buffer_load_dwordx4 v10, s[24:27], s64 offen offset:0 lds
    buffer_load_dwordx4 v11, s[24:27], s64 offen offset:1024 lds
    s_branch Q_BODY
K_END:
    s_endpgm
I_PRO:
    s_lshl2_add_u32 s71, s58, s56
    s_mul_i32 s71, s71, 4608
    s_add_u32 s71, s71, 3212288
    v_min_u32 v25, 35, v1
    v_lshlrev_b32 v25, 7, v25
    v_mov_b32 v20, 0
    v_mov_b32 v24, 1
    s_waitcnt lgkmcnt(0)
    s_add_u32 s40, s22, 9437184
    s_addc_u32 s41, s23, 0
    s_mov_b32 s42, 3310592
    s_mov_b32 s43, 0x20000
    buffer_store_dword v20, v25, s[40:43], s71 offen sc1
    s_mov_b64 s[24:25], s[4:5]
    s_mov_b32 s26, 2621440
    s_mov_b32 s27, 0x20000
    s_mov_b64 s[28:29], s[12:13]
    s_mov_b32 s30, 1966080
    s_mov_b32 s31, 0x20000
    s_mov_b64 s[32:33], s[12:13]
    s_mov_b32 s34, 1966080
    s_mov_b32 s35, 0x20000
    s_mov_b64 s[48:49], s[12:13]
    s_mov_b32 s50, 1966080
    s_mov_b32 s51, 0x20000
    s_mov_b64 s[36:37], s[22:23]
    s_mov_b32 s38, 8912896
    s_mov_b32 s39, 0x20000
    s_add_u32 s40, s22, 9437184
    s_addc_u32 s41, s23, 0
    s_mov_b32 s42, 3310592
    s_mov_b32 s43, 0x20000
    s_mov_b64 s[44:45], s[18:19]
    s_mov_b32 s46, 2621440
    s_mov_b32 s47, 0x20000
    s_mov_b64 s[52:53], s[20:21]
    s_mov_b32 s54, 256
    s_mov_b32 s55, 0x20000
    s_mov_b32 s68, 200000
    s_and_b32 s72, s2, 7
    s_lshr_b32 s60, s2, 6
    s_bfe_u32 s61, s2, 0x30003
    s_lshl2_add_u32 s60, s72, s60
    s_mul_i32 s71, s61, 68
    s_mul_i32 s72, s56, 12
    s_add_u32 s72, s72, s71
    s_mul_i32 s83, s72, 5120
    s_and_b32 s82, s60, 3
    s_mul_i32 s72, s56, 5
    s_add_u32 s72, s72, s71
    s_add_u32 s72, s72, 48
    s_mul_i32 s67, s72, 5120
    v_lshlrev_b32 v2, 4, v1
    v_min_u32 v3, 1, v1
    v_lshlrev_b32 v3, 30, v3
    s_lshl_b32 s71, s56, 28
    s_waitcnt vmcnt(0)
    s_barrier
    buffer_atomic_add v24, v3, s[52:55], s71 offen sc1
I_W:
    v_min_u32 v21, 16, v1
    s_mul_i32 s71, s56, -7
    s_add_u32 s71, s71, 36
    v_add_u32 v22, 4, v21
    v_lshrrev_b32 v22, 4, v22
    v_mad_u32_u24 v21, v22, s71, v21
    s_mul_i32 s71, s56, 24
    s_lshr_b32 s72, s61, 2
    s_add_u32 s71, s71, s72
    s_lshl_b32 s71, s71, 7
    s_add_u32 s71, s71, 3245056
    v_lshl_add_u32 v21, v21, 8, s71
I_WD:
    buffer_load_dword v20, off, s[52:55], 0 offset:0 sc1
    s_waitcnt vmcnt(0)
    v_cmp_gt_u32 vcc, 4, v20
    s_cbranch_vccz I_WDX
    s_sub_u32 s68, s68, 1
    s_cbranch_scc0 I_WD
    s_mov_b32 s68, 0
I_WDX:
I_WS:
    buffer_load_dword v20, v21, s[40:43], 0 offen sc1
    s_waitcnt vmcnt(0)
    v_cmp_eq_u32 vcc, 0, v20
    s_cbranch_vccz I_WSX
    s_sub_u32 s68, s68, 1
    s_cbranch_scc0 I_WS
    s_mov_b32 s68, 0
I_WSX:
    s_xor_b32 s66, s82, 0
    s_mul_i32 s66, s66, 15360
    s_add_u32 s66, s66, s83
    buffer_load_dwordx4 a[0:3], v2, s[40:43], s66 offen offset:0 sc1
    buffer_load_dwordx4 a[4:7], v2, s[40:43], s66 offen offset:1024 sc1
    buffer_load_dwordx4 a[8:11], v2, s[40:43], s66 offen offset:2048 sc1
    buffer_load_dwordx4 a[12:15], v2, s[40:43], s66 offen offset:3072 sc1
    s_add_u32 s66, s66, 4096
    buffer_load_dwordx4 a[16:19], v2, s[40:43], s66 offen offset:0 sc1
    buffer_load_dwordx4 a[20:23], v2, s[40:43], s66 offen offset:1024 sc1
    buffer_load_dwordx4 a[24:27], v2, s[40:43], s66 offen offset:2048 sc1
    buffer_load_dwordx4 a[28:31], v2, s[40:43], s66 offen offset:3072 sc1
    s_add_u32 s66, s66, 4096
    buffer_load_dwordx4 a[32:35], v2, s[40:43], s66 offen offset:0 sc1
    buffer_load_dwordx4 a[36:39], v2, s[40:43], s66 offen offset:1024 sc1
    buffer_load_dwordx4 a[40:43], v2, s[40:43], s66 offen offset:2048 sc1
    buffer_load_dwordx4 a[44:47], v2, s[40:43], s66 offen offset:3072 sc1
    s_add_u32 s66, s66, 4096
    buffer_load_dwordx4 a[48:51], v2, s[40:43], s66 offen offset:0 sc1
    buffer_load_dwordx4 a[52:55], v2, s[40:43], s66 offen offset:1024 sc1
    buffer_load_dwordx4 a[56:59], v2, s[40:43], s66 offen offset:2048 sc1
    s_xor_b32 s66, s82, 1
    s_mul_i32 s66, s66, 15360
    s_add_u32 s66, s66, s83
    buffer_load_dwordx4 a[60:63], v2, s[40:43], s66 offen offset:0 sc1
    buffer_load_dwordx4 a[64:67], v2, s[40:43], s66 offen offset:1024 sc1
    buffer_load_dwordx4 a[68:71], v2, s[40:43], s66 offen offset:2048 sc1
    buffer_load_dwordx4 a[72:75], v2, s[40:43], s66 offen offset:3072 sc1
    s_add_u32 s66, s66, 4096
    buffer_load_dwordx4 a[76:79], v2, s[40:43], s66 offen offset:0 sc1
    buffer_load_dwordx4 a[80:83], v2, s[40:43], s66 offen offset:1024 sc1
    buffer_load_dwordx4 a[84:87], v2, s[40:43], s66 offen offset:2048 sc1
    buffer_load_dwordx4 a[88:91], v2, s[40:43], s66 offen offset:3072 sc1
    s_add_u32 s66, s66, 4096
    buffer_load_dwordx4 a[92:95], v2, s[40:43], s66 offen offset:0 sc1
    buffer_load_dwordx4 a[96:99], v2, s[40:43], s66 offen offset:1024 sc1
    buffer_load_dwordx4 a[100:103], v2, s[40:43], s66 offen offset:2048 sc1
    buffer_load_dwordx4 a[104:107], v2, s[40:43], s66 offen offset:3072 sc1
    s_add_u32 s66, s66, 4096
    buffer_load_dwordx4 a[108:111], v2, s[40:43], s66 offen offset:0 sc1
    buffer_load_dwordx4 a[112:115], v2, s[40:43], s66 offen offset:1024 sc1
    buffer_load_dwordx4 a[116:119], v2, s[40:43], s66 offen offset:2048 sc1
    s_xor_b32 s66, s82, 2
    s_mul_i32 s66, s66, 15360
    s_add_u32 s66, s66, s83
    buffer_load_dwordx4 a[120:123], v2, s[40:43], s66 offen offset:0 sc1
    buffer_load_dwordx4 a[124:127], v2, s[40:43], s66 offen offset:1024 sc1
    buffer_load_dwordx4 a[128:131], v2, s[40:43], s66 offen offset:2048 sc1
    buffer_load_dwordx4 a[132:135], v2, s[40:43], s66 offen offset:3072 sc1
    s_add_u32 s66, s66, 4096
    buffer_load_dwordx4 a[136:139], v2, s[40:43], s66 offen offset:0 sc1
    buffer_load_dwordx4 a[140:143], v2, s[40:43], s66 offen offset:1024 sc1
    buffer_load_dwordx4 a[144:147], v2, s[40:43], s66 offen offset:2048 sc1
    buffer_load_dwordx4 a[148:151], v2, s[40:43], s66 offen offset:3072 sc1
    s_add_u32 s66, s66, 4096
    buffer_load_dwordx4 a[152:155], v2, s[40:43], s66 offen offset:0 sc1
    buffer_load_dwordx4 a[156:159], v2, s[40:43], s66 offen offset:1024 sc1
    buffer_load_dwordx4 a[160:163], v2, s[40:43], s66 offen offset:2048 sc1
    buffer_load_dwordx4 a[164:167], v2, s[40:43], s66 offen offset:3072 sc1
    s_add_u32 s66, s66, 4096
    buffer_load_dwordx4 a[168:171], v2, s[40:43], s66 offen offset:0 sc1
    buffer_load_dwordx4 a[172:175], v2, s[40:43], s66 offen offset:1024 sc1
    buffer_load_dwordx4 a[176:179], v2, s[40:43], s66 offen offset:2048 sc1
    s_xor_b32 s66, s82, 3
    s_mul_i32 s66, s66, 15360
    s_add_u32 s66, s66, s83
    buffer_load_dwordx4 a[180:183], v2, s[40:43], s66 offen offset:0 sc1
    buffer_load_dwordx4 a[184:187], v2, s[40:43], s66 offen offset:1024 sc1
    buffer_load_dwordx4 a[188:191], v2, s[40:43], s66 offen offset:2048 sc1
    s_waitcnt vmcnt(47)
    buffer_load_dwordx4 a[192:195], v2, s[40:43], s66 offen offset:3072 sc1
    s_waitcnt vmcnt(47)
    s_add_u32 s66, s66, 4096
    buffer_load_dwordx4 a[196:199], v2, s[40:43], s66 offen offset:0 sc1
    s_waitcnt vmcnt(47)
    buffer_load_dwordx4 a[200:203], v2, s[40:43], s66 offen offset:1024 sc1
    s_waitcnt vmcnt(47)
    buffer_load_dwordx4 a[204:207], v2, s[40:43], s66 offen offset:2048 sc1
    s_waitcnt vmcnt(47)
    buffer_load_dwordx4 a[208:211], v2, s[40:43], s66 offen offset:3072 sc1
    s_waitcnt vmcnt(47)
    s_add_u32 s66, s66, 4096
    buffer_load_dwordx4 a[212:215], v2, s[40:43], s66 offen offset:0 sc1
    s_waitcnt vmcnt(47)
    buffer_load_dwordx4 a[216:219], v2, s[40:43], s66 offen offset:1024 sc1
    s_waitcnt vmcnt(47)
    buffer_load_dwordx4 a[220:223], v2, s[40:43], s66 offen offset:2048 sc1
    s_waitcnt vmcnt(47)
    buffer_load_dwordx4 a[224:227], v2, s[40:43], s66 offen offset:3072 sc1
    s_waitcnt vmcnt(47)
    s_add_u32 s66, s66, 4096
    buffer_load_dwordx4 a[228:231], v2, s[40:43], s66 offen offset:0 sc1
    s_waitcnt vmcnt(47)
    buffer_load_dwordx4 a[232:235], v2, s[40:43], s66 offen offset:1024 sc1
    s_waitcnt vmcnt(47)
    buffer_load_dwordx4 a[236:239], v2, s[40:43], s66 offen offset:2048 sc1
    s_waitcnt vmcnt(47)
    buffer_load_dwordx4 a[240:243], v2, s[40:43], s67 offen offset:0 sc1
    s_waitcnt vmcnt(47)
    buffer_load_dwordx4 a[244:247], v2, s[40:43], s67 offen offset:1024 sc1
    s_waitcnt vmcnt(47)
    buffer_load_dwordx4 a[248:251], v2, s[40:43], s67 offen offset:2048 sc1
    s_waitcnt vmcnt(47)
    buffer_load_dwordx4 a[252:255], v2, s[40:43], s67 offen offset:3072 sc1
    s_waitcnt vmcnt(47)
    s_add_u32 s67, s67, 4096
    buffer_load_dwordx4 v[96:99], v2, s[40:43], s67 offen offset:0 sc1
    s_waitcnt vmcnt(47)
    buffer_load_dwordx4 v[100:103], v2, s[40:43], s67 offen offset:1024 sc1
    s_waitcnt vmcnt(47)
    buffer_load_dwordx4 v[104:107], v2, s[40:43], s67 offen offset:2048 sc1
    s_waitcnt vmcnt(47)
    buffer_load_dwordx4 v[108:111], v2, s[40:43], s67 offen offset:3072 sc1
    s_waitcnt vmcnt(47)
    s_add_u32 s67, s67, 4096
    buffer_load_dwordx4 v[112:115], v2, s[40:43], s67 offen offset:0 sc1
    s_waitcnt vmcnt(47)
    buffer_load_dwordx4 v[116:119], v2, s[40:43], s67 offen offset:1024 sc1
    s_waitcnt vmcnt(47)
    buffer_load_dwordx4 v[120:123], v2, s[40:43], s67 offen offset:2048 sc1
    s_waitcnt vmcnt(47)
    buffer_load_dwordx4 v[124:127], v2, s[40:43], s67 offen offset:3072 sc1
    s_waitcnt vmcnt(47)
    s_add_u32 s67, s67, 4096
    buffer_load_dwordx4 v[128:131], v2, s[40:43], s67 offen offset:0 sc1
    s_waitcnt vmcnt(47)
    buffer_load_dwordx4 v[132:135], v2, s[40:43], s67 offen offset:1024 sc1
    s_waitcnt vmcnt(47)
    buffer_load_dwordx4 v[136:139], v2, s[40:43], s67 offen offset:2048 sc1
    s_waitcnt vmcnt(47)
    buffer_load_dwordx4 v[140:143], v2, s[40:43], s67 offen offset:3072 sc1
    s_waitcnt vmcnt(47)
    s_add_u32 s67, s67, 4096
    buffer_load_dwordx4 v[144:147], v2, s[40:43], s67 offen offset:0 sc1
    s_waitcnt vmcnt(47)
    buffer_load_dwordx4 v[148:151], v2, s[40:43], s67 offen offset:1024 sc1
    s_waitcnt vmcnt(47)
    buffer_load_dwordx4 v[152:155], v2, s[40:43], s67 offen offset:2048 sc1
    s_xor_b32 s14, s82, 0
    s_mul_i32 s14, s14, 1536
    s_xor_b32 s15, s82, 1
    s_mul_i32 s15, s15, 1536
    s_xor_b32 s16, s82, 2
    s_mul_i32 s16, s16, 1536
    s_xor_b32 s17, s82, 3
    s_mul_i32 s17, s17, 1536
    s_and_b32 s3, s61, 0
    s_add_u32 s3, s3, s56
    s_mul_i32 s73, s60, 278528
    s_mul_i32 s74, s56, 6144
    s_add_u32 s73, s73, s74
    s_mul_i32 s74, s56, -3584
    s_add_u32 s74, s74, 24576
    s_sub_u32 s74, s74, s14
    s_add_u32 s75, s3, 1
    s_and_b32 s75, s75, 3
    s_mul_i32 s75, s75, 69632
    s_add_u32 s4, s75, s73
    s_add_u32 s8, s4, s74
    s_add_u32 s75, s3, 2
    s_and_b32 s75, s75, 3
    s_mul_i32 s75, s75, 69632
    s_add_u32 s5, s75, s73
    s_add_u32 s9, s5, s74
    s_add_u32 s75, s3, 3
    s_and_b32 s75, s75, 3
    s_mul_i32 s75, s75, 69632
    s_add_u32 s6, s75, s73
    s_add_u32 s10, s6, s74
    s_add_u32 s75, s3, 4
    s_and_b32 s75, s75, 3
    s_mul_i32 s75, s75, 69632
    s_add_u32 s7, s75, s73
    s_add_u32 s11, s7, s74
    s_mul_i32 s23, s56, 384
    s_add_u32 s23, s23, 3212288
    v_bfe_u32 v15, v1, 3, 1
    v_mul_u32_u24 v7, 34816, v15
    v_lshrrev_b32 v15, 4, v1
    v_lshl_add_u32 v7, v15, 7, v7
    v_and_b32 v15, 7, v1
    v_lshl_add_u32 v7, v15, 4, v7
    v_add_u32 v4, s14, v7
    v_add_u32 v5, s15, v7
    v_add_u32 v6, s16, v7
    v_add_u32 v7, s17, v7
    v_lshrrev_b32 v15, 5, v1
    v_mul_u32_u24 v15, 63, v15
    v_lshl_add_u32 v15, s60, 6, v15
    v_mul_u32_u24 v15, 6637, v15
    v_lshrrev_b32 v15, 20, v15
    v_and_b32 v14, 15, v1
    v_min_u32 v14, 2, v14
    v_mad_u32_u24 v15, v15, 12, v14
    v_lshl_add_u32 v14, v15, 7, s23
    v_mov_b32 v12, 0
    s_branch F_P2
.p2align 12
F_BODY:
    s_mov_b64 s[36:37], s[22:23]
    s_mov_b32 s38, 8912896
    s_mov_b32 s39, 0x20000
    s_add_u32 s40, s22, 9437184
    s_addc_u32 s41, s23, 0
    s_mov_b32 s42, 3310592
    s_mov_b32 s43, 0x20000
    s_mov_b64 s[44:45], s[18:19]
    s_mov_b32 s46, 2621440
    s_mov_b32 s47, 0x20000
    s_mov_b64 s[52:53], s[20:21]
    s_mov_b32 s54, 256
    s_mov_b32 s55, 0x20000
    s_mov_b32 s68, 200000
    s_mov_b32 s77, 0x86453021
    s_cmp_eq_u32 s59, 1
    s_cselect_b32 s77, 0x75642310, s77
    s_cmp_eq_u32 s59, 2
    s_cselect_b32 s77, 0x67534210, s77
    s_cmp_eq_u32 s59, 3
    s_cselect_b32 s77, 0x68235041, s77
    s_cmp_eq_u32 s59, 4
    s_cselect_b32 s77, 0x93824510, s77
    s_cmp_eq_u32 s59, 5
    s_cselect_b32 s77, 0x89352410, s77
    s_mov_b32 s72, 0x79988997
    s_mov_b32 s73, 0x7667
    s_lshl_b32 s59, s59, 3
    s_lshr_b64 s[72:73], s[72:73], s59
    s_mov_b32 s59, s72
    s_and_b32 s72, s2, 7
    s_lshr_b32 s60, s2, 6
    s_bfe_u32 s61, s2, 0x30003
    s_lshl2_add_u32 s60, s72, s60
    s_mul_i32 s71, s61, 68
    s_mul_i32 s72, s56, 12
    s_add_u32 s72, s72, s71
    s_mul_i32 s83, s72, 5120
    s_and_b32 s82, s60, 3
    s_mul_i32 s72, s56, 5
    s_add_u32 s72, s72, s71
    s_add_u32 s72, s72, 48
    s_mul_i32 s67, s72, 5120
    v_lshlrev_b32 v2, 4, v1
    v_min_u32 v3, 1, v1
    v_lshlrev_b32 v3, 30, v3
    s_add_u32 s71, s58, 6
    s_lshr_b32 s71, s71, 3
    s_sub_u32 s72, s58, s71
    s_mul_i32 s69, s57, 10
    s_add_u32 s69, s69, s72
    s_sub_u32 s72, 77, s57
    s_lshl1_add_u32 s72, s72, s71
    s_and_b32 s71, s58, 7
    s_cmp_eq_u32 s71, 1
    s_cselect_b32 s69, s72, s69
    s_lshr_b32 s4, s69, 1
    s_and_b32 s5, s69, 1
    s_lshl_b32 s5, s5, 2
    s_add_u32 s5, s5, s56
    s_sub_u32 s71, s4, 48
    s_mul_i32 s72, s71, 52
    s_lshr_b32 s72, s72, 8
    s_mul_i32 s73, s72, 5
    s_sub_u32 s73, s71, s73
    s_mul_i32 s72, s72, 160
    s_lshr_b32 s74, s73, 1
    s_mul_i32 s74, s74, 80
    s_and_b32 s75, s73, 1
    s_lshl_b32 s75, s75, 3
    s_add_u32 s74, s74, s75
    s_cmp_eq_u32 s73, 4
    s_cselect_b32 s74, 16, s74
    s_cselect_b32 s7, 80, 40
    s_cselect_b32 s10, 40, 4
    s_add_u32 s11, s72, s74
    s_lshl_b32 s71, s4, 5
    s_cmp_lt_u32 s4, 48
    s_cselect_b32 s11, s71, s11
    s_cselect_b32 s6, 4, 20
    s_cselect_b32 s7, 8, s7
    s_cselect_b32 s10, 16, s10
    s_cselect_b32 s48, s16, s8
    s_cselect_b32 s49, s17, s9
    s_mov_b32 s50, 819200
    s_cselect_b32 s50, 1966080, s50
    s_mov_b32 s51, 0x20000
    s_add_u32 s11, s11, s56
    s_lshr_b32 s71, s5, 2
    s_lshl1_add_u32 s11, s11, s71
    s_mul_i32 s12, s11, 640
    s_mul_i32 s11, s56, 5152
    s_mul_i32 s13, s5, 68
    s_add_u32 s13, s13, s4
    s_mul_i32 s13, s13, 5120
    s_cmp_ge_u32 s4, 68
    s_cselect_b32 s13, 1073741824, s13
    v_lshrrev_b32 v28, 4, v1
    v_and_b32 v29, 15, v1
    v_lshrrev_b32 v20, 1, v29
    v_xor_b32 v20, v20, v28
    v_lshlrev_b32 v20, 4, v20
    v_lshl_add_u32 v20, v29, 7, v20
    v_xor_b32 v20, s81, v20
    v_add_u32 v4, 98304, v20
    v_xor_b32 v5, 64, v4
    v_add_u32 v20, 1, v29
    v_and_b32 v20, 16, v20
    v_lshl_add_u32 v6, v20, 4, v4
    v_xor_b32 v7, 64, v6
    v_bfe_u32 v20, v1, 2, 3
    s_lshl_b32 s71, s56, 1
    v_xor_b32 v21, s71, v20
    v_lshlrev_b32 v21, 5, v21
    v_lshl_add_u32 v21, v20, 8, v21
    v_lshrrev_b32 v20, 5, v1
    v_lshl_add_u32 v21, v20, 12, v21
    v_and_b32 v20, 3, v1
    v_lshl_add_u32 v8, v20, 3, v21
    v_xor_b32 v9, 32, v8
    v_add_u32 v15, 0x10000, v8
    v_add_u32 v16, 0x10000, v9
    s_add_u32 s65, s65, s101
    s_add_u32 m0, s63, 16384
    s_nop 0
    buffer_load_dwordx4 v17, s[28:31], s65 offen offset:0 lds
    buffer_load_dwordx4 v18, s[28:31], s65 offen offset:1024 lds
    buffer_load_dwordx4 v17, s[32:35], s65 offen offset:2048 lds
    buffer_load_dwordx4 v18, s[32:35], s65 offen offset:3072 lds
    v_min_u32 v20, 2, v28
    v_mul_u32_u24 v20, 20736, v20
    v_lshl_add_u32 v20, v29, 4, v20
    v_add_u32 v20, 86016, v20
    v_mov_b32 v48, 0x3f803f80
    v_mov_b32 v49, 0x3f803f80
    v_mov_b32 v50, 0x3f803f80
    v_mov_b32 v51, 0x3f803f80
    ds_write_b128 v20, v[48:51] offset:32768
    s_lshl_b32 s71, s69, 4
    s_lshl_b32 s72, s56, 2
    s_add_u32 s71, s71, s72
    v_add_u32 v20, s71, v28
    v_mul_u32_u24 v26, 1280, v20
    v_lshl_add_u32 v26, v29, 4, v26
    v_bfe_u32 v21, v20, 1, 2
    v_and_or_b32 v21, v20, -8, v21
    v_and_b32 v20, 1, v20
    v_lshl_add_u32 v20, v20, 2, v21
    v_lshlrev_b32 v20, 4, v20
    v_min_u32 v21, 1, v29
    v_lshl_add_u32 v20, v21, 30, v20
    v_add_u32 v27, 3145728, v20
    v_bfe_u32 v20, v1, 2, 2
    v_mul_u32_u24 v20, 5152, v20
    v_and_b32 v21, 3, v1
    v_mul_u32_u24 v22, 640, v28
    s_mul_i32 s71, s56, 160
    s_add_u32 s71, s71, 65536
    v_add3_u32 v20, s71, v20, v22
    v_lshl_add_u32 v25, v21, 5, v20
    v_lshl_add_u32 v0, v21, 3, v20
    s_movk_i32 s71, -40
    v_add_u32 v30, 0, v1
    v_mul_u32_u24 v31, 1639, v30
    v_lshrrev_b32 v31, 16, v31
    v_mad_i32_i24 v30, v31, s71, v30
    v_and_b32 v32, 1, v31
    v_mul_u32_u24 v20, s6, v32
    v_bfe_u32 v32, v31, 1, 1
    v_mad_u32_u24 v20, v32, s7, v20
    v_lshrrev_b32 v32, 2, v31
    v_mad_u32_u24 v20, v32, s10, v20
    v_mul_u32_u24 v20, 1280, v20
    v_lshl_add_u32 v20, v30, 4, v20
    v_add_u32 v30, 64, v1
    v_mul_u32_u24 v31, 1639, v30
    v_lshrrev_b32 v31, 16, v31
    v_mad_i32_i24 v30, v31, s71, v30
    v_and_b32 v32, 1, v31
    v_mul_u32_u24 v21, s6, v32
    v_bfe_u32 v32, v31, 1, 1
    v_mad_u32_u24 v21, v32, s7, v21
    v_lshrrev_b32 v32, 2, v31
    v_mad_u32_u24 v21, v32, s10, v21
    v_mul_u32_u24 v21, 1280, v21
    v_lshl_add_u32 v21, v30, 4, v21
    v_add_u32 v30, 128, v1
    v_mul_u32_u24 v31, 1639, v30
    v_lshrrev_b32 v31, 16, v31
    v_mad_i32_i24 v30, v31, s71, v30
    v_and_b32 v32, 1, v31
    v_mul_u32_u24 v22, s6, v32
    v_bfe_u32 v32, v31, 1, 1
    v_mad_u32_u24 v22, v32, s7, v22
    v_lshrrev_b32 v32, 2, v31
    v_mad_u32_u24 v22, v32, s10, v22
    v_mul_u32_u24 v22, 1280, v22
    v_lshl_add_u32 v22, v30, 4, v22
    v_add_u32 v30, 192, v1
    v_mul_u32_u24 v31, 1639, v30
    v_lshrrev_b32 v31, 16, v31
    v_mad_i32_i24 v30, v31, s71, v30
    v_and_b32 v32, 1, v31
    v_mul_u32_u24 v23, s6, v32
    v_bfe_u32 v32, v31, 1, 1
    v_mad_u32_u24 v23, v32, s7, v23
    v_lshrrev_b32 v32, 2, v31
    v_mad_u32_u24 v23, v32, s10, v23
    v_mul_u32_u24 v23, 1280, v23
    v_lshl_add_u32 v23, v30, 4, v23
    v_add_u32 v30, 256, v1
    v_mul_u32_u24 v31, 1639, v30
    v_lshrrev_b32 v31, 16, v31
    v_mad_i32_i24 v30, v31, s71, v30
    v_and_b32 v32, 1, v31
    v_mul_u32_u24 v24, s6, v32
    v_bfe_u32 v32, v31, 1, 1
    v_mad_u32_u24 v24, v32, s7, v24
    v_lshrrev_b32 v32, 2, v31
    v_mad_u32_u24 v24, v32, s10, v24
    v_mul_u32_u24 v24, 1280, v24
    v_lshl_add_u32 v24, v30, 4, v24
    s_mov_b64 exec, 0
    s_cmp_eq_u32 s56, 0
    s_cbranch_scc1 F_PG1
    s_cmp_eq_u32 s56, 1
    s_cbranch_scc1 F_PG2
    s_cmp_eq_u32 s56, 2
    s_cbranch_scc1 F_PG3
    s_cmp_eq_u32 s56, 3
    s_cbranch_scc1 F_PG4
F_TRET:
    s_mov_b64 exec, -1
    s_bfe_u32 s64, s77, 0x40004
    s_lshl_b32 s64, s64, 7
    s_add_u32 m0, s62, 119040
    s_nop 0
    buffer_load_dwordx4 v10, s[24:27], s64 offen offset:0 lds
    buffer_load_dwordx4 v11, s[24:27], s64 offen offset:1024 lds
    s_add_u32 m0, s62, 121088
    s_nop 0
    buffer_load_dwordx4 v12, s[24:27], s64 offen offset:0 lds
    buffer_load_dwordx4 v13, s[24:27], s64 offen offset:1024 lds
    buffer_load_dwordx4 v14, s[24:27], s64 offen offset:2048 lds
    s_waitcnt vmcnt(9) lgkmcnt(0)
    s_barrier
    ds_read_b64_tr_b16 v[48:49], v8 offset:0
    ds_read_b64_tr_b16 v[50:51], v8 offset:8192
    ds_read_b128 v[80:83], v4 offset:0
    ds_read_b64_tr_b16 v[52:53], v9 offset:0
    ds_read_b64_tr_b16 v[54:55], v9 offset:8192
    ds_read_b64_tr_b16 v[56:57], v8 offset:2048
    ds_read_b64_tr_b16 v[58:59], v8 offset:10240
    ds_read_b64_tr_b16 v[60:61], v9 offset:2048
    ds_read_b64_tr_b16 v[62:63], v9 offset:10240
    ds_read_b128 v[84:87], v4 offset:2048
    ds_read_b128 v[88:91], v4 offset:4096
    s_waitcnt lgkmcnt(2)
    v_mfma_f32_16x16x32_bf16 v[96:99], v[48:51], v[80:83], 0
    s_bfe_u32 s65, s77, 0x40004
    ds_read_b128 v[92:95], v4 offset:6144
    s_lshl1_add_u32 s65, s65, s76
    v_mfma_f32_16x16x32_bf16 v[100:103], v[52:55], v[80:83], 0
    s_waitcnt vmcnt(5)
    s_barrier
    s_mul_i32 s65, s65, 98304
    v_mfma_f32_16x16x32_bf16 v[104:107], v[56:59], v[80:83], 0
    s_add_u32 m0, s63, 32768
    ds_read_b64_tr_b16 v[64:65], v8 offset:16384
    v_mfma_f32_16x16x32_bf16 v[108:111], v[60:63], v[80:83], 0
    s_waitcnt lgkmcnt(3)
    ds_read_b64_tr_b16 v[66:67], v8 offset:24576
    buffer_load_dwordx4 v17, s[28:31], s65 offen offset:0 lds
    v_mfma_f32_16x16x32_bf16 v[124:127], v[60:63], v[84:87], 0
    ds_read_b128 a[216:219], v4 offset:8192
    buffer_load_dwordx4 v18, s[28:31], s65 offen offset:1024 lds
    v_mfma_f32_16x16x32_bf16 v[120:123], v[56:59], v[84:87], 0
    ds_read_b64_tr_b16 v[68:69], v9 offset:16384
    buffer_load_dwordx4 v17, s[32:35], s65 offen offset:2048 lds
    v_mfma_f32_16x16x32_bf16 v[116:119], v[52:55], v[84:87], 0
    buffer_load_dwordx4 v18, s[32:35], s65 offen offset:3072 lds
    s_add_u32 s65, s65, s101
    v_mfma_f32_16x16x32_bf16 v[112:115], v[48:51], v[84:87], 0
    s_waitcnt lgkmcnt(5)
    ds_read_b64_tr_b16 v[70:71], v9 offset:24576
    s_add_u32 m0, s63, 49152
    v_mfma_f32_16x16x32_bf16 v[128:131], v[48:51], v[88:91], 0
    ds_read_b128 a[220:223], v4 offset:10240
    buffer_load_dwordx4 v17, s[28:31], s65 offen offset:0 lds
    v_mfma_f32_16x16x32_bf16 v[132:135], v[52:55], v[88:91], 0
    ds_read_b64_tr_b16 v[72:73], v8 offset:18432
    v_mfma_f32_16x16x32_bf16 v[136:139], v[56:59], v[88:91], 0
    ds_read_b64_tr_b16 v[74:75], v8 offset:26624
    v_mfma_f32_16x16x32_bf16 v[140:143], v[60:63], v[88:91], 0
    s_waitcnt lgkmcnt(8)
    ds_read_b128 v[80:83], v5 offset:10240
    buffer_load_dwordx4 v18, s[28:31], s65 offen offset:1024 lds
    v_mfma_f32_16x16x32_bf16 v[156:159], v[60:63], v[92:95], 0
    ds_read_b64_tr_b16 v[76:77], v9 offset:18432
    v_mfma_f32_16x16x32_bf16 v[152:155], v[56:59], v[92:95], 0
    v_mfma_f32_16x16x32_bf16 v[148:151], v[52:55], v[92:95], 0
    ds_read_b64_tr_b16 v[78:79], v9 offset:26624
    v_mfma_f32_16x16x32_bf16 v[144:147], v[48:51], v[92:95], 0
    s_waitcnt lgkmcnt(8)
    buffer_load_dwordx4 v17, s[32:35], s65 offen offset:2048 lds
    v_mfma_f32_16x16x32_bf16 v[160:163], v[48:51], a[216:219], 0
    ds_read_b128 v[84:87], v4 offset:12288
    v_mfma_f32_16x16x32_bf16 v[164:167], v[52:55], a[216:219], 0
    v_mfma_f32_16x16x32_bf16 v[168:171], v[56:59], a[216:219], 0
    v_mfma_f32_16x16x32_bf16 v[172:175], v[60:63], a[216:219], 0
    s_waitcnt lgkmcnt(1)
    ds_read_b128 v[88:91], v5 offset:12288
    buffer_load_dwordx4 v18, s[32:35], s65 offen offset:3072 lds
    v_mfma_f32_16x16x32_bf16 v[188:191], v[60:63], a[220:223], 0
    s_bfe_u32 s64, s77, 0x40008
    s_lshl_b32 s64, s64, 7
    v_mfma_f32_16x16x32_bf16 v[188:191], v[76:79], v[80:83], v[188:191]
    s_add_u32 m0, s62, 139776
    v_mfma_f32_16x16x32_bf16 v[184:187], v[72:75], v[80:83], 0
    v_mfma_f32_16x16x32_bf16 v[184:187], v[56:59], a[220:223], v[184:187]
    buffer_load_dwordx4 v10, s[24:27], s64 offen offset:0 lds
    v_mfma_f32_16x16x32_bf16 v[180:183], v[52:55], a[220:223], 0
    ds_read_b128 v[92:95], v4 offset:14336
    v_mfma_f32_16x16x32_bf16 v[180:183], v[68:71], v[80:83], v[180:183]
    v_mfma_f32_16x16x32_bf16 v[176:179], v[64:67], v[80:83], 0
    v_mfma_f32_16x16x32_bf16 v[176:179], v[48:51], a[220:223], v[176:179]
    s_waitcnt lgkmcnt(1)
    ds_read_b128 a[216:219], v5 offset:14336
    v_mfma_f32_16x16x32_bf16 v[192:195], v[48:51], v[84:87], 0
    v_mfma_f32_16x16x32_bf16 v[192:195], v[64:67], v[88:91], v[192:195]
    v_mfma_f32_16x16x32_bf16 v[196:199], v[68:71], v[88:91], 0
    v_mfma_f32_16x16x32_bf16 v[196:199], v[52:55], v[84:87], v[196:199]
    buffer_load_dwordx4 v11, s[24:27], s64 offen offset:1024 lds
    s_add_u32 m0, s62, 141824
    v_mfma_f32_16x16x32_bf16 v[200:203], v[56:59], v[84:87], 0
    s_waitcnt vmcnt(6)
    s_barrier
    ds_read_b128 a[220:223], v4 offset:16384
    v_mfma_f32_16x16x32_bf16 v[200:203], v[72:75], v[88:91], v[200:203]
    ds_read_b64_tr_b16 a[240:241], v8 offset:32768
    v_mfma_f32_16x16x32_bf16 v[204:207], v[76:79], v[88:91], 0
    v_mfma_f32_16x16x32_bf16 v[204:207], v[60:63], v[84:87], v[204:207]
    s_waitcnt lgkmcnt(2)
    ds_read_b128 v[80:83], v5 offset:16384
    buffer_load_dwordx4 v12, s[24:27], s64 offen offset:0 lds
    v_mfma_f32_16x16x32_bf16 v[220:223], v[60:63], v[92:95], 0
    ds_read_b64_tr_b16 a[242:243], v8 offset:40960
    v_mfma_f32_16x16x32_bf16 v[220:223], v[76:79], a[216:219], v[220:223]
    v_mfma_f32_16x16x32_bf16 v[216:219], v[72:75], a[216:219], 0
    v_mfma_f32_16x16x32_bf16 v[216:219], v[56:59], v[92:95], v[216:219]
    ds_read_b64_tr_b16 a[244:245], v9 offset:32768
    buffer_load_dwordx4 v13, s[24:27], s64 offen offset:1024 lds
    v_mfma_f32_16x16x32_bf16 v[212:215], v[52:55], v[92:95], 0
    ds_read_b128 v[84:87], v6 offset:18432
    v_mfma_f32_16x16x32_bf16 v[212:215], v[68:71], a[216:219], v[212:215]
    v_mfma_f32_16x16x32_bf16 v[208:211], v[64:67], a[216:219], 0
    ds_read_b64_tr_b16 a[246:247], v9 offset:40960
    v_mfma_f32_16x16x32_bf16 v[208:211], v[48:51], v[92:95], v[208:211]
    s_waitcnt lgkmcnt(4)
    ds_read_b128 v[88:91], v7 offset:18432
    buffer_load_dwordx4 v14, s[24:27], s64 offen offset:2048 lds
    v_mfma_f32_16x16x32_bf16 v[224:227], v[48:51], a[220:223], 0
    s_bfe_u32 s65, s77, 0x40008
    s_lshl1_add_u32 s65, s65, s76
    v_mfma_f32_16x16x32_bf16 v[224:227], v[64:67], v[80:83], v[224:227]
    s_mul_i32 s65, s65, 98304
    ds_read_b64_tr_b16 a[248:249], v8 offset:34816
    s_add_u32 m0, s63, 0
    v_mfma_f32_16x16x32_bf16 v[228:231], v[68:71], v[80:83], 0
    v_mfma_f32_16x16x32_bf16 v[228:231], v[52:55], a[220:223], v[228:231]
    buffer_load_dwordx4 v17, s[28:31], s65 offen offset:0 lds
    v_mfma_f32_16x16x32_bf16 v[232:235], v[56:59], a[220:223], 0
    ds_read_b128 v[92:95], v5 offset:0
    v_mfma_f32_16x16x32_bf16 v[232:235], v[72:75], v[80:83], v[232:235]
    ds_read_b64_tr_b16 a[250:251], v8 offset:43008
    v_mfma_f32_16x16x32_bf16 v[236:239], v[76:79], v[80:83], 0
    v_mfma_f32_16x16x32_bf16 v[236:239], v[60:63], a[220:223], v[236:239]
    s_waitcnt lgkmcnt(3)
    ds_read_b128 a[216:219], v4 offset:20736
    buffer_load_dwordx4 v18, s[28:31], s65 offen offset:1024 lds
    v_mfma_f32_16x16x32_bf16 v[252:255], v[60:63], v[84:87], 0
    ds_read_b64_tr_b16 a[252:253], v9 offset:34816
    v_mfma_f32_16x16x32_bf16 v[252:255], v[76:79], v[88:91], v[252:255]
    v_mfma_f32_16x16x32_bf16 v[248:251], v[72:75], v[88:91], 0
    ds_read_b64_tr_b16 a[254:255], v9 offset:43008
    v_mfma_f32_16x16x32_bf16 v[248:251], v[56:59], v[84:87], v[248:251]
    buffer_load_dwordx4 v17, s[32:35], s65 offen offset:2048 lds
    v_mfma_f32_16x16x32_bf16 v[244:247], v[52:55], v[84:87], 0
    ds_read_b128 a[220:223], v5 offset:2048
    v_mfma_f32_16x16x32_bf16 v[244:247], v[68:71], v[88:91], v[244:247]
    v_mfma_f32_16x16x32_bf16 v[240:243], v[64:67], v[88:91], 0
    v_mfma_f32_16x16x32_bf16 v[240:243], v[48:51], v[84:87], v[240:243]
    s_waitcnt lgkmcnt(1)
    ds_read_b128 v[80:83], v4 offset:22784
    buffer_load_dwordx4 v18, s[32:35], s65 offen offset:3072 lds
    v_mfma_f32_16x16x32_bf16 v[96:99], v[64:67], v[92:95], v[96:99]
    s_add_u32 m0, s11, 65536
    v_mfma_f32_16x16x32_bf16 v[96:99], a[240:243], a[216:219], v[96:99]
    v_mfma_f32_16x16x32_bf16 v[100:103], a[244:247], a[216:219], v[100:103]
    v_mfma_f32_16x16x32_bf16 v[100:103], v[68:71], v[92:95], v[100:103]
    v_mfma_f32_16x16x32_bf16 v[104:107], v[72:75], v[92:95], v[104:107]
    ds_read_b128 v[84:87], v5 offset:4096
    v_mfma_f32_16x16x32_bf16 v[104:107], a[248:251], a[216:219], v[104:107]
    v_mfma_f32_16x16x32_bf16 v[108:111], a[252:255], a[216:219], v[108:111]
    v_mfma_f32_16x16x32_bf16 v[108:111], v[76:79], v[92:95], v[108:111]
    s_waitcnt lgkmcnt(1)
    ds_read_b128 v[88:91], v4 offset:24832
    buffer_load_dwordx4 v20, s[48:51], s12 offen lds
    v_mfma_f32_16x16x32_bf16 v[124:127], v[76:79], a[220:223], v[124:127]
    s_add_u32 m0, s11, 66560
    v_mfma_f32_16x16x32_bf16 v[124:127], a[252:255], v[80:83], v[124:127]
    v_mfma_f32_16x16x32_bf16 v[120:123], a[248:251], v[80:83], v[120:123]
    v_mfma_f32_16x16x32_bf16 v[120:123], v[72:75], a[220:223], v[120:123]
    buffer_load_dwordx4 v21, s[48:51], s12 offen lds
    s_add_u32 m0, s11, 67584
    v_mfma_f32_16x16x32_bf16 v[116:119], v[68:71], a[220:223], v[116:119]
    s_waitcnt vmcnt(11)
    s_barrier
    ds_read_b128 v[92:95], v5 offset:6144
    v_mfma_f32_16x16x32_bf16 v[116:119], a[244:247], v[80:83], v[116:119]
    ds_read_b64_tr_b16 a[224:225], v8 offset:49152
    v_mfma_f32_16x16x32_bf16 v[112:115], a[240:243], v[80:83], v[112:115]
    v_mfma_f32_16x16x32_bf16 v[112:115], v[64:67], a[220:223], v[112:115]
    s_waitcnt lgkmcnt(2)
    ds_read_b128 a[216:219], v4 offset:26880
    buffer_load_dwordx4 v22, s[48:51], s12 offen lds
    v_mfma_f32_16x16x32_bf16 v[128:131], v[64:67], v[84:87], v[128:131]
    s_add_u32 m0, s11, 68608
    ds_read_b64_tr_b16 a[226:227], v8 offset:57344
    v_mfma_f32_16x16x32_bf16 v[128:131], a[240:243], v[88:91], v[128:131]
    v_mfma_f32_16x16x32_bf16 v[132:135], a[244:247], v[88:91], v[132:135]
    v_mfma_f32_16x16x32_bf16 v[132:135], v[68:71], v[84:87], v[132:135]
    ds_read_b64_tr_b16 a[228:229], v9 offset:49152
    buffer_load_dwordx4 v23, s[48:51], s12 offen lds
    v_mfma_f32_16x16x32_bf16 v[136:139], v[72:75], v[84:87], v[136:139]
    s_add_u32 m0, s11, 69632
    ds_read_b128 a[220:223], v5 offset:8192
    v_mfma_f32_16x16x32_bf16 v[136:139], a[248:251], v[88:91], v[136:139]
    v_mfma_f32_16x16x32_bf16 v[140:143], a[252:255], v[88:91], v[140:143]
    ds_read_b64_tr_b16 a[230:231], v9 offset:57344
    v_mfma_f32_16x16x32_bf16 v[140:143], v[76:79], v[84:87], v[140:143]
    s_waitcnt lgkmcnt(4)
    ds_read_b128 v[80:83], v4 offset:28928
    buffer_load_dwordx4 v24, s[48:51], s12 offen lds
    v_mfma_f32_16x16x32_bf16 v[156:159], v[76:79], v[92:95], v[156:159]
    s_add_u32 s65, s65, s101
    s_add_u32 m0, s63, 16384
    v_mfma_f32_16x16x32_bf16 v[156:159], a[252:255], a[216:219], v[156:159]
    ds_read_b64_tr_b16 a[232:233], v8 offset:51200
    v_mfma_f32_16x16x32_bf16 v[152:155], a[248:251], a[216:219], v[152:155]
    v_mfma_f32_16x16x32_bf16 v[152:155], v[72:75], v[92:95], v[152:155]
    buffer_load_dwordx4 v17, s[28:31], s65 offen offset:0 lds
    v_mfma_f32_16x16x32_bf16 v[148:151], v[68:71], v[92:95], v[148:151]
    ds_read_b128 v[84:87], v4 offset:30976
    v_mfma_f32_16x16x32_bf16 v[148:151], a[244:247], a[216:219], v[148:151]
    ds_read_b64_tr_b16 a[234:235], v8 offset:59392
    v_mfma_f32_16x16x32_bf16 v[144:147], a[240:243], a[216:219], v[144:147]
    v_mfma_f32_16x16x32_bf16 v[144:147], v[64:67], v[92:95], v[144:147]
    s_waitcnt lgkmcnt(3)
    ds_read_b128 v[88:91], v5 offset:30976
    v_mfma_f32_16x16x32_bf16 v[160:163], v[64:67], a[220:223], v[160:163]
    ds_read_b64_tr_b16 a[236:237], v9 offset:51200
    v_mfma_f32_16x16x32_bf16 v[160:163], a[240:243], v[80:83], v[160:163]
    v_mfma_f32_16x16x32_bf16 v[164:167], a[244:247], v[80:83], v[164:167]
    ds_read_b64_tr_b16 a[238:239], v9 offset:59392
    v_mfma_f32_16x16x32_bf16 v[164:167], v[68:71], a[220:223], v[164:167]
    buffer_load_dwordx4 v18, s[28:31], s65 offen offset:1024 lds
    v_mfma_f32_16x16x32_bf16 v[168:171], v[72:75], a[220:223], v[168:171]
    ds_read_b128 v[92:95], v4 offset:33024
    v_mfma_f32_16x16x32_bf16 v[168:171], a[248:251], v[80:83], v[168:171]
    v_mfma_f32_16x16x32_bf16 v[172:175], a[252:255], v[80:83], v[172:175]
    v_mfma_f32_16x16x32_bf16 v[172:175], v[76:79], a[220:223], v[172:175]
    s_waitcnt lgkmcnt(1)
    ds_read_b128 a[216:219], v5 offset:33024
    buffer_load_dwordx4 v17, s[32:35], s65 offen offset:2048 lds
    v_mfma_f32_16x16x32_bf16 v[188:191], a[252:255], v[84:87], v[188:191]
    v_mfma_f32_16x16x32_bf16 v[188:191], a[236:239], v[88:91], v[188:191]
    s_barrier
    v_mfma_f32_16x16x32_bf16 v[184:187], a[232:235], v[88:91], v[184:187]
    v_mfma_f32_16x16x32_bf16 v[184:187], a[248:251], v[84:87], v[184:187]
    buffer_load_dwordx4 v18, s[32:35], s65 offen offset:3072 lds
    s_bfe_u32 s64, s77, 0x4000c
    v_mfma_f32_16x16x32_bf16 v[180:183], a[244:247], v[84:87], v[180:183]
    s_lshl_b32 s64, s64, 7
    ds_read_b128 a[220:223], v4 offset:35072
    s_add_u32 m0, s62, 98304
    v_mfma_f32_16x16x32_bf16 v[180:183], a[228:231], v[88:91], v[180:183]
    s_waitcnt vmcnt(4)
    s_barrier
    v_mfma_f32_16x16x32_bf16 v[176:179], a[224:227], v[88:91], v[176:179]
    ds_read_b64_tr_b16 v[48:49], v8 offset:0
    v_mfma_f32_16x16x32_bf16 v[176:179], a[240:243], v[84:87], v[176:179]
    s_waitcnt lgkmcnt(2)
    ds_read_b128 v[80:83], v5 offset:35072
    v_mfma_f32_16x16x32_bf16 v[192:195], a[240:243], v[92:95], v[192:195]
    ds_read_b64_tr_b16 a[0:1], v25 offset:0
    v_mfma_f32_16x16x32_bf16 v[192:195], a[224:227], a[216:219], v[192:195]
    ds_read_b64_tr_b16 a[2:3], v25 offset:2560
    buffer_load_dwordx4 v10, s[24:27], s64 offen offset:0 lds
    v_mfma_f32_16x16x32_bf16 v[196:199], a[228:231], a[216:219], v[196:199]
    ds_read_b64_tr_b16 v[50:51], v8 offset:8192
    v_mfma_f32_16x16x32_bf16 v[196:199], a[244:247], v[92:95], v[196:199]
    buffer_load_dword v20, off, s[52:55], 0 offset:0 sc1
    v_mfma_f32_16x16x32_bf16 v[200:203], a[248:251], v[92:95], v[200:203]
    ds_read_b128 v[84:87], v4 offset:37120
    v_mfma_f32_16x16x32_bf16 v[200:203], a[232:235], a[216:219], v[200:203]
    ds_read_b64_tr_b16 a[4:5], v25 offset:8
    v_mfma_f32_16x16x32_bf16 v[204:207], a[236:239], a[216:219], v[204:207]
    ds_read_b64_tr_b16 v[52:53], v9 offset:0
    v_mfma_f32_16x16x32_bf16 v[204:207], a[252:255], v[92:95], v[204:207]
    s_waitcnt lgkmcnt(6)
    ds_read_b128 v[88:91], v5 offset:37120
    v_mfma_f32_16x16x32_bf16 v[220:223], a[252:255], a[220:223], v[220:223]
    ds_read_b64_tr_b16 a[6:7], v25 offset:2568
    v_mfma_f32_16x16x32_bf16 v[220:223], a[236:239], v[80:83], v[220:223]
    ds_read_b64_tr_b16 a[8:9], v25 offset:16
    buffer_load_dwordx4 v11, s[24:27], s64 offen offset:1024 lds
    v_mfma_f32_16x16x32_bf16 v[216:219], a[232:235], v[80:83], v[216:219]
    s_add_u32 m0, s62, 100352
    ds_read_b64_tr_b16 v[54:55], v9 offset:8192
    v_mfma_f32_16x16x32_bf16 v[216:219], a[248:251], a[220:223], v[216:219]
    ds_read_b64_tr_b16 a[10:11], v25 offset:2576
    v_mfma_f32_16x16x32_bf16 v[212:215], a[244:247], a[220:223], v[212:215]
    ds_read_b128 v[92:95], v6 offset:39168
    v_mfma_f32_16x16x32_bf16 v[212:215], a[228:231], v[80:83], v[212:215]
    ds_read_b64_tr_b16 a[12:13], v25 offset:24
    v_mfma_f32_16x16x32_bf16 v[208:211], a[224:227], v[80:83], v[208:211]
    ds_read_b64_tr_b16 v[56:57], v8 offset:2048
    v_mfma_f32_16x16x32_bf16 v[208:211], a[240:243], a[220:223], v[208:211]
    s_waitcnt lgkmcnt(7)
    ds_read_b128 a[216:219], v7 offset:39168
    v_mfma_f32_16x16x32_bf16 v[224:227], a[240:243], v[84:87], v[224:227]
    ds_read_b64_tr_b16 a[14:15], v25 offset:2584
    v_mfma_f32_16x16x32_bf16 v[224:227], a[224:227], v[88:91], v[224:227]
    ds_read_b64_tr_b16 a[16:17], v0 offset:128
    buffer_load_dwordx4 v12, s[24:27], s64 offen offset:0 lds
    v_mfma_f32_16x16x32_bf16 v[228:231], a[228:231], v[88:91], v[228:231]
    ds_read_b64_tr_b16 v[58:59], v8 offset:10240
    v_mfma_f32_16x16x32_bf16 v[228:231], a[244:247], v[84:87], v[228:231]
    ds_read_b64_tr_b16 a[18:19], v0 offset:2688
    v_mfma_f32_16x16x32_bf16 v[232:235], a[248:251], v[84:87], v[232:235]
    ds_read_b128 a[220:223], v5 offset:20736
    v_mfma_f32_16x16x32_bf16 v[232:235], a[232:235], v[88:91], v[232:235]
    buffer_load_dwordx4 v13, s[24:27], s64 offen offset:1024 lds
    v_mfma_f32_16x16x32_bf16 v[236:239], a[236:239], v[88:91], v[236:239]
    ds_read_b64_tr_b16 v[60:61], v9 offset:2048
    v_mfma_f32_16x16x32_bf16 v[236:239], a[252:255], v[84:87], v[236:239]
    s_waitcnt lgkmcnt(6)
    ds_read_b128 v[80:83], v4 offset:41472
    v_mfma_f32_16x16x32_bf16 v[252:255], a[252:255], v[92:95], v[252:255]
    v_mfma_f32_16x16x32_bf16 v[252:255], a[236:239], a[216:219], v[252:255]
    buffer_load_dwordx4 v14, s[24:27], s64 offen offset:2048 lds
    s_bfe_u32 s65, s77, 0x4000c
    v_mfma_f32_16x16x32_bf16 v[248:251], a[232:235], a[216:219], v[248:251]
    s_lshl1_add_u32 s65, s65, s76
    ds_read_b64_tr_b16 v[62:63], v9 offset:10240
    s_mul_i32 s65, s65, 98304
    v_mfma_f32_16x16x32_bf16 v[248:251], a[248:251], v[92:95], v[248:251]
    s_waitcnt lgkmcnt(4)
    buffer_store_dwordx4 a[0:3], v2, s[40:43], s13 offen offset:0 sc1
    s_add_u32 m0, s63, 32768
    v_mfma_f32_16x16x32_bf16 v[244:247], a[244:247], v[92:95], v[244:247]
    ds_read_b128 v[84:87], v5 offset:22784
    v_mfma_f32_16x16x32_bf16 v[244:247], a[228:231], a[216:219], v[244:247]
    v_mfma_f32_16x16x32_bf16 v[240:243], a[224:227], a[216:219], v[240:243]
    v_mfma_f32_16x16x32_bf16 v[240:243], a[240:243], v[92:95], v[240:243]
    s_waitcnt lgkmcnt(1)
    ds_read_b128 v[88:91], v4 offset:43520
    buffer_store_dwordx4 a[4:7], v2, s[40:43], s13 offen offset:1024 sc1
    v_mfma_f32_16x16x32_bf16 v[96:99], a[224:227], a[220:223], v[96:99]
    v_mfma_f32_16x16x32_bf16 v[96:99], v[48:51], v[80:83], v[96:99]
    v_mfma_f32_16x16x32_bf16 v[100:103], v[52:55], v[80:83], v[100:103]
    v_mfma_f32_16x16x32_bf16 v[100:103], a[228:231], a[220:223], v[100:103]
    buffer_store_dwordx4 a[8:11], v2, s[40:43], s13 offen offset:2048 sc1
    v_mfma_f32_16x16x32_bf16 v[104:107], a[232:235], a[220:223], v[104:107]
    ds_read_b128 v[92:95], v5 offset:24832
    v_mfma_f32_16x16x32_bf16 v[104:107], v[56:59], v[80:83], v[104:107]
    v_mfma_f32_16x16x32_bf16 v[108:111], v[60:63], v[80:83], v[108:111]
    v_mfma_f32_16x16x32_bf16 v[108:111], a[236:239], a[220:223], v[108:111]
    s_waitcnt lgkmcnt(1)
    ds_read_b128 a[216:219], v4 offset:45568
    buffer_store_dwordx4 a[12:15], v2, s[40:43], s13 offen offset:3072 sc1
    v_mfma_f32_16x16x32_bf16 v[124:127], a[236:239], v[84:87], v[124:127]
    s_add_u32 s13, s13, 4096
    v_mfma_f32_16x16x32_bf16 v[124:127], v[60:63], v[88:91], v[124:127]
    v_mfma_f32_16x16x32_bf16 v[120:123], v[56:59], v[88:91], v[120:123]
    v_mfma_f32_16x16x32_bf16 v[120:123], a[232:235], v[84:87], v[120:123]
    buffer_store_dwordx4 a[16:19], v2, s[40:43], s13 offen offset:0 sc1
    v_mfma_f32_16x16x32_bf16 v[116:119], a[228:231], v[84:87], v[116:119]
    ds_read_b128 a[220:223], v5 offset:26880
    v_mfma_f32_16x16x32_bf16 v[116:119], v[52:55], v[88:91], v[116:119]
    v_mfma_f32_16x16x32_bf16 v[112:115], v[48:51], v[88:91], v[112:115]
    v_mfma_f32_16x16x32_bf16 v[112:115], a[224:227], v[84:87], v[112:115]
    s_waitcnt lgkmcnt(1)
    ds_read_b128 v[80:83], v4 offset:47616
    v_mfma_f32_16x16x32_bf16 v[128:131], a[224:227], v[92:95], v[128:131]
    v_mfma_f32_16x16x32_bf16 v[128:131], v[48:51], a[216:219], v[128:131]
    s_waitcnt vmcnt(9)
F_PG1:
    s_cbranch_execz F_PG5
    buffer_load_dwordx4 v17, s[28:31], s65 offen offset:0 lds
    v_mfma_f32_16x16x32_bf16 v[132:135], v[52:55], a[216:219], v[132:135]
    v_cmp_gt_u32 vcc, 4, v20
    s_cbranch_vccnz F_SPIN_D
F_BACK_D:
    v_mfma_f32_16x16x32_bf16 v[132:135], a[228:231], v[92:95], v[132:135]
    s_lshl_b32 s70, s69, 7
    s_add_u32 s70, s70, 3245056
    v_mfma_f32_16x16x32_bf16 v[136:139], a[232:235], v[92:95], v[136:139]
    s_lshl_b32 s72, s56, 28
    ds_read_b128 v[84:87], v5 offset:28928
    s_add_u32 s70, s70, s72
    v_mfma_f32_16x16x32_bf16 v[136:139], v[56:59], a[216:219], v[136:139]
    buffer_load_dwordx4 v18, s[28:31], s65 offen offset:1024 lds
    v_mfma_f32_16x16x32_bf16 v[140:143], v[60:63], a[216:219], v[140:143]
    v_mov_b32 v20, 1
    v_mfma_f32_16x16x32_bf16 v[140:143], a[236:239], v[92:95], v[140:143]
    s_waitcnt lgkmcnt(1)
    ds_read_b128 v[88:91], v4 offset:49664
    v_mfma_f32_16x16x32_bf16 v[156:159], a[236:239], a[220:223], v[156:159]
    v_mfma_f32_16x16x32_bf16 v[156:159], v[60:63], v[80:83], v[156:159]
    buffer_load_dwordx4 v17, s[32:35], s65 offen offset:2048 lds
    v_mfma_f32_16x16x32_bf16 v[152:155], v[56:59], v[80:83], v[152:155]
    v_mfma_f32_16x16x32_bf16 v[152:155], a[232:235], a[220:223], v[152:155]
    s_barrier
    v_mfma_f32_16x16x32_bf16 v[148:151], a[228:231], a[220:223], v[148:151]
    ds_read_b128 v[92:95], v4 offset:51712
    v_mfma_f32_16x16x32_bf16 v[148:151], v[52:55], v[80:83], v[148:151]
    ds_read_b64_tr_b16 v[64:65], v8 offset:16384
    buffer_load_dwordx4 v18, s[32:35], s65 offen offset:3072 lds
    v_mfma_f32_16x16x32_bf16 v[144:147], v[48:51], v[80:83], v[144:147]
    s_add_u32 s65, s65, s101
    ds_read_b64_tr_b16 v[66:67], v8 offset:24576
    s_add_u32 m0, s63, 49152
    v_mfma_f32_16x16x32_bf16 v[144:147], a[224:227], a[220:223], v[144:147]
    s_waitcnt lgkmcnt(3)
    ds_read_b128 a[216:219], v5 offset:51712
    v_mfma_f32_16x16x32_bf16 v[160:163], a[224:227], v[84:87], v[160:163]
    ds_read_b64_tr_b16 v[68:69], v9 offset:16384
    v_mfma_f32_16x16x32_bf16 v[160:163], v[48:51], v[88:91], v[160:163]
    ds_read_b64_tr_b16 v[70:71], v9 offset:24576
    buffer_load_dwordx4 v17, s[28:31], s65 offen offset:0 lds
    v_mfma_f32_16x16x32_bf16 v[164:167], v[52:55], v[88:91], v[164:167]
    ds_read_b64_tr_b16 v[72:73], v8 offset:18432
    v_mfma_f32_16x16x32_bf16 v[164:167], a[228:231], v[84:87], v[164:167]
    ds_read_b64_tr_b16 v[74:75], v8 offset:26624
    v_mfma_f32_16x16x32_bf16 v[168:171], a[232:235], v[84:87], v[168:171]
    ds_read_b128 a[220:223], v4 offset:53760
    v_mfma_f32_16x16x32_bf16 v[168:171], v[56:59], v[88:91], v[168:171]
    ds_read_b64_tr_b16 v[76:77], v9 offset:18432
    buffer_load_dwordx4 v18, s[28:31], s65 offen offset:1024 lds
    v_mfma_f32_16x16x32_bf16 v[172:175], v[60:63], v[88:91], v[172:175]
    ds_read_b64_tr_b16 v[78:79], v9 offset:26624
    v_mfma_f32_16x16x32_bf16 v[172:175], a[236:239], v[84:87], v[172:175]
    s_waitcnt lgkmcnt(0)
    ds_read_b128 v[80:83], v5 offset:53760
    v_mfma_f32_16x16x32_bf16 v[188:191], v[60:63], v[92:95], v[188:191]
    v_mfma_f32_16x16x32_bf16 v[188:191], v[76:79], a[216:219], v[188:191]
    s_barrier
    buffer_load_dwordx4 v17, s[32:35], s65 offen offset:2048 lds
    v_mfma_f32_16x16x32_bf16 v[184:187], v[72:75], a[216:219], v[184:187]
    v_mfma_f32_16x16x32_bf16 v[184:187], v[56:59], v[92:95], v[184:187]
    v_mfma_f32_16x16x32_bf16 v[180:183], v[52:55], v[92:95], v[180:183]
    ds_read_b128 v[84:87], v4 offset:55808
    v_mfma_f32_16x16x32_bf16 v[180:183], v[68:71], a[216:219], v[180:183]
    buffer_load_dwordx4 v18, s[32:35], s65 offen offset:3072 lds
    v_mfma_f32_16x16x32_bf16 v[176:179], v[64:67], a[216:219], v[176:179]
    v_mfma_f32_16x16x32_bf16 v[176:179], v[48:51], v[92:95], v[176:179]
    s_waitcnt lgkmcnt(1)
    ds_read_b128 v[88:91], v5 offset:55808
    v_mfma_f32_16x16x32_bf16 v[192:195], v[48:51], a[220:223], v[192:195]
    v_mfma_f32_16x16x32_bf16 v[192:195], v[64:67], v[80:83], v[192:195]
    buffer_load_dwordx4 v[28:31], v26, s[24:27], 0 offen offset:0
    v_mfma_f32_16x16x32_bf16 v[196:199], v[68:71], v[80:83], v[196:199]
    v_mfma_f32_16x16x32_bf16 v[196:199], v[52:55], a[220:223], v[196:199]
    v_mfma_f32_16x16x32_bf16 v[200:203], v[56:59], a[220:223], v[200:203]
    ds_read_b128 v[92:95], v4 offset:57856
    v_mfma_f32_16x16x32_bf16 v[200:203], v[72:75], v[80:83], v[200:203]
    buffer_load_dwordx4 v[32:35], v26, s[24:27], 0 offen offset:256
    v_mfma_f32_16x16x32_bf16 v[204:207], v[76:79], v[80:83], v[204:207]
    v_mfma_f32_16x16x32_bf16 v[204:207], v[60:63], a[220:223], v[204:207]
    s_waitcnt lgkmcnt(1)
    ds_read_b128 a[216:219], v5 offset:57856
    v_mfma_f32_16x16x32_bf16 v[220:223], v[60:63], v[84:87], v[220:223]
    v_mfma_f32_16x16x32_bf16 v[220:223], v[76:79], v[88:91], v[220:223]
    buffer_load_dwordx4 v[36:39], v26, s[24:27], 0 offen offset:512
    v_mfma_f32_16x16x32_bf16 v[216:219], v[72:75], v[88:91], v[216:219]
    v_mfma_f32_16x16x32_bf16 v[216:219], v[56:59], v[84:87], v[216:219]
    v_mfma_f32_16x16x32_bf16 v[212:215], v[52:55], v[84:87], v[212:215]
    ds_read_b128 a[220:223], v6 offset:59904
    v_mfma_f32_16x16x32_bf16 v[212:215], v[68:71], v[88:91], v[212:215]
    s_waitcnt vmcnt(7)
    s_barrier
    buffer_load_dwordx4 v[40:43], v26, s[24:27], 0 offen offset:768
    v_mfma_f32_16x16x32_bf16 v[208:211], v[64:67], v[88:91], v[208:211]
    ds_read_b64_tr_b16 a[240:241], v8 offset:32768
    buffer_store_dword v20, v3, s[40:43], s70 offen sc1
    v_mfma_f32_16x16x32_bf16 v[208:211], v[48:51], v[84:87], v[208:211]
    s_waitcnt lgkmcnt(2)
    ds_read_b128 v[80:83], v7 offset:59904
    s_add_u32 s70, s70, 20480
    v_mfma_f32_16x16x32_bf16 v[224:227], v[48:51], v[92:95], v[224:227]
    s_xor_b32 s14, s82, 0
    ds_read_b64_tr_b16 a[242:243], v8 offset:40960
    v_min_u32 v21, 16, v1
    v_mfma_f32_16x16x32_bf16 v[224:227], v[64:67], a[216:219], v[224:227]
    s_mul_i32 s71, s56, -7
    ds_read_b64_tr_b16 a[244:245], v9 offset:32768
    s_add_u32 s71, s71, 36
    v_mfma_f32_16x16x32_bf16 v[228:231], v[68:71], a[216:219], v[228:231]
    s_mul_i32 s14, s14, 1536
    v_add_u32 v22, 4, v21
    v_lshrrev_b32 v22, 4, v22
    v_mfma_f32_16x16x32_bf16 v[228:231], v[52:55], v[92:95], v[228:231]
    s_xor_b32 s15, s82, 1
    ds_read_b64_tr_b16 a[246:247], v9 offset:40960
    v_mad_u32_u24 v21, v22, s71, v21
    v_mfma_f32_16x16x32_bf16 v[232:235], v[56:59], v[92:95], v[232:235]
    s_mul_i32 s71, s56, 24
    ds_read_b128 v[84:87], v5 offset:41472
    s_lshr_b32 s72, s61, 2
    v_mfma_f32_16x16x32_bf16 v[232:235], v[72:75], a[216:219], v[232:235]
    s_add_u32 s71, s71, s72
    ds_read_b64_tr_b16 a[248:249], v8 offset:34816
    buffer_load_dwordx4 v[44:47], v26, s[24:27], 0 offen offset:1024
    v_mfma_f32_16x16x32_bf16 v[236:239], v[76:79], a[216:219], v[236:239]
    s_lshl_b32 s71, s71, 7
    ds_read_b64_tr_b16 a[250:251], v8 offset:43008
    s_add_u32 s71, s71, 3245056
    v_mfma_f32_16x16x32_bf16 v[236:239], v[60:63], v[92:95], v[236:239]
    s_waitcnt lgkmcnt(6)
    ds_read_b128 v[88:91], v4 offset:0
    v_lshl_add_u32 v21, v21, 8, s71
    v_mfma_f32_16x16x32_bf16 v[252:255], v[60:63], a[220:223], v[252:255]
    s_bfe_u32 s64, s77, 0x40010
    ds_read_b64_tr_b16 a[252:253], v9 offset:34816
    s_lshl_b32 s64, s64, 7
    v_mfma_f32_16x16x32_bf16 v[252:255], v[76:79], v[80:83], v[252:255]
    s_add_u32 m0, s62, 119040
    s_mul_i32 s15, s15, 1536
    v_mfma_f32_16x16x32_bf16 v[248:251], v[72:75], v[80:83], v[248:251]
    s_xor_b32 s16, s82, 2
    ds_read_b64_tr_b16 a[254:255], v9 offset:43008
    buffer_load_dwordx4 v10, s[24:27], s64 offen offset:0 lds
    v_mfma_f32_16x16x32_bf16 v[248:251], v[56:59], a[220:223], v[248:251]
    s_mul_i32 s16, s16, 1536
    s_xor_b32 s17, s82, 3
    v_mfma_f32_16x16x32_bf16 v[244:247], v[52:55], a[220:223], v[244:247]
    s_mul_i32 s17, s17, 1536
    ds_read_b128 v[92:95], v5 offset:43520
    s_and_b32 s3, s61, 0
    v_mfma_f32_16x16x32_bf16 v[244:247], v[68:71], v[80:83], v[244:247]
    s_add_u32 s3, s3, s56
    buffer_load_dwordx4 v11, s[24:27], s64 offen offset:1024 lds
    s_add_u32 m0, s62, 121088
    v_mfma_f32_16x16x32_bf16 v[240:243], v[64:67], v[80:83], v[240:243]
    s_mul_i32 s73, s60, 278528
    s_mul_i32 s74, s56, 6144
    v_mfma_f32_16x16x32_bf16 v[240:243], v[48:51], a[220:223], v[240:243]
    s_waitcnt lgkmcnt(1)
    ds_read_b128 a[216:219], v4 offset:2048
    buffer_load_dwordx4 v12, s[24:27], s64 offen offset:0 lds
    v_mfma_f32_16x16x32_bf16 v[96:99], v[64:67], v[84:87], v[96:99]
    s_add_u32 s73, s73, s74
    s_mul_i32 s74, s56, -3584
    v_mfma_f32_16x16x32_bf16 v[96:99], a[240:243], v[88:91], v[96:99]
    s_add_u32 s74, s74, 24576
    s_sub_u32 s74, s74, s14
    v_mfma_f32_16x16x32_bf16 v[100:103], a[244:247], v[88:91], v[100:103]
    s_add_u32 s75, s3, 1
    s_and_b32 s75, s75, 3
    v_mfma_f32_16x16x32_bf16 v[100:103], v[68:71], v[84:87], v[100:103]
    s_mul_i32 s75, s75, 69632
    s_add_u32 s4, s75, s73
    v_mfma_f32_16x16x32_bf16 v[104:107], v[72:75], v[84:87], v[104:107]
    s_add_u32 s8, s4, s74
    ds_read_b128 a[220:223], v5 offset:45568
    s_add_u32 s75, s3, 2
    v_mfma_f32_16x16x32_bf16 v[104:107], a[248:251], v[88:91], v[104:107]
    s_and_b32 s75, s75, 3
    s_mul_i32 s75, s75, 69632
    v_mfma_f32_16x16x32_bf16 v[108:111], a[252:255], v[88:91], v[108:111]
    s_add_u32 s5, s75, s73
    s_add_u32 s9, s5, s74
    v_mfma_f32_16x16x32_bf16 v[108:111], v[76:79], v[84:87], v[108:111]
    s_waitcnt lgkmcnt(1)
    ds_read_b128 v[80:83], v4 offset:4096
    s_add_u32 s75, s3, 3
    v_mfma_f32_16x16x32_bf16 v[124:127], v[76:79], v[92:95], v[124:127]
    s_and_b32 s75, s75, 3
    s_mul_i32 s75, s75, 69632
    v_mfma_f32_16x16x32_bf16 v[124:127], a[252:255], a[216:219], v[124:127]
    s_add_u32 s6, s75, s73
    s_add_u32 s10, s6, s74
    v_mfma_f32_16x16x32_bf16 v[120:123], a[248:251], a[216:219], v[120:123]
    s_add_u32 s75, s3, 4
    s_and_b32 s75, s75, 3
    v_mfma_f32_16x16x32_bf16 v[120:123], v[72:75], v[92:95], v[120:123]
    s_mul_i32 s75, s75, 69632
    buffer_load_dwordx4 v13, s[24:27], s64 offen offset:1024 lds
    s_add_u32 s7, s75, s73
    v_mfma_f32_16x16x32_bf16 v[116:119], v[68:71], v[92:95], v[116:119]
    s_add_u32 s11, s7, s74
    ds_read_b128 v[84:87], v5 offset:47616
    s_mul_i32 s23, s56, 384
    v_mfma_f32_16x16x32_bf16 v[116:119], a[244:247], a[216:219], v[116:119]
    s_add_u32 s23, s23, 3212288
    s_mul_i32 s69, s57, 12
    v_mfma_f32_16x16x32_bf16 v[112:115], a[240:243], a[216:219], v[112:115]
    s_add_u32 s69, s69, s58
    s_lshl_b32 s69, s69, 7
    v_mfma_f32_16x16x32_bf16 v[112:115], v[64:67], v[92:95], v[112:115]
    s_waitcnt lgkmcnt(1)
    ds_read_b128 v[88:91], v4 offset:6144
    buffer_load_dwordx4 v14, s[24:27], s64 offen offset:2048 lds
    v_mfma_f32_16x16x32_bf16 v[128:131], v[64:67], a[220:223], v[128:131]
    s_bfe_u32 s65, s77, 0x40010
    s_lshl1_add_u32 s65, s65, s76
    v_mfma_f32_16x16x32_bf16 v[128:131], a[240:243], v[80:83], v[128:131]
    s_mul_i32 s65, s65, 98304
    s_add_u32 m0, s63, 0
    v_mfma_f32_16x16x32_bf16 v[132:135], a[244:247], v[80:83], v[132:135]
    s_lshl_b32 s75, s56, 28
    s_add_u32 s69, s69, s75
    v_mfma_f32_16x16x32_bf16 v[132:135], v[68:71], a[220:223], v[132:135]
    s_waitcnt vmcnt(10)
    buffer_load_dwordx4 v17, s[28:31], s65 offen offset:0 lds
    s_add_u32 s69, s69, 3212288
    v_mfma_f32_16x16x32_bf16 v[136:139], v[72:75], a[220:223], v[136:139]
    ds_read_b128 v[92:95], v5 offset:49664
    v_lshlrev_b32 v19, 16, v28
    v_mfma_f32_16x16x32_bf16 v[136:139], a[248:251], v[80:83], v[136:139]
    s_barrier
    v_and_b32 v28, 0xffff0000, v28
    v_mfma_f32_16x16x32_bf16 v[140:143], a[252:255], v[80:83], v[140:143]
    ds_read_b64_tr_b16 a[224:225], v8 offset:49152
    v_mul_f32 v26, v19, v19
    v_mfma_f32_16x16x32_bf16 v[140:143], v[76:79], a[220:223], v[140:143]
    s_waitcnt lgkmcnt(2)
    ds_read_b128 a[216:219], v4 offset:8192
    buffer_load_dwordx4 v18, s[28:31], s65 offen offset:1024 lds
    v_mfma_f32_16x16x32_bf16 v[156:159], v[76:79], v[84:87], v[156:159]
    ds_read_b64_tr_b16 a[226:227], v8 offset:57344
    v_add_f32 v19, v19, v28
    v_mfma_f32_16x16x32_bf16 v[156:159], a[252:255], v[88:91], v[156:159]
    ds_read_b64_tr_b16 a[228:229], v9 offset:49152
    v_fmac_f32 v26, v28, v28
    v_mfma_f32_16x16x32_bf16 v[152:155], a[248:251], v[88:91], v[152:155]
    v_lshlrev_b32 v28, 16, v29
    v_and_b32 v29, 0xffff0000, v29
    v_mfma_f32_16x16x32_bf16 v[152:155], v[72:75], v[84:87], v[152:155]
    ds_read_b64_tr_b16 a[230:231], v9 offset:57344
    buffer_load_dwordx4 v17, s[32:35], s65 offen offset:2048 lds
    v_mfma_f32_16x16x32_bf16 v[148:151], v[68:71], v[84:87], v[148:151]
    ds_read_b128 a[220:223], v4 offset:10240
    v_add_f32 v19, v19, v28
    v_mfma_f32_16x16x32_bf16 v[148:151], a[244:247], v[88:91], v[148:151]
    ds_read_b64_tr_b16 a[232:233], v8 offset:51200
    v_fmac_f32 v26, v28, v28
    v_mfma_f32_16x16x32_bf16 v[144:147], a[240:243], v[88:91], v[144:147]
    ds_read_b64_tr_b16 a[234:235], v8 offset:59392
    v_add_f32 v19, v19, v29
    v_mfma_f32_16x16x32_bf16 v[144:147], v[64:67], v[84:87], v[144:147]
    s_waitcnt lgkmcnt(6)
    ds_read_b128 v[80:83], v5 offset:10240
    buffer_load_dwordx4 v18, s[32:35], s65 offen offset:3072 lds
    v_mfma_f32_16x16x32_bf16 v[160:163], v[64:67], v[92:95], v[160:163]
    s_add_u32 s65, s65, s101
    ds_read_b64_tr_b16 a[236:237], v9 offset:51200
    v_fmac_f32 v26, v29, v29
    v_mfma_f32_16x16x32_bf16 v[160:163], a[240:243], a[216:219], v[160:163]
    s_add_u32 m0, s63, 65536
    v_lshlrev_b32 v28, 16, v30
    v_and_b32 v30, 0xffff0000, v30
    v_mfma_f32_16x16x32_bf16 v[164:167], a[244:247], a[216:219], v[164:167]
    ds_read_b64_tr_b16 a[238:239], v9 offset:59392
    v_add_f32 v19, v19, v28
    v_mfma_f32_16x16x32_bf16 v[164:167], v[68:71], v[92:95], v[164:167]
    buffer_load_dwordx4 v17, s[28:31], s65 offen offset:0 lds
    v_mfma_f32_16x16x32_bf16 v[168:171], v[72:75], v[92:95], v[168:171]
    ds_read_b128 v[84:87], v4 offset:12288
    v_fmac_f32 v26, v28, v28
    v_mfma_f32_16x16x32_bf16 v[168:171], a[248:251], a[216:219], v[168:171]
    v_add_f32 v19, v19, v30
    v_fmac_f32 v26, v30, v30
    v_mfma_f32_16x16x32_bf16 v[172:175], a[252:255], a[216:219], v[172:175]
    v_lshlrev_b32 v28, 16, v31
    v_and_b32 v31, 0xffff0000, v31
    v_mfma_f32_16x16x32_bf16 v[172:175], v[76:79], v[92:95], v[172:175]
    s_waitcnt lgkmcnt(1)
    ds_read_b128 v[88:91], v5 offset:12288
    buffer_load_dwordx4 v18, s[28:31], s65 offen offset:1024 lds
    v_mfma_f32_16x16x32_bf16 v[188:191], a[252:255], a[220:223], v[188:191]
    v_add_f32 v19, v19, v28
    v_fmac_f32 v26, v28, v28
    v_mfma_f32_16x16x32_bf16 v[188:191], a[236:239], v[80:83], v[188:191]
    s_barrier
    v_add_f32 v19, v19, v31
    v_fmac_f32 v26, v31, v31
    v_mfma_f32_16x16x32_bf16 v[184:187], a[232:235], v[80:83], v[184:187]
    s_waitcnt vmcnt(15)
    v_lshlrev_b32 v28, 16, v32
    v_and_b32 v32, 0xffff0000, v32
    v_mfma_f32_16x16x32_bf16 v[184:187], a[248:251], a[220:223], v[184:187]
    buffer_load_dwordx4 v17, s[32:35], s65 offen offset:2048 lds
    v_mfma_f32_16x16x32_bf16 v[180:183], a[244:247], a[220:223], v[180:183]
    ds_read_b128 v[92:95], v4 offset:14336
    v_add_f32 v19, v19, v28
    v_mfma_f32_16x16x32_bf16 v[180:183], a[228:231], v[80:83], v[180:183]
    v_fmac_f32 v26, v28, v28
    v_add_f32 v19, v19, v32
    v_mfma_f32_16x16x32_bf16 v[176:179], a[224:227], v[80:83], v[176:179]
    v_fmac_f32 v26, v32, v32
    v_lshlrev_b32 v28, 16, v33
    v_mfma_f32_16x16x32_bf16 v[176:179], a[240:243], a[220:223], v[176:179]
    s_waitcnt lgkmcnt(1)
    ds_read_b128 a[216:219], v5 offset:14336
    buffer_load_dwordx4 v18, s[32:35], s65 offen offset:3072 lds
    v_mfma_f32_16x16x32_bf16 v[192:195], a[240:243], v[84:87], v[192:195]
    s_bfe_u32 s64, s77, 0x40014
    v_and_b32 v33, 0xffff0000, v33
    v_add_f32 v19, v19, v28
    v_mfma_f32_16x16x32_bf16 v[192:195], a[224:227], v[88:91], v[192:195]
    s_lshl_b32 s64, s64, 7
    v_fmac_f32 v26, v28, v28
    v_add_f32 v19, v19, v33
    v_mfma_f32_16x16x32_bf16 v[196:199], a[228:231], v[88:91], v[196:199]
    s_add_u32 m0, s62, 139776
    v_fmac_f32 v26, v33, v33
    v_lshlrev_b32 v28, 16, v34
    v_mfma_f32_16x16x32_bf16 v[196:199], a[244:247], v[84:87], v[196:199]
    buffer_load_dwordx4 v10, s[24:27], s64 offen offset:0 lds
    v_mfma_f32_16x16x32_bf16 v[200:203], a[248:251], v[84:87], v[200:203]
    ds_read_b128 a[220:223], v4 offset:16384
    v_and_b32 v34, 0xffff0000, v34
    v_mfma_f32_16x16x32_bf16 v[200:203], a[232:235], v[88:91], v[200:203]
    v_add_f32 v19, v19, v28
    v_fmac_f32 v26, v28, v28
    v_mfma_f32_16x16x32_bf16 v[204:207], a[236:239], v[88:91], v[204:207]
    v_add_f32 v19, v19, v34
    v_fmac_f32 v26, v34, v34
    v_mfma_f32_16x16x32_bf16 v[204:207], a[252:255], v[84:87], v[204:207]
    s_waitcnt lgkmcnt(1)
    ds_read_b128 v[80:83], v5 offset:16384
    buffer_load_dwordx4 v11, s[24:27], s64 offen offset:1024 lds
    v_mfma_f32_16x16x32_bf16 v[220:223], a[252:255], v[92:95], v[220:223]
    s_add_u32 m0, s62, 141824
    v_lshlrev_b32 v28, 16, v35
    v_and_b32 v35, 0xffff0000, v35
    v_mfma_f32_16x16x32_bf16 v[220:223], a[236:239], a[216:219], v[220:223]
    v_add_f32 v19, v19, v28
    v_fmac_f32 v26, v28, v28
    v_mfma_f32_16x16x32_bf16 v[216:219], a[232:235], a[216:219], v[216:219]
    v_add_f32 v19, v19, v35
    v_fmac_f32 v26, v35, v35
    v_mfma_f32_16x16x32_bf16 v[216:219], a[248:251], v[92:95], v[216:219]
    s_waitcnt vmcnt(18)
    buffer_load_dwordx4 v12, s[24:27], s64 offen offset:0 lds
    v_mfma_f32_16x16x32_bf16 v[212:215], a[244:247], v[92:95], v[212:215]
    ds_read_b128 v[84:87], v6 offset:18432
    v_lshlrev_b32 v28, 16, v36
    v_mfma_f32_16x16x32_bf16 v[212:215], a[228:231], a[216:219], v[212:215]
    s_waitcnt vmcnt(7)
    s_barrier
    v_and_b32 v36, 0xffff0000, v36
    v_mfma_f32_16x16x32_bf16 v[208:211], a[224:227], a[216:219], v[208:211]
    ds_read_b64_tr_b16 v[48:49], v8 offset:0
    v_add_f32 v19, v19, v28
    v_mfma_f32_16x16x32_bf16 v[208:211], a[240:243], v[92:95], v[208:211]
    s_waitcnt lgkmcnt(2)
    ds_read_b128 v[88:91], v7 offset:18432
    buffer_load_dwordx4 v13, s[24:27], s64 offen offset:1024 lds
    v_mfma_f32_16x16x32_bf16 v[224:227], a[240:243], a[220:223], v[224:227]
    ds_read_b64_tr_b16 v[50:51], v8 offset:8192
    v_fmac_f32 v26, v28, v28
    v_mfma_f32_16x16x32_bf16 v[224:227], a[224:227], v[80:83], v[224:227]
    ds_read_b64_tr_b16 v[52:53], v9 offset:0
    v_add_f32 v19, v19, v36
    v_mfma_f32_16x16x32_bf16 v[228:231], a[228:231], v[80:83], v[228:231]
    v_fmac_f32 v26, v36, v36
    v_lshlrev_b32 v28, 16, v37
    v_mfma_f32_16x16x32_bf16 v[228:231], a[244:247], a[220:223], v[228:231]
    ds_read_b64_tr_b16 v[54:55], v9 offset:8192
    buffer_load_dwordx4 v14, s[24:27], s64 offen offset:2048 lds
    v_mfma_f32_16x16x32_bf16 v[232:235], a[248:251], a[220:223], v[232:235]
    s_bfe_u32 s65, s77, 0x40014
    ds_read_b128 v[92:95], v5 offset:0
    s_lshl1_add_u32 s65, s65, s76
    v_mfma_f32_16x16x32_bf16 v[232:235], a[232:235], v[80:83], v[232:235]
    s_mul_i32 s65, s65, 98304
    ds_read_b64_tr_b16 v[56:57], v8 offset:2048
    v_mfma_f32_16x16x32_bf16 v[236:239], a[236:239], v[80:83], v[236:239]
    s_add_u32 m0, s63, 81920
    ds_read_b64_tr_b16 v[58:59], v8 offset:10240
    v_mfma_f32_16x16x32_bf16 v[236:239], a[252:255], a[220:223], v[236:239]
    s_waitcnt lgkmcnt(6)
    ds_read_b128 a[216:219], v4 offset:20736
    buffer_load_dwordx4 v17, s[28:31], s65 offen offset:0 lds
    v_mfma_f32_16x16x32_bf16 v[252:255], a[252:255], v[84:87], v[252:255]
    ds_read_b64_tr_b16 v[60:61], v9 offset:2048
    v_and_b32 v37, 0xffff0000, v37
    v_mfma_f32_16x16x32_bf16 v[252:255], a[236:239], v[88:91], v[252:255]
    v_add_f32 v19, v19, v28
    v_fmac_f32 v26, v28, v28
    v_mfma_f32_16x16x32_bf16 v[248:251], a[232:235], v[88:91], v[248:251]
    ds_read_b64_tr_b16 v[62:63], v9 offset:10240
    v_add_f32 v19, v19, v37
    v_mfma_f32_16x16x32_bf16 v[248:251], a[248:251], v[84:87], v[248:251]
    buffer_load_dwordx4 v18, s[28:31], s65 offen offset:1024 lds
    v_mfma_f32_16x16x32_bf16 v[244:247], a[244:247], v[84:87], v[244:247]
    ds_read_b128 a[220:223], v5 offset:2048
    v_fmac_f32 v26, v37, v37
    v_mfma_f32_16x16x32_bf16 v[244:247], a[228:231], v[88:91], v[244:247]
    v_lshlrev_b32 v28, 16, v38
    v_and_b32 v38, 0xffff0000, v38
    v_mfma_f32_16x16x32_bf16 v[240:243], a[224:227], v[88:91], v[240:243]
    v_add_f32 v19, v19, v28
    v_fmac_f32 v26, v28, v28
    v_mfma_f32_16x16x32_bf16 v[240:243], a[240:243], v[84:87], v[240:243]
    s_waitcnt lgkmcnt(1)
    ds_read_b128 v[80:83], v4 offset:22784
    buffer_load_dwordx4 v17, s[32:35], s65 offen offset:2048 lds
    v_mfma_f32_16x16x32_bf16 v[96:99], a[224:227], v[92:95], v[96:99]
    v_add_f32 v19, v19, v38
    v_fmac_f32 v26, v38, v38
    v_mfma_f32_16x16x32_bf16 v[96:99], v[48:51], a[216:219], v[96:99]
    v_lshlrev_b32 v28, 16, v39
    v_and_b32 v39, 0xffff0000, v39
    v_mfma_f32_16x16x32_bf16 v[100:103], v[52:55], a[216:219], v[100:103]
    v_add_f32 v19, v19, v28
    v_fmac_f32 v26, v28, v28
    v_mfma_f32_16x16x32_bf16 v[100:103], a[228:231], v[92:95], v[100:103]
    buffer_load_dwordx4 v18, s[32:35], s65 offen offset:3072 lds
    s_add_u32 s65, s65, s101
    v_mfma_f32_16x16x32_bf16 v[104:107], a[232:235], v[92:95], v[104:107]
    s_add_u32 m0, s63, 16384
    ds_read_b128 v[84:87], v5 offset:4096
    v_add_f32 v19, v19, v39
    v_mfma_f32_16x16x32_bf16 v[104:107], v[56:59], a[216:219], v[104:107]
    v_fmac_f32 v26, v39, v39
    v_mfma_f32_16x16x32_bf16 v[108:111], v[60:63], a[216:219], v[108:111]
    v_lshlrev_b32 v28, 16, v40
    v_and_b32 v40, 0xffff0000, v40
    v_mfma_f32_16x16x32_bf16 v[108:111], a[236:239], v[92:95], v[108:111]
    s_waitcnt lgkmcnt(1)
    ds_read_b128 v[88:91], v4 offset:24832
    buffer_load_dwordx4 v17, s[28:31], s65 offen offset:0 lds
    v_mfma_f32_16x16x32_bf16 v[124:127], a[236:239], a[220:223], v[124:127]
    v_add_f32 v19, v19, v28
    v_fmac_f32 v26, v28, v28
    v_mfma_f32_16x16x32_bf16 v[124:127], v[60:63], v[80:83], v[124:127]
    v_add_f32 v19, v19, v40
    v_fmac_f32 v26, v40, v40
    v_mfma_f32_16x16x32_bf16 v[120:123], v[56:59], v[80:83], v[120:123]
    v_lshlrev_b32 v28, 16, v41
    v_and_b32 v41, 0xffff0000, v41
    v_mfma_f32_16x16x32_bf16 v[120:123], a[232:235], a[220:223], v[120:123]
    buffer_load_dwordx4 v18, s[28:31], s65 offen offset:1024 lds
    v_mfma_f32_16x16x32_bf16 v[116:119], a[228:231], a[220:223], v[116:119]
    ds_read_b128 v[92:95], v5 offset:6144
    v_add_f32 v19, v19, v28
    v_mfma_f32_16x16x32_bf16 v[116:119], v[52:55], v[80:83], v[116:119]
    v_fmac_f32 v26, v28, v28
    v_add_f32 v19, v19, v41
    v_mfma_f32_16x16x32_bf16 v[112:115], v[48:51], v[80:83], v[112:115]
    v_fmac_f32 v26, v41, v41
    v_lshlrev_b32 v28, 16, v42
    v_mfma_f32_16x16x32_bf16 v[112:115], a[224:227], a[220:223], v[112:115]
    s_waitcnt lgkmcnt(1)
    ds_read_b128 a[216:219], v4 offset:26880
    buffer_load_dwordx4 v17, s[32:35], s65 offen offset:2048 lds
    v_mfma_f32_16x16x32_bf16 v[128:131], a[224:227], v[84:87], v[128:131]
    v_and_b32 v42, 0xffff0000, v42
    v_add_f32 v19, v19, v28
    v_mfma_f32_16x16x32_bf16 v[128:131], v[48:51], v[88:91], v[128:131]
    v_fmac_f32 v26, v28, v28
    v_add_f32 v19, v19, v42
    v_mfma_f32_16x16x32_bf16 v[132:135], v[52:55], v[88:91], v[132:135]
    v_fmac_f32 v26, v42, v42
    v_lshlrev_b32 v28, 16, v43
    v_mfma_f32_16x16x32_bf16 v[132:135], a[228:231], v[84:87], v[132:135]
    buffer_load_dwordx4 v18, s[32:35], s65 offen offset:3072 lds
    s_bfe_u32 s65, s77, 0x40018
    v_mfma_f32_16x16x32_bf16 v[136:139], a[232:235], v[84:87], v[136:139]
    s_lshl1_add_u32 s65, s65, s76
    ds_read_b128 a[220:223], v5 offset:8192
    v_and_b32 v43, 0xffff0000, v43
    v_mfma_f32_16x16x32_bf16 v[136:139], v[56:59], v[88:91], v[136:139]
    s_waitcnt vmcnt(13)
    s_barrier
    v_add_f32 v19, v19, v28
    v_mfma_f32_16x16x32_bf16 v[140:143], v[60:63], v[88:91], v[140:143]
    s_mul_i32 s65, s65, 98304
    ds_read_b64_tr_b16 v[64:65], v15 offset:0
    v_fmac_f32 v26, v28, v28
    v_mfma_f32_16x16x32_bf16 v[140:143], a[236:239], v[84:87], v[140:143]
    s_waitcnt lgkmcnt(2)
    ds_read_b128 v[80:83], v4 offset:28928
    v_add_f32 v19, v19, v43
    v_mfma_f32_16x16x32_bf16 v[156:159], a[236:239], v[92:95], v[156:159]
    s_add_u32 m0, s63, 32768
    ds_read_b64_tr_b16 v[66:67], v15 offset:8192
    v_fmac_f32 v26, v43, v43
    v_mfma_f32_16x16x32_bf16 v[156:159], v[60:63], a[216:219], v[156:159]
    ds_read_b64_tr_b16 v[68:69], v16 offset:0
    buffer_load_dwordx4 v17, s[28:31], s65 offen offset:0 lds
    v_mfma_f32_16x16x32_bf16 v[152:155], v[56:59], a[216:219], v[152:155]
    v_lshlrev_b32 v28, 16, v44
    v_and_b32 v44, 0xffff0000, v44
    v_mfma_f32_16x16x32_bf16 v[152:155], a[232:235], v[92:95], v[152:155]
    ds_read_b64_tr_b16 v[70:71], v16 offset:8192
    v_add_f32 v19, v19, v28
    v_mfma_f32_16x16x32_bf16 v[148:151], a[228:231], v[92:95], v[148:151]
    ds_read_b128 v[84:87], v4 offset:30976
    v_fmac_f32 v26, v28, v28
    v_mfma_f32_16x16x32_bf16 v[148:151], v[52:55], a[216:219], v[148:151]
    ds_read_b64_tr_b16 v[72:73], v15 offset:2048
    v_add_f32 v19, v19, v44
    v_mfma_f32_16x16x32_bf16 v[144:147], v[48:51], a[216:219], v[144:147]
    ds_read_b64_tr_b16 v[74:75], v15 offset:10240
    v_fmac_f32 v26, v44, v44
    v_mfma_f32_16x16x32_bf16 v[144:147], a[224:227], v[92:95], v[144:147]
    s_waitcnt lgkmcnt(6)
    ds_read_b128 v[88:91], v5 offset:30976
    buffer_load_dwordx4 v18, s[28:31], s65 offen offset:1024 lds
    v_mfma_f32_16x16x32_bf16 v[160:163], a[224:227], a[220:223], v[160:163]
    ds_read_b64_tr_b16 v[76:77], v16 offset:2048
    v_lshlrev_b32 v28, 16, v45
    v_mfma_f32_16x16x32_bf16 v[160:163], v[48:51], v[80:83], v[160:163]
    v_and_b32 v45, 0xffff0000, v45
    v_add_f32 v19, v19, v28
    v_mfma_f32_16x16x32_bf16 v[164:167], v[52:55], v[80:83], v[164:167]
    ds_read_b64_tr_b16 v[78:79], v16 offset:10240
    v_fmac_f32 v26, v28, v28
    v_mfma_f32_16x16x32_bf16 v[164:167], a[228:231], a[220:223], v[164:167]
    buffer_load_dwordx4 v17, s[32:35], s65 offen offset:2048 lds
    v_mfma_f32_16x16x32_bf16 v[168:171], a[232:235], a[220:223], v[168:171]
    ds_read_b128 v[92:95], v4 offset:33024
    v_add_f32 v19, v19, v45
    v_mfma_f32_16x16x32_bf16 v[168:171], v[56:59], v[80:83], v[168:171]
    v_fmac_f32 v26, v45, v45
    v_lshlrev_b32 v28, 16, v46
    v_mfma_f32_16x16x32_bf16 v[172:175], v[60:63], v[80:83], v[172:175]
    v_and_b32 v46, 0xffff0000, v46
    v_add_f32 v19, v19, v28
    v_mfma_f32_16x16x32_bf16 v[172:175], a[236:239], a[220:223], v[172:175]
    s_waitcnt lgkmcnt(1)
    ds_read_b128 a[216:219], v5 offset:33024
    buffer_load_dwordx4 v18, s[32:35], s65 offen offset:3072 lds
    v_mfma_f32_16x16x32_bf16 v[188:191], v[60:63], v[84:87], v[188:191]
    s_bfe_u32 s64, s77, 0x40018
    v_fmac_f32 v26, v28, v28
    v_add_f32 v19, v19, v46
    v_mfma_f32_16x16x32_bf16 v[188:191], v[76:79], v[88:91], v[188:191]
    s_barrier
    v_fmac_f32 v26, v46, v46
    v_lshlrev_b32 v28, 16, v47
    v_mfma_f32_16x16x32_bf16 v[184:187], v[72:75], v[88:91], v[184:187]
    s_lshl_b32 s64, s64, 7
    v_and_b32 v47, 0xffff0000, v47
    v_add_f32 v19, v19, v28
    v_mfma_f32_16x16x32_bf16 v[184:187], v[56:59], v[84:87], v[184:187]
    s_add_u32 m0, s62, 98304
    v_fmac_f32 v26, v28, v28
    v_add_f32 v19, v19, v47
    v_mfma_f32_16x16x32_bf16 v[180:183], v[52:55], v[84:87], v[180:183]
    ds_read_b128 a[220:223], v4 offset:35072
    buffer_load_dwordx4 v10, s[24:27], s64 offen offset:0 lds
    v_mfma_f32_16x16x32_bf16 v[180:183], v[68:71], v[88:91], v[180:183]
    v_fmac_f32 v26, v47, v47
    v_add_f32_dpp v19, v19, v19 quad_perm:[1,0,3,2] row_mask:0xf bank_mask:0xf
    v_mfma_f32_16x16x32_bf16 v[176:179], v[64:67], v[88:91], v[176:179]
    v_add_f32_dpp v26, v26, v26 quad_perm:[1,0,3,2] row_mask:0xf bank_mask:0xf
    s_nop 0
    v_mfma_f32_16x16x32_bf16 v[176:179], v[48:51], v[84:87], v[176:179]
    s_waitcnt lgkmcnt(1)
    ds_read_b128 v[80:83], v5 offset:35072
    buffer_load_dwordx4 v11, s[24:27], s64 offen offset:1024 lds
    v_mfma_f32_16x16x32_bf16 v[192:195], v[48:51], v[92:95], v[192:195]
    s_add_u32 m0, s62, 100352
    v_add_f32_dpp v19, v19, v19 quad_perm:[2,3,0,1] row_mask:0xf bank_mask:0xf
    v_mfma_f32_16x16x32_bf16 v[192:195], v[64:67], a[216:219], v[192:195]
    v_add_f32_dpp v26, v26, v26 quad_perm:[2,3,0,1] row_mask:0xf bank_mask:0xf
    s_nop 0
    v_mfma_f32_16x16x32_bf16 v[196:199], v[68:71], a[216:219], v[196:199]
    v_add_f32_dpp v19, v19, v19 row_half_mirror row_mask:0xf bank_mask:0xf
    v_add_f32_dpp v26, v26, v26 row_half_mirror row_mask:0xf bank_mask:0xf
    v_mfma_f32_16x16x32_bf16 v[196:199], v[52:55], v[92:95], v[196:199]
    s_nop 0
    buffer_load_dwordx4 v12, s[24:27], s64 offen offset:0 lds
    v_mfma_f32_16x16x32_bf16 v[200:203], v[56:59], v[92:95], v[200:203]
    ds_read_b128 v[84:87], v4 offset:37120
    v_add_f32_dpp v19, v19, v19 row_mirror row_mask:0xf bank_mask:0xf
    v_mfma_f32_16x16x32_bf16 v[200:203], v[72:75], a[216:219], v[200:203]
    v_add_f32_dpp v26, v26, v26 row_mirror row_mask:0xf bank_mask:0xf
    s_nop 0
    v_mfma_f32_16x16x32_bf16 v[204:207], v[76:79], a[216:219], v[204:207]
    v_mul_f32 v29, 0xbacccccd, v19
    v_mul_f32 v26, 0x3acccccd, v26
    v_mfma_f32_16x16x32_bf16 v[204:207], v[60:63], v[92:95], v[204:207]
    s_waitcnt lgkmcnt(1)
    ds_read_b128 v[88:91], v5 offset:37120
    buffer_load_dwordx4 v13, s[24:27], s64 offen offset:1024 lds
    v_mfma_f32_16x16x32_bf16 v[220:223], v[60:63], a[220:223], v[220:223]
    v_fma_f32 v26, -v29, v29, v26
    v_max_f32 v26, 0, v26
    v_mfma_f32_16x16x32_bf16 v[220:223], v[76:79], v[80:83], v[220:223]
    v_cvt_pk_bf16_f32 v26, v26, v26
    v_and_b32 v26, 0xffff0000, v26
    v_mfma_f32_16x16x32_bf16 v[216:219], v[72:75], v[80:83], v[216:219]
    v_add_f32 v26, 0x3727c5ac, v26
F_PG2:
    s_cbranch_execz F_PG6
    v_cvt_pk_bf16_f32 v26, v26, v26
    v_mfma_f32_16x16x32_bf16 v[216:219], v[56:59], a[220:223], v[216:219]
    buffer_load_dwordx4 v14, s[24:27], s64 offen offset:2048 lds
    s_add_u32 s65, s65, s101
    v_mfma_f32_16x16x32_bf16 v[212:215], v[52:55], a[220:223], v[212:215]
    s_add_u32 m0, s63, 49152
    ds_read_b128 v[92:95], v6 offset:39168
    v_mfma_f32_16x16x32_bf16 v[212:215], v[68:71], v[80:83], v[212:215]
    v_and_b32 v26, 0xffff0000, v26
    v_mfma_f32_16x16x32_bf16 v[208:211], v[64:67], v[80:83], v[208:211]
    v_sqrt_f32 v26, v26
    v_mfma_f32_16x16x32_bf16 v[208:211], v[48:51], a[220:223], v[208:211]
    s_waitcnt lgkmcnt(1)
    ds_read_b128 a[216:219], v7 offset:39168
    v_cvt_pk_bf16_f32 v29, v29, v29
    v_mfma_f32_16x16x32_bf16 v[224:227], v[48:51], v[84:87], v[224:227]
    v_and_b32 v29, 0xffff0000, v29
    v_cvt_pk_bf16_f32 v26, v26, v26
    v_mfma_f32_16x16x32_bf16 v[224:227], v[64:67], v[88:91], v[224:227]
    v_and_b32 v26, 0xffff0000, v26
    v_mfma_f32_16x16x32_bf16 v[228:231], v[68:71], v[88:91], v[228:231]
    v_rcp_f32 v28, v26
    v_mfma_f32_16x16x32_bf16 v[228:231], v[52:55], v[84:87], v[228:231]
    buffer_load_dwordx4 v17, s[28:31], s65 offen offset:0 lds
    v_mfma_f32_16x16x32_bf16 v[232:235], v[56:59], v[84:87], v[232:235]
    s_waitcnt vmcnt(10)
    s_barrier
    ds_read_b128 a[220:223], v5 offset:20736
    v_mfma_f32_16x16x32_bf16 v[232:235], v[72:75], v[88:91], v[232:235]
    ds_read_b64_tr_b16 a[240:241], v15 offset:16384
    v_mul_f32 v31, v26, v26
    v_mfma_f32_16x16x32_bf16 v[236:239], v[76:79], v[88:91], v[236:239]
    ds_read_b64_tr_b16 a[242:243], v15 offset:24576
    v_mul_f32 v30, 0xbfb8aa3b, v28
    v_mfma_f32_16x16x32_bf16 v[236:239], v[60:63], v[84:87], v[236:239]
    s_waitcnt lgkmcnt(3)
    buffer_load_dwordx4 v18, s[28:31], s65 offen offset:1024 lds
    v_mfma_f32_16x16x32_bf16 v[252:255], v[60:63], v[92:95], v[252:255]
    ds_read_b128 v[80:83], v5 offset:22784
    buffer_store_dwordx4 v[28:31], v27, s[40:43], 0 offen sc1
    v_mfma_f32_16x16x32_bf16 v[252:255], v[76:79], a[216:219], v[252:255]
    ds_read_b64_tr_b16 a[244:245], v16 offset:16384
    v_mfma_f32_16x16x32_bf16 v[248:251], v[72:75], a[216:219], v[248:251]
    ds_read_b64_tr_b16 a[246:247], v16 offset:24576
    v_mfma_f32_16x16x32_bf16 v[248:251], v[56:59], v[92:95], v[248:251]
    ds_read_b64_tr_b16 a[248:249], v15 offset:18432
    v_mfma_f32_16x16x32_bf16 v[244:247], v[52:55], v[92:95], v[244:247]
    ds_read_b128 v[84:87], v5 offset:24832
    v_mfma_f32_16x16x32_bf16 v[244:247], v[68:71], a[216:219], v[244:247]
    ds_read_b64_tr_b16 a[250:251], v15 offset:26624
    v_mfma_f32_16x16x32_bf16 v[240:243], v[64:67], a[216:219], v[240:243]
    v_mfma_f32_16x16x32_bf16 v[240:243], v[48:51], v[92:95], v[240:243]
    s_waitcnt lgkmcnt(8)
    ds_read_b64_tr_b16 a[252:253], v16 offset:18432
    buffer_load_dwordx4 v17, s[32:35], s65 offen offset:2048 lds
    v_mfma_f32_16x16x32_bf16 v[96:99], v[64:67], a[220:223], v[96:99]
    ds_read_b128 v[88:91], v5 offset:26880
    v_mfma_f32_16x16x32_bf16 v[100:103], v[68:71], a[220:223], v[100:103]
    ds_read_b64_tr_b16 a[254:255], v16 offset:26624
    v_mfma_f32_16x16x32_bf16 v[104:107], v[72:75], a[220:223], v[104:107]
    ds_read_b64_tr_b16 a[224:225], v8 offset:16384
    v_mfma_f32_16x16x32_bf16 v[108:111], v[76:79], a[220:223], v[108:111]
    s_waitcnt lgkmcnt(9)
    buffer_load_dwordx4 v18, s[32:35], s65 offen offset:3072 lds
    s_bfe_u32 s64, s77, 0x4001c
    v_mfma_f32_16x16x32_bf16 v[124:127], v[76:79], v[80:83], v[124:127]
    s_lshl_b32 s64, s64, 7
    ds_read_b128 v[92:95], v5 offset:28928
    v_mfma_f32_16x16x32_bf16 v[120:123], v[72:75], v[80:83], v[120:123]
    ds_read_b64_tr_b16 a[226:227], v8 offset:24576
    v_mfma_f32_16x16x32_bf16 v[116:119], v[68:71], v[80:83], v[116:119]
    ds_read_b64_tr_b16 a[228:229], v9 offset:16384
    v_mfma_f32_16x16x32_bf16 v[112:115], v[64:67], v[80:83], v[112:115]
    s_waitcnt lgkmcnt(8)
    ds_read_b64_tr_b16 a[230:231], v9 offset:24576
    v_mfma_f32_16x16x32_bf16 v[128:131], v[64:67], v[84:87], v[128:131]
    ds_read_b128 a[216:219], v4 offset:41472
    v_mfma_f32_16x16x32_bf16 v[132:135], v[68:71], v[84:87], v[132:135]
    ds_read_b64_tr_b16 a[232:233], v8 offset:18432
    v_mfma_f32_16x16x32_bf16 v[136:139], v[72:75], v[84:87], v[136:139]
    ds_read_b64_tr_b16 a[234:235], v8 offset:26624
    v_mfma_f32_16x16x32_bf16 v[140:143], v[76:79], v[84:87], v[140:143]
    s_waitcnt lgkmcnt(9)
    ds_read_b128 a[220:223], v5 offset:41472
    v_mfma_f32_16x16x32_bf16 v[156:159], v[76:79], v[88:91], v[156:159]
    ds_read_b64_tr_b16 a[236:237], v9 offset:18432
    v_mfma_f32_16x16x32_bf16 v[152:155], v[72:75], v[88:91], v[152:155]
    v_mfma_f32_16x16x32_bf16 v[148:151], v[68:71], v[88:91], v[148:151]
    ds_read_b64_tr_b16 a[238:239], v9 offset:26624
    v_mfma_f32_16x16x32_bf16 v[144:147], v[64:67], v[88:91], v[144:147]
    s_waitcnt lgkmcnt(9)
    v_mfma_f32_16x16x32_bf16 v[160:163], v[64:67], v[92:95], v[160:163]
    ds_read_b128 v[80:83], v4 offset:43520
    v_mfma_f32_16x16x32_bf16 v[164:167], v[68:71], v[92:95], v[164:167]
    v_mfma_f32_16x16x32_bf16 v[168:171], v[72:75], v[92:95], v[168:171]
    v_mfma_f32_16x16x32_bf16 v[172:175], v[76:79], v[92:95], v[172:175]
    s_waitcnt lgkmcnt(1)
    ds_read_b128 v[84:87], v5 offset:43520
    v_mfma_f32_16x16x32_bf16 v[108:111], a[252:255], a[216:219], v[108:111]
    buffer_load_dword v22, v21, s[40:43], 0 offen sc1
    v_mfma_f32_16x16x32_bf16 v[108:111], a[236:239], a[220:223], v[108:111]
    v_mfma_f32_16x16x32_bf16 v[104:107], a[232:235], a[220:223], v[104:107]
    s_barrier
    v_mfma_f32_16x16x32_bf16 v[104:107], a[248:251], a[216:219], v[104:107]
    s_add_u32 m0, s62, 119040
    v_mfma_f32_16x16x32_bf16 v[100:103], a[244:247], a[216:219], v[100:103]
    ds_read_b128 v[88:91], v4 offset:45568
    buffer_load_dwordx4 v10, s[24:27], s64 offen offset:0 lds
    v_mfma_f32_16x16x32_bf16 v[100:103], a[228:231], a[220:223], v[100:103]
    buffer_load_dwordx4 v11, s[24:27], s64 offen offset:1024 lds
    s_add_u32 m0, s62, 121088
    v_mfma_f32_16x16x32_bf16 v[96:99], a[224:227], a[220:223], v[96:99]
    buffer_load_dwordx4 v12, s[24:27], s64 offen offset:0 lds
    v_mfma_f32_16x16x32_bf16 v[96:99], a[240:243], a[216:219], v[96:99]
    s_waitcnt lgkmcnt(1)
    ds_read_b128 v[92:95], v5 offset:45568
    buffer_load_dwordx4 v13, s[24:27], s64 offen offset:1024 lds
    v_mfma_f32_16x16x32_bf16 v[112:115], a[240:243], v[80:83], v[112:115]
    v_mfma_f32_16x16x32_bf16 v[112:115], a[224:227], v[84:87], v[112:115]
    v_mfma_f32_16x16x32_bf16 v[116:119], a[228:231], v[84:87], v[116:119]
    v_mfma_f32_16x16x32_bf16 v[116:119], a[244:247], v[80:83], v[116:119]
    v_mfma_f32_16x16x32_bf16 v[120:123], a[248:251], v[80:83], v[120:123]
    ds_read_b128 a[216:219], v4 offset:47616
    v_mfma_f32_16x16x32_bf16 v[120:123], a[232:235], v[84:87], v[120:123]
    buffer_load_dwordx4 v14, s[24:27], s64 offen offset:2048 lds
    s_bfe_u32 s65, s77, 0x4001c
    v_mfma_f32_16x16x32_bf16 v[124:127], a[236:239], v[84:87], v[124:127]
    s_lshl1_add_u32 s65, s65, s76
    s_mul_i32 s65, s65, 98304
    v_mfma_f32_16x16x32_bf16 v[124:127], a[252:255], v[80:83], v[124:127]
    s_waitcnt lgkmcnt(1)
    ds_read_b128 a[220:223], v5 offset:47616
    s_add_u32 m0, s63, 0
    v_mfma_f32_16x16x32_bf16 v[140:143], a[252:255], v[88:91], v[140:143]
    v_mfma_f32_16x16x32_bf16 v[140:143], a[236:239], v[92:95], v[140:143]
    buffer_load_dwordx4 v17, s[28:31], s65 offen offset:0 lds
    v_mfma_f32_16x16x32_bf16 v[136:139], a[232:235], v[92:95], v[136:139]
    v_mfma_f32_16x16x32_bf16 v[136:139], a[248:251], v[88:91], v[136:139]
    v_mfma_f32_16x16x32_bf16 v[132:135], a[244:247], v[88:91], v[132:135]
    ds_read_b128 v[80:83], v4 offset:49664
    v_mfma_f32_16x16x32_bf16 v[132:135], a[228:231], v[92:95], v[132:135]
    v_mfma_f32_16x16x32_bf16 v[128:131], a[224:227], v[92:95], v[128:131]
    v_mfma_f32_16x16x32_bf16 v[128:131], a[240:243], v[88:91], v[128:131]
    s_waitcnt lgkmcnt(1)
    ds_read_b128 v[84:87], v5 offset:49664
    v_mfma_f32_16x16x32_bf16 v[144:147], a[240:243], a[216:219], v[144:147]
    v_mfma_f32_16x16x32_bf16 v[144:147], a[224:227], a[220:223], v[144:147]
    buffer_load_dwordx4 v18, s[28:31], s65 offen offset:1024 lds
    v_mfma_f32_16x16x32_bf16 v[148:151], a[228:231], a[220:223], v[148:151]
    v_mfma_f32_16x16x32_bf16 v[148:151], a[244:247], a[216:219], v[148:151]
    v_mfma_f32_16x16x32_bf16 v[152:155], a[248:251], a[216:219], v[152:155]
    ds_read_b128 v[88:91], v4 offset:51712
    v_mfma_f32_16x16x32_bf16 v[152:155], a[232:235], a[220:223], v[152:155]
    buffer_load_dwordx4 v17, s[32:35], s65 offen offset:2048 lds
    v_mfma_f32_16x16x32_bf16 v[156:159], a[236:239], a[220:223], v[156:159]
    v_mfma_f32_16x16x32_bf16 v[156:159], a[252:255], a[216:219], v[156:159]
    s_waitcnt lgkmcnt(1)
    ds_read_b128 v[92:95], v5 offset:51712
    v_mfma_f32_16x16x32_bf16 v[172:175], a[252:255], v[80:83], v[172:175]
    v_mfma_f32_16x16x32_bf16 v[172:175], a[236:239], v[84:87], v[172:175]
    s_waitcnt vmcnt(8)
    buffer_load_dwordx4 v18, s[32:35], s65 offen offset:3072 lds
    s_add_u32 s65, s65, s101
    v_mfma_f32_16x16x32_bf16 v[168:171], a[232:235], v[84:87], v[168:171]
    s_add_u32 m0, s63, 65536
    v_cmp_eq_u32 vcc, 0, v22
    s_cbranch_vccnz F_SPIN_S
F_BACK_S:
    v_mfma_f32_16x16x32_bf16 v[168:171], a[248:251], v[80:83], v[168:171]
    s_xor_b32 s66, s82, 0
    s_mul_i32 s66, s66, 15360
    v_mfma_f32_16x16x32_bf16 v[164:167], a[244:247], v[80:83], v[164:167]
    s_add_u32 s66, s66, s83
    ds_read_b128 a[216:219], v4 offset:53760
    v_mfma_f32_16x16x32_bf16 v[164:167], a[228:231], v[84:87], v[164:167]
    buffer_load_dwordx4 v17, s[28:31], s65 offen offset:0 lds
    v_mfma_f32_16x16x32_bf16 v[160:163], a[224:227], v[84:87], v[160:163]
    v_mfma_f32_16x16x32_bf16 v[160:163], a[240:243], v[80:83], v[160:163]
    s_waitcnt lgkmcnt(1)
    ds_read_b128 a[220:223], v5 offset:53760
    v_mfma_f32_16x16x32_bf16 v[176:179], a[240:243], v[88:91], v[176:179]
    v_mfma_f32_16x16x32_bf16 v[176:179], a[224:227], v[92:95], v[176:179]
    buffer_load_dwordx4 v18, s[28:31], s65 offen offset:1024 lds
    v_mfma_f32_16x16x32_bf16 v[180:183], a[228:231], v[92:95], v[180:183]
    v_mfma_f32_16x16x32_bf16 v[180:183], a[244:247], v[88:91], v[180:183]
    v_mfma_f32_16x16x32_bf16 v[184:187], a[248:251], v[88:91], v[184:187]
    ds_read_b128 v[80:83], v4 offset:55808
    v_mfma_f32_16x16x32_bf16 v[184:187], a[232:235], v[92:95], v[184:187]
    buffer_load_dwordx4 v17, s[32:35], s65 offen offset:2048 lds
    v_mfma_f32_16x16x32_bf16 v[188:191], a[236:239], v[92:95], v[188:191]
    v_mfma_f32_16x16x32_bf16 v[188:191], a[252:255], v[88:91], v[188:191]
    s_waitcnt lgkmcnt(1)
    ds_read_b128 v[84:87], v5 offset:55808
    v_mfma_f32_16x16x32_bf16 v[204:207], a[252:255], a[216:219], v[204:207]
    s_barrier
    v_mfma_f32_16x16x32_bf16 v[204:207], a[236:239], a[220:223], v[204:207]
    ds_read_b64_tr_b16 v[48:49], v8 offset:32768
    buffer_store_dword v20, v3, s[40:43], s70 offen sc1
    v_mfma_f32_16x16x32_bf16 v[200:203], a[232:235], a[220:223], v[200:203]
    s_mul_i32 s71, s56, 40
    ds_read_b64_tr_b16 v[50:51], v8 offset:40960
    v_add_u32 v20, s71, v1
    v_mfma_f32_16x16x32_bf16 v[200:203], a[248:251], a[216:219], v[200:203]
    s_add_u32 s72, s79, 152
    v_mov_b32 v22, 152
    v_cmp_gt_u32 vcc, s72, v20
    v_mfma_f32_16x16x32_bf16 v[196:199], a[244:247], a[216:219], v[196:199]
    ds_read_b128 v[88:91], v4 offset:57856
    v_add_u32 v21, s78, v20
    v_mfma_f32_16x16x32_bf16 v[196:199], a[228:231], a[220:223], v[196:199]
    ds_read_b64_tr_b16 v[52:53], v9 offset:32768
    buffer_load_dwordx4 v18, s[32:35], s65 offen offset:3072 lds
    v_mfma_f32_16x16x32_bf16 v[192:195], a[224:227], a[220:223], v[192:195]
    s_bfe_u32 s64, s59, 0x40000
    ds_read_b64_tr_b16 v[54:55], v9 offset:40960
    v_lshlrev_b32 v23, 4, v20
    v_mfma_f32_16x16x32_bf16 v[192:195], a[240:243], a[216:219], v[192:195]
    s_waitcnt lgkmcnt(5)
    ds_read_b128 v[92:95], v5 offset:57856
    v_cndmask_b32 v22, 0, v22, vcc
    v_mfma_f32_16x16x32_bf16 v[208:211], a[240:243], v[80:83], v[208:211]
    s_lshl_b32 s64, s64, 7
    ds_read_b64_tr_b16 v[56:57], v8 offset:34816
    v_cmp_gt_u32 vcc, 152, v20
    v_mfma_f32_16x16x32_bf16 v[208:211], a[224:227], v[84:87], v[208:211]
    ds_read_b64_tr_b16 v[58:59], v8 offset:43008
    buffer_load_dwordx4 a[0:3], v2, s[40:43], s66 offen offset:0 sc1
    v_mfma_f32_16x16x32_bf16 v[212:215], a[228:231], v[84:87], v[212:215]
    v_sub_u32 v21, v21, v22
    v_add_u32 v22, s80, v20
    v_mfma_f32_16x16x32_bf16 v[212:215], a[244:247], v[80:83], v[212:215]
    ds_read_b64_tr_b16 v[60:61], v9 offset:34816
    v_cndmask_b32 v21, v21, v22, vcc
    v_mfma_f32_16x16x32_bf16 v[216:219], a[248:251], v[80:83], v[216:219]
    ds_read_b128 a[216:219], v6 offset:59904
    v_lshrrev_b32 v22, 4, v21
    v_mfma_f32_16x16x32_bf16 v[216:219], a[232:235], v[84:87], v[216:219]
    ds_read_b64_tr_b16 v[62:63], v9 offset:43008
    buffer_load_dwordx4 a[4:7], v2, s[40:43], s66 offen offset:1024 sc1
    v_mfma_f32_16x16x32_bf16 v[220:223], a[236:239], v[84:87], v[220:223]
    ds_read_b64_tr_b16 v[64:65], v8 offset:49152
    v_min_u32 v22, 127, v22
    v_mfma_f32_16x16x32_bf16 v[220:223], a[252:255], v[80:83], v[220:223]
    s_waitcnt lgkmcnt(6)
    ds_read_b128 a[220:223], v7 offset:59904
    buffer_load_dwordx4 a[8:11], v2, s[40:43], s66 offen offset:2048 sc1
    v_mfma_f32_16x16x32_bf16 v[236:239], a[252:255], v[88:91], v[236:239]
    ds_read_b64_tr_b16 v[66:67], v8 offset:57344
    v_lshlrev_b32 v22, 7, v22
    v_mfma_f32_16x16x32_bf16 v[236:239], a[236:239], v[92:95], v[236:239]
    ds_read_b64_tr_b16 v[68:69], v9 offset:49152
    v_add_u32 v22, 3265536, v22
    v_mfma_f32_16x16x32_bf16 v[232:235], a[232:235], v[92:95], v[232:235]
    v_lshlrev_b32 v21, 4, v21
    v_add_u32 v21, 3145728, v21
    v_mfma_f32_16x16x32_bf16 v[232:235], a[248:251], v[88:91], v[232:235]
    ds_read_b64_tr_b16 v[70:71], v9 offset:57344
    buffer_load_dwordx4 a[12:15], v2, s[40:43], s66 offen offset:3072 sc1
    v_mfma_f32_16x16x32_bf16 v[228:231], a[244:247], v[88:91], v[228:231]
    s_add_u32 s66, s66, 4096
    ds_read_b128 v[80:83], v4 offset:0
    v_mfma_f32_16x16x32_bf16 v[228:231], a[228:231], v[92:95], v[228:231]
    ds_read_b64_tr_b16 v[72:73], v8 offset:51200
    v_mfma_f32_16x16x32_bf16 v[224:227], a[224:227], v[92:95], v[224:227]
    ds_read_b64_tr_b16 v[74:75], v8 offset:59392
    v_mfma_f32_16x16x32_bf16 v[224:227], a[240:243], v[88:91], v[224:227]
    s_waitcnt lgkmcnt(6)
    ds_read_b128 v[84:87], v5 offset:0
    v_mfma_f32_16x16x32_bf16 v[240:243], a[240:243], a[216:219], v[240:243]
    ds_read_b64_tr_b16 v[76:77], v9 offset:51200
    v_mfma_f32_16x16x32_bf16 v[240:243], a[224:227], a[220:223], v[240:243]
    v_mfma_f32_16x16x32_bf16 v[244:247], a[228:231], a[220:223], v[244:247]
    ds_read_b64_tr_b16 v[78:79], v9 offset:59392
    v_mfma_f32_16x16x32_bf16 v[244:247], a[244:247], a[216:219], v[244:247]
    v_mfma_f32_16x16x32_bf16 v[248:251], a[248:251], a[216:219], v[248:251]
    ds_read_b128 v[88:91], v4 offset:2048
    buffer_load_dwordx4 a[16:19], v2, s[40:43], s66 offen offset:0 sc1
    v_mfma_f32_16x16x32_bf16 v[248:251], a[232:235], a[220:223], v[248:251]
    v_mfma_f32_16x16x32_bf16 v[252:255], a[236:239], a[220:223], v[252:255]
    v_mfma_f32_16x16x32_bf16 v[252:255], a[252:255], a[216:219], v[252:255]
    s_waitcnt lgkmcnt(1)
    ds_read_b128 v[92:95], v5 offset:2048
    v_mfma_f32_16x16x32_bf16 v[108:111], v[60:63], v[80:83], v[108:111]
    v_mfma_f32_16x16x32_bf16 v[108:111], v[76:79], v[84:87], v[108:111]
    v_mfma_f32_16x16x32_bf16 v[104:107], v[72:75], v[84:87], v[104:107]
    s_barrier
    v_mfma_f32_16x16x32_bf16 v[104:107], v[56:59], v[80:83], v[104:107]
    s_add_u32 m0, s62, 139776
    v_mfma_f32_16x16x32_bf16 v[100:103], v[52:55], v[80:83], v[100:103]
    ds_read_b128 a[216:219], v4 offset:4096
    v_mfma_f32_16x16x32_bf16 v[100:103], v[68:71], v[84:87], v[100:103]
    buffer_load_dwordx4 v10, s[24:27], s64 offen offset:0 lds
    v_mfma_f32_16x16x32_bf16 v[96:99], v[64:67], v[84:87], v[96:99]
    v_mfma_f32_16x16x32_bf16 v[96:99], v[48:51], v[80:83], v[96:99]
    s_waitcnt lgkmcnt(1)
    ds_read_b128 a[220:223], v5 offset:4096
    v_mfma_f32_16x16x32_bf16 v[112:115], v[48:51], v[88:91], v[112:115]
    v_mfma_f32_16x16x32_bf16 v[112:115], v[64:67], v[92:95], v[112:115]
    v_mfma_f32_16x16x32_bf16 v[116:119], v[68:71], v[92:95], v[116:119]
    v_mfma_f32_16x16x32_bf16 v[116:119], v[52:55], v[88:91], v[116:119]
    v_mfma_f32_16x16x32_bf16 v[120:123], v[56:59], v[88:91], v[120:123]
    ds_read_b128 v[80:83], v4 offset:6144
    v_mfma_f32_16x16x32_bf16 v[120:123], v[72:75], v[92:95], v[120:123]
    v_mfma_f32_16x16x32_bf16 v[124:127], v[76:79], v[92:95], v[124:127]
    buffer_load_dwordx4 v11, s[24:27], s64 offen offset:1024 lds
    s_add_u32 m0, s62, 141824
    v_mfma_f32_16x16x32_bf16 v[124:127], v[60:63], v[88:91], v[124:127]
    s_waitcnt lgkmcnt(1)
    ds_read_b128 v[84:87], v5 offset:6144
    v_mfma_f32_16x16x32_bf16 v[140:143], v[60:63], a[216:219], v[140:143]
    v_mfma_f32_16x16x32_bf16 v[140:143], v[76:79], a[220:223], v[140:143]
    v_mfma_f32_16x16x32_bf16 v[136:139], v[72:75], a[220:223], v[136:139]
    v_mfma_f32_16x16x32_bf16 v[136:139], v[56:59], a[216:219], v[136:139]
    v_mfma_f32_16x16x32_bf16 v[132:135], v[52:55], a[216:219], v[132:135]
    ds_read_b128 v[88:91], v4 offset:8192
    v_mfma_f32_16x16x32_bf16 v[132:135], v[68:71], a[220:223], v[132:135]
    v_mfma_f32_16x16x32_bf16 v[128:131], v[64:67], a[220:223], v[128:131]
    v_mfma_f32_16x16x32_bf16 v[128:131], v[48:51], a[216:219], v[128:131]
    s_waitcnt lgkmcnt(1)
    ds_read_b128 v[92:95], v5 offset:8192
    buffer_load_dwordx4 v12, s[24:27], s64 offen offset:0 lds
    v_mfma_f32_16x16x32_bf16 v[144:147], v[48:51], v[80:83], v[144:147]
    v_mfma_f32_16x16x32_bf16 v[144:147], v[64:67], v[84:87], v[144:147]
    v_mfma_f32_16x16x32_bf16 v[148:151], v[68:71], v[84:87], v[148:151]
    v_mfma_f32_16x16x32_bf16 v[148:151], v[52:55], v[80:83], v[148:151]
    v_mfma_f32_16x16x32_bf16 v[152:155], v[56:59], v[80:83], v[152:155]
    ds_read_b128 a[216:219], v4 offset:10240
    v_mfma_f32_16x16x32_bf16 v[152:155], v[72:75], v[84:87], v[152:155]
    v_mfma_f32_16x16x32_bf16 v[156:159], v[76:79], v[84:87], v[156:159]
    v_mfma_f32_16x16x32_bf16 v[156:159], v[60:63], v[80:83], v[156:159]
    s_waitcnt lgkmcnt(1)
    ds_read_b128 a[220:223], v5 offset:10240
    v_mfma_f32_16x16x32_bf16 v[172:175], v[60:63], v[88:91], v[172:175]
    buffer_load_dwordx4 v13, s[24:27], s64 offen offset:1024 lds
    v_mfma_f32_16x16x32_bf16 v[172:175], v[76:79], v[92:95], v[172:175]
    v_mfma_f32_16x16x32_bf16 v[168:171], v[72:75], v[92:95], v[168:171]
    v_mfma_f32_16x16x32_bf16 v[168:171], v[56:59], v[88:91], v[168:171]
    v_mfma_f32_16x16x32_bf16 v[164:167], v[52:55], v[88:91], v[164:167]
    ds_read_b128 v[80:83], v4 offset:12288
    buffer_load_dwordx4 v14, s[24:27], s64 offen offset:2048 lds
    v_mfma_f32_16x16x32_bf16 v[164:167], v[68:71], v[92:95], v[164:167]
    s_bfe_u32 s65, s59, 0x40000
    s_lshl1_add_u32 s65, s65, s76
    v_mfma_f32_16x16x32_bf16 v[160:163], v[64:67], v[92:95], v[160:163]
    s_mul_i32 s65, s65, 98304
    s_add_u32 m0, s63, 16384
    v_mfma_f32_16x16x32_bf16 v[160:163], v[48:51], v[88:91], v[160:163]
    s_waitcnt lgkmcnt(1)
    ds_read_b128 v[84:87], v5 offset:12288
    v_mfma_f32_16x16x32_bf16 v[176:179], v[48:51], a[216:219], v[176:179]
    buffer_load_dwordx4 v17, s[28:31], s65 offen offset:0 lds
    v_mfma_f32_16x16x32_bf16 v[176:179], v[64:67], a[220:223], v[176:179]
    v_mfma_f32_16x16x32_bf16 v[180:183], v[68:71], a[220:223], v[180:183]
    v_mfma_f32_16x16x32_bf16 v[180:183], v[52:55], a[216:219], v[180:183]
    v_mfma_f32_16x16x32_bf16 v[184:187], v[56:59], a[216:219], v[184:187]
    ds_read_b128 v[88:91], v4 offset:14336
    buffer_load_dwordx4 v18, s[28:31], s65 offen offset:1024 lds
    v_mfma_f32_16x16x32_bf16 v[184:187], v[72:75], a[220:223], v[184:187]
    v_mfma_f32_16x16x32_bf16 v[188:191], v[76:79], a[220:223], v[188:191]
    v_mfma_f32_16x16x32_bf16 v[188:191], v[60:63], a[216:219], v[188:191]
    s_waitcnt lgkmcnt(1)
    ds_read_b128 v[92:95], v5 offset:14336
    v_mfma_f32_16x16x32_bf16 v[204:207], v[60:63], v[80:83], v[204:207]
    s_waitcnt vmcnt(12)
    s_barrier
    buffer_load_dwordx4 v17, s[32:35], s65 offen offset:2048 lds
    v_mfma_f32_16x16x32_bf16 v[204:207], v[76:79], v[84:87], v[204:207]
    ds_read_b64_tr_b16 a[240:241], v8 offset:0
    v_mfma_f32_16x16x32_bf16 v[200:203], v[72:75], v[84:87], v[200:203]
    ds_read_b64_tr_b16 a[242:243], v8 offset:8192
    v_mfma_f32_16x16x32_bf16 v[200:203], v[56:59], v[80:83], v[200:203]
    v_mfma_f32_16x16x32_bf16 v[196:199], v[52:55], v[80:83], v[196:199]
    ds_read_b128 a[216:219], v4 offset:16384
    buffer_load_dwordx4 v18, s[32:35], s65 offen offset:3072 lds
    v_mfma_f32_16x16x32_bf16 v[196:199], v[68:71], v[84:87], v[196:199]
    s_add_u32 s65, s65, s101
    ds_read_b64_tr_b16 a[244:245], v9 offset:0
    s_add_u32 m0, s63, 81920
    v_mfma_f32_16x16x32_bf16 v[192:195], v[64:67], v[84:87], v[192:195]
    ds_read_b64_tr_b16 a[246:247], v9 offset:8192
    v_mfma_f32_16x16x32_bf16 v[192:195], v[48:51], v[80:83], v[192:195]
    s_waitcnt lgkmcnt(5)
    ds_read_b128 a[220:223], v5 offset:16384
    v_mfma_f32_16x16x32_bf16 v[208:211], v[48:51], v[88:91], v[208:211]
    ds_read_b64_tr_b16 a[248:249], v8 offset:2048
    buffer_load_dwordx4 v17, s[28:31], s65 offen offset:0 lds
    v_mfma_f32_16x16x32_bf16 v[208:211], v[64:67], v[92:95], v[208:211]
    ds_read_b64_tr_b16 a[250:251], v8 offset:10240
    v_mfma_f32_16x16x32_bf16 v[212:215], v[68:71], v[92:95], v[212:215]
    v_mfma_f32_16x16x32_bf16 v[212:215], v[52:55], v[88:91], v[212:215]
    ds_read_b64_tr_b16 a[252:253], v9 offset:2048
    v_mfma_f32_16x16x32_bf16 v[216:219], v[56:59], v[88:91], v[216:219]
    ds_read_b128 v[80:83], v6 offset:18432
    buffer_load_dwordx4 v18, s[28:31], s65 offen offset:1024 lds
    v_mfma_f32_16x16x32_bf16 v[216:219], v[72:75], v[92:95], v[216:219]
    ds_read_b64_tr_b16 a[254:255], v9 offset:10240
    v_mfma_f32_16x16x32_bf16 v[220:223], v[76:79], v[92:95], v[220:223]
    ds_read_b64_tr_b16 a[224:225], v15 offset:0
    v_mfma_f32_16x16x32_bf16 v[220:223], v[60:63], v[88:91], v[220:223]
    s_waitcnt lgkmcnt(6)
    ds_read_b128 v[84:87], v7 offset:18432
    v_mfma_f32_16x16x32_bf16 v[236:239], v[60:63], a[216:219], v[236:239]
    ds_read_b64_tr_b16 a[226:227], v15 offset:8192
    buffer_load_dwordx4 v17, s[32:35], s65 offen offset:2048 lds
    v_mfma_f32_16x16x32_bf16 v[236:239], v[76:79], a[220:223], v[236:239]
    ds_read_b64_tr_b16 a[228:229], v16 offset:0
    v_mfma_f32_16x16x32_bf16 v[232:235], v[72:75], a[220:223], v[232:235]
    v_mfma_f32_16x16x32_bf16 v[232:235], v[56:59], a[216:219], v[232:235]
    ds_read_b64_tr_b16 a[230:231], v16 offset:8192
    v_mfma_f32_16x16x32_bf16 v[228:231], v[52:55], a[216:219], v[228:231]
    ds_read_b128 v[88:91], v4 offset:20736
    buffer_load_dwordx4 v18, s[32:35], s65 offen offset:3072 lds
    v_mfma_f32_16x16x32_bf16 v[228:231], v[68:71], a[220:223], v[228:231]
    s_bfe_u32 s64, s59, 0x40004
    ds_read_b64_tr_b16 a[232:233], v15 offset:2048
    s_lshl_b32 s64, s64, 7
    v_mfma_f32_16x16x32_bf16 v[224:227], v[64:67], a[220:223], v[224:227]
    ds_read_b64_tr_b16 a[234:235], v15 offset:10240
    v_mfma_f32_16x16x32_bf16 v[224:227], v[48:51], a[216:219], v[224:227]
    s_waitcnt lgkmcnt(6)
    ds_read_b128 v[92:95], v5 offset:20736
    v_mfma_f32_16x16x32_bf16 v[240:243], v[48:51], v[80:83], v[240:243]
    ds_read_b64_tr_b16 a[236:237], v16 offset:2048
    buffer_load_dwordx4 a[20:23], v2, s[40:43], s66 offen offset:1024 sc1
    v_mfma_f32_16x16x32_bf16 v[240:243], v[64:67], v[84:87], v[240:243]
    v_mfma_f32_16x16x32_bf16 v[244:247], v[68:71], v[84:87], v[244:247]
    ds_read_b64_tr_b16 a[238:239], v16 offset:10240
    v_mfma_f32_16x16x32_bf16 v[244:247], v[52:55], v[80:83], v[244:247]
    v_mfma_f32_16x16x32_bf16 v[248:251], v[56:59], v[80:83], v[248:251]
    ds_read_b128 a[216:219], v4 offset:22784
    buffer_load_dwordx4 a[24:27], v2, s[40:43], s66 offen offset:2048 sc1
    v_mfma_f32_16x16x32_bf16 v[248:251], v[72:75], v[84:87], v[248:251]
    v_mfma_f32_16x16x32_bf16 v[252:255], v[76:79], v[84:87], v[252:255]
    v_mfma_f32_16x16x32_bf16 v[252:255], v[60:63], v[80:83], v[252:255]
    s_waitcnt lgkmcnt(1)
    ds_read_b128 a[220:223], v5 offset:22784
    v_mfma_f32_16x16x32_bf16 v[108:111], a[252:255], v[88:91], v[108:111]
    buffer_load_dwordx4 a[28:31], v2, s[40:43], s66 offen offset:3072 sc1
    s_add_u32 s66, s66, 4096
    v_mfma_f32_16x16x32_bf16 v[108:111], a[236:239], v[92:95], v[108:111]
    v_mfma_f32_16x16x32_bf16 v[104:107], a[232:235], v[92:95], v[104:107]
    s_barrier
    v_mfma_f32_16x16x32_bf16 v[104:107], a[248:251], v[88:91], v[104:107]
    s_add_u32 m0, s62, 98304
    v_mfma_f32_16x16x32_bf16 v[100:103], a[244:247], v[88:91], v[100:103]
    ds_read_b128 v[80:83], v4 offset:24832
    buffer_load_dwordx4 v10, s[24:27], s64 offen offset:0 lds
    v_mfma_f32_16x16x32_bf16 v[100:103], a[228:231], v[92:95], v[100:103]
    v_mfma_f32_16x16x32_bf16 v[96:99], a[224:227], v[92:95], v[96:99]
    v_mfma_f32_16x16x32_bf16 v[96:99], a[240:243], v[88:91], v[96:99]
    s_waitcnt lgkmcnt(1)
    ds_read_b128 v[84:87], v5 offset:24832
    v_mfma_f32_16x16x32_bf16 v[112:115], a[240:243], a[216:219], v[112:115]
    v_mfma_f32_16x16x32_bf16 v[112:115], a[224:227], a[220:223], v[112:115]
    v_mfma_f32_16x16x32_bf16 v[116:119], a[228:231], a[220:223], v[116:119]
    v_mfma_f32_16x16x32_bf16 v[116:119], a[244:247], a[216:219], v[116:119]
    v_mfma_f32_16x16x32_bf16 v[120:123], a[248:251], a[216:219], v[120:123]
    ds_read_b128 v[88:91], v4 offset:26880
    v_mfma_f32_16x16x32_bf16 v[120:123], a[232:235], a[220:223], v[120:123]
    buffer_load_dwordx4 v11, s[24:27], s64 offen offset:1024 lds
    s_add_u32 m0, s62, 100352
    v_mfma_f32_16x16x32_bf16 v[124:127], a[236:239], a[220:223], v[124:127]
    v_mfma_f32_16x16x32_bf16 v[124:127], a[252:255], a[216:219], v[124:127]
    s_waitcnt lgkmcnt(1)
    ds_read_b128 v[92:95], v5 offset:26880
    v_mfma_f32_16x16x32_bf16 v[140:143], a[252:255], v[80:83], v[140:143]
    v_mfma_f32_16x16x32_bf16 v[140:143], a[236:239], v[84:87], v[140:143]
    v_mfma_f32_16x16x32_bf16 v[136:139], a[232:235], v[84:87], v[136:139]
    v_mfma_f32_16x16x32_bf16 v[136:139], a[248:251], v[80:83], v[136:139]
    v_mfma_f32_16x16x32_bf16 v[132:135], a[244:247], v[80:83], v[132:135]
    ds_read_b128 a[216:219], v4 offset:28928
    v_mfma_f32_16x16x32_bf16 v[132:135], a[228:231], v[84:87], v[132:135]
    v_mfma_f32_16x16x32_bf16 v[128:131], a[224:227], v[84:87], v[128:131]
    buffer_load_dwordx4 v12, s[24:27], s64 offen offset:0 lds
    v_mfma_f32_16x16x32_bf16 v[128:131], a[240:243], v[80:83], v[128:131]
    s_waitcnt lgkmcnt(1)
    ds_read_b128 a[220:223], v5 offset:28928
    v_mfma_f32_16x16x32_bf16 v[144:147], a[240:243], v[88:91], v[144:147]
    v_mfma_f32_16x16x32_bf16 v[144:147], a[224:227], v[92:95], v[144:147]
    v_mfma_f32_16x16x32_bf16 v[148:151], a[228:231], v[92:95], v[148:151]
    v_mfma_f32_16x16x32_bf16 v[148:151], a[244:247], v[88:91], v[148:151]
    v_mfma_f32_16x16x32_bf16 v[152:155], a[248:251], v[88:91], v[152:155]
    ds_read_b128 v[80:83], v4 offset:30976
    v_mfma_f32_16x16x32_bf16 v[152:155], a[232:235], v[92:95], v[152:155]
    v_mfma_f32_16x16x32_bf16 v[156:159], a[236:239], v[92:95], v[156:159]
    v_mfma_f32_16x16x32_bf16 v[156:159], a[252:255], v[88:91], v[156:159]
    s_waitcnt lgkmcnt(1)
    ds_read_b128 v[84:87], v5 offset:30976
    buffer_load_dwordx4 v13, s[24:27], s64 offen offset:1024 lds
    v_mfma_f32_16x16x32_bf16 v[172:175], a[252:255], a[216:219], v[172:175]
    v_mfma_f32_16x16x32_bf16 v[172:175], a[236:239], a[220:223], v[172:175]
    v_mfma_f32_16x16x32_bf16 v[168:171], a[232:235], a[220:223], v[168:171]
    v_mfma_f32_16x16x32_bf16 v[168:171], a[248:251], a[216:219], v[168:171]
    buffer_load_dwordx4 v14, s[24:27], s64 offen offset:2048 lds
    s_bfe_u32 s65, s59, 0x40004
    v_mfma_f32_16x16x32_bf16 v[164:167], a[244:247], a[216:219], v[164:167]
    s_lshl1_add_u32 s65, s65, s76
    ds_read_b128 v[88:91], v4 offset:33024
    s_mul_i32 s65, s65, 98304
    v_mfma_f32_16x16x32_bf16 v[164:167], a[228:231], a[220:223], v[164:167]
    s_add_u32 m0, s63, 32768
    v_mfma_f32_16x16x32_bf16 v[160:163], a[224:227], a[220:223], v[160:163]
    v_mfma_f32_16x16x32_bf16 v[160:163], a[240:243], a[216:219], v[160:163]
    s_waitcnt lgkmcnt(1)
    ds_read_b128 v[92:95], v5 offset:33024
    buffer_load_dwordx4 v17, s[28:31], s65 offen offset:0 lds
    v_mfma_f32_16x16x32_bf16 v[176:179], a[240:243], v[80:83], v[176:179]
    buffer_load_dword v20, v22, s[40:43], 0 offen sc1
    v_mfma_f32_16x16x32_bf16 v[176:179], a[224:227], v[84:87], v[176:179]
    v_mfma_f32_16x16x32_bf16 v[180:183], a[228:231], v[84:87], v[180:183]
    v_mfma_f32_16x16x32_bf16 v[180:183], a[244:247], v[80:83], v[180:183]
    v_mfma_f32_16x16x32_bf16 v[184:187], a[248:251], v[80:83], v[184:187]
    ds_read_b128 a[216:219], v4 offset:35072
    v_mfma_f32_16x16x32_bf16 v[184:187], a[232:235], v[84:87], v[184:187]
    v_mfma_f32_16x16x32_bf16 v[188:191], a[236:239], v[84:87], v[188:191]
    v_mfma_f32_16x16x32_bf16 v[188:191], a[252:255], v[80:83], v[188:191]
    s_waitcnt lgkmcnt(1)
    ds_read_b128 a[220:223], v5 offset:35072
    buffer_load_dwordx4 v18, s[28:31], s65 offen offset:1024 lds
    v_mfma_f32_16x16x32_bf16 v[204:207], a[252:255], v[88:91], v[204:207]
    s_waitcnt vmcnt(11)
    s_barrier
    v_mfma_f32_16x16x32_bf16 v[204:207], a[236:239], v[92:95], v[204:207]
    ds_read_b64_tr_b16 v[48:49], v8 offset:16384
    v_mfma_f32_16x16x32_bf16 v[200:203], a[232:235], v[92:95], v[200:203]
    ds_read_b64_tr_b16 v[50:51], v8 offset:24576
    v_mfma_f32_16x16x32_bf16 v[200:203], a[248:251], v[88:91], v[200:203]
    buffer_load_dwordx4 v17, s[32:35], s65 offen offset:2048 lds
    v_mfma_f32_16x16x32_bf16 v[196:199], a[244:247], v[88:91], v[196:199]
    ds_read_b128 v[80:83], v4 offset:37120
    v_mfma_f32_16x16x32_bf16 v[196:199], a[228:231], v[92:95], v[196:199]
    ds_read_b64_tr_b16 v[52:53], v9 offset:16384
    v_mfma_f32_16x16x32_bf16 v[192:195], a[224:227], v[92:95], v[192:195]
    ds_read_b64_tr_b16 v[54:55], v9 offset:24576
    v_mfma_f32_16x16x32_bf16 v[192:195], a[240:243], v[88:91], v[192:195]
    s_waitcnt lgkmcnt(5)
    ds_read_b128 v[84:87], v5 offset:37120
    buffer_load_dwordx4 v18, s[32:35], s65 offen offset:3072 lds
    v_mfma_f32_16x16x32_bf16 v[208:211], a[240:243], a[216:219], v[208:211]
    s_add_u32 s65, s65, s101
    ds_read_b64_tr_b16 v[56:57], v8 offset:18432
    s_add_u32 m0, s63, 49152
    v_mfma_f32_16x16x32_bf16 v[208:211], a[224:227], a[220:223], v[208:211]
    ds_read_b64_tr_b16 v[58:59], v8 offset:26624
    buffer_load_dwordx4 v17, s[28:31], s65 offen offset:0 lds
    v_mfma_f32_16x16x32_bf16 v[212:215], a[228:231], a[220:223], v[212:215]
    v_mfma_f32_16x16x32_bf16 v[212:215], a[244:247], a[216:219], v[212:215]
    ds_read_b64_tr_b16 v[60:61], v9 offset:18432
    v_mfma_f32_16x16x32_bf16 v[216:219], a[248:251], a[216:219], v[216:219]
    ds_read_b128 v[88:91], v6 offset:39168
    v_mfma_f32_16x16x32_bf16 v[216:219], a[232:235], a[220:223], v[216:219]
F_PG3:
    s_cbranch_execz F_TRET
    ds_read_b64_tr_b16 v[62:63], v9 offset:26624
    buffer_load_dwordx4 v18, s[28:31], s65 offen offset:1024 lds
    v_mfma_f32_16x16x32_bf16 v[220:223], a[236:239], a[220:223], v[220:223]
    ds_read_b64_tr_b16 v[64:65], v15 offset:16384
    v_mfma_f32_16x16x32_bf16 v[220:223], a[252:255], a[216:219], v[220:223]
    s_waitcnt lgkmcnt(6)
    ds_read_b128 v[92:95], v7 offset:39168
    v_mfma_f32_16x16x32_bf16 v[236:239], a[252:255], v[80:83], v[236:239]
    ds_read_b64_tr_b16 v[66:67], v15 offset:24576
    v_mfma_f32_16x16x32_bf16 v[236:239], a[236:239], v[84:87], v[236:239]
    ds_read_b64_tr_b16 v[68:69], v16 offset:16384
    buffer_load_dwordx4 v17, s[32:35], s65 offen offset:2048 lds
    v_mfma_f32_16x16x32_bf16 v[232:235], a[232:235], v[84:87], v[232:235]
    v_mfma_f32_16x16x32_bf16 v[232:235], a[248:251], v[80:83], v[232:235]
    ds_read_b64_tr_b16 v[70:71], v16 offset:24576
    v_mfma_f32_16x16x32_bf16 v[228:231], a[244:247], v[80:83], v[228:231]
    ds_read_b128 a[216:219], v4 offset:41472
    v_mfma_f32_16x16x32_bf16 v[228:231], a[228:231], v[84:87], v[228:231]
    ds_read_b64_tr_b16 v[72:73], v15 offset:18432
    buffer_load_dwordx4 v18, s[32:35], s65 offen offset:3072 lds
    v_mfma_f32_16x16x32_bf16 v[224:227], a[224:227], v[84:87], v[224:227]
    ds_read_b64_tr_b16 v[74:75], v15 offset:26624
    v_mfma_f32_16x16x32_bf16 v[224:227], a[240:243], v[80:83], v[224:227]
    s_waitcnt lgkmcnt(6)
    ds_read_b128 a[220:223], v5 offset:41472
    v_mfma_f32_16x16x32_bf16 v[240:243], a[240:243], v[88:91], v[240:243]
    ds_read_b64_tr_b16 v[76:77], v16 offset:18432
    v_mfma_f32_16x16x32_bf16 v[240:243], a[224:227], v[92:95], v[240:243]
    buffer_load_dwordx4 a[32:35], v2, s[40:43], s66 offen offset:0 sc1
    v_mfma_f32_16x16x32_bf16 v[244:247], a[228:231], v[92:95], v[244:247]
    ds_read_b64_tr_b16 v[78:79], v16 offset:26624
    v_mfma_f32_16x16x32_bf16 v[244:247], a[244:247], v[88:91], v[244:247]
    v_mfma_f32_16x16x32_bf16 v[248:251], a[248:251], v[88:91], v[248:251]
    ds_read_b128 v[80:83], v4 offset:43520
    v_mfma_f32_16x16x32_bf16 v[248:251], a[232:235], v[92:95], v[248:251]
    buffer_load_dwordx4 a[36:39], v2, s[40:43], s66 offen offset:1024 sc1
    v_mfma_f32_16x16x32_bf16 v[252:255], a[236:239], v[92:95], v[252:255]
    v_mfma_f32_16x16x32_bf16 v[252:255], a[252:255], v[88:91], v[252:255]
    s_waitcnt lgkmcnt(1)
    ds_read_b128 v[84:87], v5 offset:43520
    v_mfma_f32_16x16x32_bf16 v[108:111], v[60:63], a[216:219], v[108:111]
    v_mfma_f32_16x16x32_bf16 v[108:111], v[76:79], a[220:223], v[108:111]
    buffer_load_dwordx4 a[40:43], v2, s[40:43], s66 offen offset:2048 sc1
    v_mfma_f32_16x16x32_bf16 v[104:107], v[72:75], a[220:223], v[104:107]
    v_mfma_f32_16x16x32_bf16 v[104:107], v[56:59], a[216:219], v[104:107]
    s_waitcnt vmcnt(10)
    v_cmp_eq_u32 vcc, 0, v20
    s_cbranch_vccnz F_SPIN_T
F_BACK_T:
    v_mfma_f32_16x16x32_bf16 v[100:103], v[52:55], a[216:219], v[100:103]
    ds_read_b128 v[88:91], v4 offset:45568
    buffer_load_dwordx4 v[24:27], v21, s[40:43], 0 offen sc1
    v_mfma_f32_16x16x32_bf16 v[100:103], v[68:71], a[220:223], v[100:103]
    v_add_u32 v23, 127744, v23
    v_mfma_f32_16x16x32_bf16 v[96:99], v[64:67], a[220:223], v[96:99]
    v_mfma_f32_16x16x32_bf16 v[96:99], v[48:51], a[216:219], v[96:99]
    s_waitcnt lgkmcnt(1)
    ds_read_b128 v[92:95], v5 offset:45568
    v_mfma_f32_16x16x32_bf16 v[112:115], v[48:51], v[80:83], v[112:115]
    v_mfma_f32_16x16x32_bf16 v[112:115], v[64:67], v[84:87], v[112:115]
    v_mfma_f32_16x16x32_bf16 v[116:119], v[68:71], v[84:87], v[116:119]
    v_mfma_f32_16x16x32_bf16 v[116:119], v[52:55], v[80:83], v[116:119]
    v_mfma_f32_16x16x32_bf16 v[120:123], v[56:59], v[80:83], v[120:123]
    ds_read_b128 a[216:219], v4 offset:47616
    v_mfma_f32_16x16x32_bf16 v[120:123], v[72:75], v[84:87], v[120:123]
    v_mfma_f32_16x16x32_bf16 v[124:127], v[76:79], v[84:87], v[124:127]
    buffer_load_dwordx4 a[44:47], v2, s[40:43], s66 offen offset:3072 sc1
    s_add_u32 s66, s66, 4096
    v_mfma_f32_16x16x32_bf16 v[124:127], v[60:63], v[80:83], v[124:127]
    s_waitcnt lgkmcnt(1)
    ds_read_b128 a[220:223], v5 offset:47616
    v_mfma_f32_16x16x32_bf16 v[140:143], v[60:63], v[88:91], v[140:143]
    v_mfma_f32_16x16x32_bf16 v[140:143], v[76:79], v[92:95], v[140:143]
    v_mfma_f32_16x16x32_bf16 v[136:139], v[72:75], v[92:95], v[136:139]
    v_mfma_f32_16x16x32_bf16 v[136:139], v[56:59], v[88:91], v[136:139]
    v_mfma_f32_16x16x32_bf16 v[132:135], v[52:55], v[88:91], v[132:135]
    ds_read_b128 v[80:83], v4 offset:49664
    v_mfma_f32_16x16x32_bf16 v[132:135], v[68:71], v[92:95], v[132:135]
    v_mfma_f32_16x16x32_bf16 v[128:131], v[64:67], v[92:95], v[128:131]
    v_mfma_f32_16x16x32_bf16 v[128:131], v[48:51], v[88:91], v[128:131]
    s_waitcnt lgkmcnt(1)
    ds_read_b128 v[84:87], v5 offset:49664
    buffer_load_dwordx4 a[48:51], v2, s[40:43], s66 offen offset:0 sc1
    v_mfma_f32_16x16x32_bf16 v[144:147], v[48:51], a[216:219], v[144:147]
    v_mfma_f32_16x16x32_bf16 v[144:147], v[64:67], a[220:223], v[144:147]
    v_mfma_f32_16x16x32_bf16 v[148:151], v[68:71], a[220:223], v[148:151]
    v_mfma_f32_16x16x32_bf16 v[148:151], v[52:55], a[216:219], v[148:151]
    v_mfma_f32_16x16x32_bf16 v[152:155], v[56:59], a[216:219], v[152:155]
    ds_read_b128 v[88:91], v4 offset:51712
    v_mfma_f32_16x16x32_bf16 v[152:155], v[72:75], a[220:223], v[152:155]
    v_mfma_f32_16x16x32_bf16 v[156:159], v[76:79], a[220:223], v[156:159]
    v_mfma_f32_16x16x32_bf16 v[156:159], v[60:63], a[216:219], v[156:159]
    s_waitcnt lgkmcnt(1)
    ds_read_b128 v[92:95], v5 offset:51712
    v_mfma_f32_16x16x32_bf16 v[172:175], v[60:63], v[80:83], v[172:175]
    buffer_load_dwordx4 a[52:55], v2, s[40:43], s66 offen offset:1024 sc1
    v_mfma_f32_16x16x32_bf16 v[172:175], v[76:79], v[84:87], v[172:175]
    v_mfma_f32_16x16x32_bf16 v[168:171], v[72:75], v[84:87], v[168:171]
    v_mfma_f32_16x16x32_bf16 v[168:171], v[56:59], v[80:83], v[168:171]
    v_mfma_f32_16x16x32_bf16 v[164:167], v[52:55], v[80:83], v[164:167]
    ds_read_b128 a[216:219], v4 offset:53760
    buffer_load_dwordx4 a[56:59], v2, s[40:43], s66 offen offset:2048 sc1
    v_mfma_f32_16x16x32_bf16 v[164:167], v[68:71], v[84:87], v[164:167]
    s_xor_b32 s66, s82, 1
    s_mul_i32 s66, s66, 15360
    v_mfma_f32_16x16x32_bf16 v[160:163], v[64:67], v[84:87], v[160:163]
    s_add_u32 s66, s66, s83
    v_mfma_f32_16x16x32_bf16 v[160:163], v[48:51], v[80:83], v[160:163]
    s_waitcnt lgkmcnt(1)
    ds_read_b128 a[220:223], v5 offset:53760
    v_mfma_f32_16x16x32_bf16 v[176:179], v[48:51], v[88:91], v[176:179]
    v_mfma_f32_16x16x32_bf16 v[176:179], v[64:67], v[92:95], v[176:179]
    v_mfma_f32_16x16x32_bf16 v[180:183], v[68:71], v[92:95], v[180:183]
    v_mfma_f32_16x16x32_bf16 v[180:183], v[52:55], v[88:91], v[180:183]
    v_mfma_f32_16x16x32_bf16 v[184:187], v[56:59], v[88:91], v[184:187]
    ds_read_b128 v[80:83], v4 offset:55808
    v_mfma_f32_16x16x32_bf16 v[184:187], v[72:75], v[92:95], v[184:187]
    buffer_load_dwordx4 a[60:63], v2, s[40:43], s66 offen offset:0 sc1
    v_mfma_f32_16x16x32_bf16 v[188:191], v[76:79], v[92:95], v[188:191]
    v_mfma_f32_16x16x32_bf16 v[188:191], v[60:63], v[88:91], v[188:191]
    s_waitcnt lgkmcnt(1)
    ds_read_b128 v[84:87], v5 offset:55808
    v_mfma_f32_16x16x32_bf16 v[204:207], v[60:63], a[216:219], v[204:207]
    s_waitcnt vmcnt(9)
    s_barrier
    v_mfma_f32_16x16x32_bf16 v[204:207], v[76:79], a[220:223], v[204:207]
    ds_read_b64_tr_b16 a[240:241], v8 offset:32768
    v_mfma_f32_16x16x32_bf16 v[200:203], v[72:75], a[220:223], v[200:203]
    ds_read_b64_tr_b16 a[242:243], v8 offset:40960
    v_mfma_f32_16x16x32_bf16 v[200:203], v[56:59], a[216:219], v[200:203]
    v_mfma_f32_16x16x32_bf16 v[196:199], v[52:55], a[216:219], v[196:199]
    ds_read_b128 v[88:91], v4 offset:57856
    v_mfma_f32_16x16x32_bf16 v[196:199], v[68:71], a[220:223], v[196:199]
    ds_read_b64_tr_b16 a[244:245], v9 offset:32768
    v_mfma_f32_16x16x32_bf16 v[192:195], v[64:67], a[220:223], v[192:195]
    ds_read_b64_tr_b16 a[246:247], v9 offset:40960
    buffer_load_dwordx4 a[64:67], v2, s[40:43], s66 offen offset:1024 sc1
    v_mfma_f32_16x16x32_bf16 v[192:195], v[48:51], a[216:219], v[192:195]
    s_waitcnt lgkmcnt(5)
    ds_read_b128 v[92:95], v5 offset:57856
    v_mfma_f32_16x16x32_bf16 v[208:211], v[48:51], v[80:83], v[208:211]
    ds_read_b64_tr_b16 a[248:249], v8 offset:34816
    v_mfma_f32_16x16x32_bf16 v[208:211], v[64:67], v[84:87], v[208:211]
    ds_read_b64_tr_b16 a[250:251], v8 offset:43008
    v_mfma_f32_16x16x32_bf16 v[212:215], v[68:71], v[84:87], v[212:215]
    v_mfma_f32_16x16x32_bf16 v[212:215], v[52:55], v[80:83], v[212:215]
    ds_read_b64_tr_b16 a[252:253], v9 offset:34816
    v_mfma_f32_16x16x32_bf16 v[216:219], v[56:59], v[80:83], v[216:219]
    ds_read_b128 a[216:219], v6 offset:59904
    v_mfma_f32_16x16x32_bf16 v[216:219], v[72:75], v[84:87], v[216:219]
    ds_read_b64_tr_b16 a[254:255], v9 offset:43008
    v_mfma_f32_16x16x32_bf16 v[220:223], v[76:79], v[84:87], v[220:223]
    s_waitcnt vmcnt(6)
    ds_read_b64_tr_b16 a[224:225], v8 offset:49152
    v_mfma_f32_16x16x32_bf16 v[220:223], v[60:63], v[80:83], v[220:223]
    s_waitcnt lgkmcnt(6)
    ds_read_b128 a[220:223], v7 offset:59904
    buffer_load_dwordx4 a[68:71], v2, s[40:43], s66 offen offset:2048 sc1
    v_mfma_f32_16x16x32_bf16 v[236:239], v[60:63], v[88:91], v[236:239]
    ds_read_b64_tr_b16 a[226:227], v8 offset:57344
    v_mfma_f32_16x16x32_bf16 v[236:239], v[76:79], v[92:95], v[236:239]
    ds_read_b64_tr_b16 a[228:229], v9 offset:49152
    v_mfma_f32_16x16x32_bf16 v[232:235], v[72:75], v[92:95], v[232:235]
    ds_write_b128 v23, v[24:27] offset:32768
    v_mfma_f32_16x16x32_bf16 v[232:235], v[56:59], v[88:91], v[232:235]
    ds_read_b64_tr_b16 a[230:231], v9 offset:57344
    v_bfe_u32 v28, v1, 3, 1
    v_mfma_f32_16x16x32_bf16 v[228:231], v[52:55], v[88:91], v[228:231]
    ds_read_b128 v[80:83], v6 offset:18432
    v_and_b32 v29, 7, v1
    v_mfma_f32_16x16x32_bf16 v[228:231], v[68:71], v[92:95], v[228:231]
    ds_read_b64_tr_b16 a[232:233], v8 offset:51200
    v_lshrrev_b32 v30, 4, v1
    v_mfma_f32_16x16x32_bf16 v[224:227], v[64:67], v[92:95], v[224:227]
    s_lshl_b32 s71, s58, 2
    ds_read_b64_tr_b16 a[234:235], v8 offset:59392
    s_add_u32 s71, s71, s56
    v_mfma_f32_16x16x32_bf16 v[224:227], v[48:51], v[88:91], v[224:227]
    s_waitcnt lgkmcnt(7)
    ds_read_b128 v[84:87], v7 offset:18432
    s_lshl_b32 s71, s71, 9
    v_mfma_f32_16x16x32_bf16 v[240:243], v[48:51], a[216:219], v[240:243]
    ds_read_b64_tr_b16 a[236:237], v9 offset:51200
    buffer_load_dwordx4 a[72:75], v2, s[40:43], s66 offen offset:3072 sc1
    v_mfma_f32_16x16x32_bf16 v[240:243], v[64:67], a[220:223], v[240:243]
    s_add_u32 s66, s66, 4096
    v_lshl_add_u32 v30, v30, 7, s71
    v_and_b32 v31, 15, v1
    v_mfma_f32_16x16x32_bf16 v[244:247], v[68:71], a[220:223], v[244:247]
    ds_read_b64_tr_b16 a[238:239], v9 offset:59392
    v_lshlrev_b32 v14, 4, v31
    v_mfma_f32_16x16x32_bf16 v[244:247], v[52:55], a[216:219], v[244:247]
    v_add_u32 v14, 127744, v14
    v_add_u32 v31, s80, v31
    v_mfma_f32_16x16x32_bf16 v[248:251], v[56:59], a[216:219], v[248:251]
    ds_read_b128 v[88:91], v4 offset:0
    buffer_load_dwordx4 a[76:79], v2, s[40:43], s66 offen offset:0 sc1
    v_mfma_f32_16x16x32_bf16 v[248:251], v[72:75], a[220:223], v[248:251]
    v_lshrrev_b32 v32, 3, v31
    v_mul_u32_u24 v32, 34816, v32
    v_mfma_f32_16x16x32_bf16 v[252:255], v[76:79], a[220:223], v[252:255]
    v_lshl_add_u32 v32, v29, 4, v32
    v_add_u32 v12, v32, v30
    v_mfma_f32_16x16x32_bf16 v[252:255], v[60:63], a[216:219], v[252:255]
    s_waitcnt lgkmcnt(1)
    ds_read_b128 v[92:95], v5 offset:0
    v_cmp_le_u32 vcc, s79, v29
    v_mfma_f32_16x16x32_bf16 v[252:255], a[252:255], v[80:83], v[252:255]
    buffer_load_dwordx4 a[80:83], v2, s[40:43], s66 offen offset:1024 sc1
    v_mfma_f32_16x16x32_bf16 v[252:255], a[236:239], v[84:87], v[252:255]
    v_mov_b32 v33, 152
    v_add_u32 v31, 144, v31
    v_mfma_f32_16x16x32_bf16 v[248:251], a[232:235], v[84:87], v[248:251]
    s_barrier
    v_cndmask_b32 v33, 0, v33, vcc
    v_mfma_f32_16x16x32_bf16 v[248:251], a[248:251], v[80:83], v[248:251]
    v_add3_u32 v33, v33, s78, v29
    v_cmp_eq_u32 vcc, 1, v28
    v_mfma_f32_16x16x32_bf16 v[244:247], a[244:247], v[80:83], v[244:247]
    ds_read_b128 a[216:219], v4 offset:2048
    buffer_load_dwordx4 a[84:87], v2, s[40:43], s66 offen offset:2048 sc1
    v_mfma_f32_16x16x32_bf16 v[244:247], a[228:231], v[84:87], v[244:247]
    v_and_b32 v32, 14, v1
    v_add_u32 v32, 2, v32
    v_mfma_f32_16x16x32_bf16 v[240:243], a[224:227], v[84:87], v[240:243]
    v_cndmask_b32 v31, v31, v33, vcc
    v_lshrrev_b32 v32, 4, v32
    v_mfma_f32_16x16x32_bf16 v[240:243], a[240:243], v[80:83], v[240:243]
    s_waitcnt lgkmcnt(1)
    ds_read_b128 a[220:223], v5 offset:2048
    v_lshl_add_u32 v30, v32, 30, v30
    v_mfma_f32_16x16x32_bf16 v[96:99], a[240:243], v[88:91], v[96:99]
    buffer_load_dwordx4 a[88:91], v2, s[40:43], s66 offen offset:3072 sc1
    s_add_u32 s66, s66, 4096
    v_mfma_f32_16x16x32_bf16 v[96:99], a[224:227], v[92:95], v[96:99]
    v_lshrrev_b32 v32, 3, v31
    v_mul_u32_u24 v32, 34816, v32
    v_mfma_f32_16x16x32_bf16 v[100:103], a[228:231], v[92:95], v[100:103]
    v_and_b32 v33, 7, v31
    v_lshl_add_u32 v32, v33, 4, v32
    v_mfma_f32_16x16x32_bf16 v[100:103], a[244:247], v[88:91], v[100:103]
    v_add_u32 v13, v32, v30
    v_mov_b32_dpp v48, v240 row_newbcast:15 row_mask:0xf bank_mask:0xf
    v_mfma_f32_16x16x32_bf16 v[104:107], a[248:251], v[88:91], v[104:107]
    s_mov_b32 s70, 0
    ds_read_b128 v[80:83], v4 offset:4096
    buffer_load_dwordx4 a[92:95], v2, s[40:43], s66 offen offset:0 sc1
    v_mfma_f32_16x16x32_bf16 v[104:107], a[232:235], v[92:95], v[104:107]
    ds_read_b128 v[20:23], v14 offset:32768
    v_mov_b32_dpp v49, v241 row_newbcast:15 row_mask:0xf bank_mask:0xf
    v_mfma_f32_16x16x32_bf16 v[108:111], a[236:239], v[92:95], v[108:111]
    ds_read_b128 v[24:27], v14 offset:33024
    v_mov_b32_dpp v50, v242 row_newbcast:15 row_mask:0xf bank_mask:0xf
    v_mfma_f32_16x16x32_bf16 v[108:111], a[252:255], v[88:91], v[108:111]
    s_waitcnt lgkmcnt(3)
    ds_read_b128 v[84:87], v5 offset:4096
    v_mov_b32_dpp v51, v243 row_newbcast:15 row_mask:0xf bank_mask:0xf
    v_mfma_f32_16x16x32_bf16 v[124:127], a[252:255], a[216:219], v[124:127]
    ds_read_b128 v[28:31], v14 offset:33280
    buffer_load_dwordx4 a[96:99], v2, s[40:43], s66 offen offset:1024 sc1
    v_mfma_f32_16x16x32_bf16 v[124:127], a[236:239], a[220:223], v[124:127]
    ds_read_b128 v[32:35], v14 offset:33536
    v_mov_b32_dpp v52, v244 row_newbcast:15 row_mask:0xf bank_mask:0xf
    v_mfma_f32_16x16x32_bf16 v[120:123], a[232:235], a[220:223], v[120:123]
    ds_read_b128 v[36:39], v14 offset:33792
    v_mov_b32_dpp v53, v245 row_newbcast:15 row_mask:0xf bank_mask:0xf
    v_mfma_f32_16x16x32_bf16 v[120:123], a[248:251], a[216:219], v[120:123]
    v_mov_b32_dpp v54, v246 row_newbcast:15 row_mask:0xf bank_mask:0xf
    v_mov_b32_dpp v55, v247 row_newbcast:15 row_mask:0xf bank_mask:0xf
    v_mfma_f32_16x16x32_bf16 v[116:119], a[244:247], a[216:219], v[116:119]
    ds_read_b128 v[88:91], v4 offset:6144
    buffer_load_dwordx4 a[100:103], v2, s[40:43], s66 offen offset:2048 sc1
    v_mfma_f32_16x16x32_bf16 v[116:119], a[228:231], a[220:223], v[116:119]
    v_mov_b32_dpp v56, v248 row_newbcast:15 row_mask:0xf bank_mask:0xf
    v_mov_b32_dpp v57, v249 row_newbcast:15 row_mask:0xf bank_mask:0xf
    v_mfma_f32_16x16x32_bf16 v[112:115], a[224:227], a[220:223], v[112:115]
    v_mov_b32_dpp v58, v250 row_newbcast:15 row_mask:0xf bank_mask:0xf
    v_mov_b32_dpp v59, v251 row_newbcast:15 row_mask:0xf bank_mask:0xf
    v_mfma_f32_16x16x32_bf16 v[112:115], a[240:243], a[216:219], v[112:115]
    s_waitcnt lgkmcnt(4)
    ds_read_b128 v[92:95], v5 offset:6144
    v_mov_b32_dpp v60, v252 row_newbcast:15 row_mask:0xf bank_mask:0xf
    v_mfma_f32_16x16x32_bf16 v[128:131], a[240:243], v[80:83], v[128:131]
    buffer_load_dwordx4 a[104:107], v2, s[40:43], s66 offen offset:3072 sc1
    s_add_u32 s66, s66, 4096
    v_mfma_f32_16x16x32_bf16 v[128:131], a[224:227], v[84:87], v[128:131]
    v_mov_b32_dpp v61, v253 row_newbcast:15 row_mask:0xf bank_mask:0xf
    v_mov_b32_dpp v62, v254 row_newbcast:15 row_mask:0xf bank_mask:0xf
    v_mfma_f32_16x16x32_bf16 v[132:135], a[228:231], v[84:87], v[132:135]
    v_mov_b32_dpp v63, v255 row_newbcast:15 row_mask:0xf bank_mask:0xf
    v_mfma_f32_16x16x32_bf16 v[132:135], a[244:247], v[80:83], v[132:135]
    v_fmac_f32 v96, v48, v21
    v_fmac_f32 v97, v49, v21
    v_mfma_f32_16x16x32_bf16 v[136:139], a[248:251], v[80:83], v[136:139]
    ds_read_b128 a[216:219], v4 offset:8192
    buffer_load_dwordx4 a[108:111], v2, s[40:43], s66 offen offset:0 sc1
    v_mfma_f32_16x16x32_bf16 v[136:139], a[232:235], v[84:87], v[136:139]
    v_mul_f32 v40, v96, v22
    v_mul_f32 v41, v97, v22
    v_mfma_f32_16x16x32_bf16 v[140:143], a[236:239], v[84:87], v[140:143]
    v_fmac_f32 v98, v50, v21
    v_fmac_f32 v99, v51, v21
    v_mfma_f32_16x16x32_bf16 v[140:143], a[252:255], v[80:83], v[140:143]
    s_waitcnt lgkmcnt(1)
    ds_read_b128 a[220:223], v5 offset:8192
    v_mul_f32 v42, v98, v22
    v_mfma_f32_16x16x32_bf16 v[156:159], a[252:255], v[88:91], v[156:159]
    buffer_load_dwordx4 a[112:115], v2, s[40:43], s66 offen offset:1024 sc1
    v_mfma_f32_16x16x32_bf16 v[156:159], a[236:239], v[92:95], v[156:159]
    v_mul_f32 v43, v99, v22
    v_fmac_f32 v100, v52, v21
    v_mfma_f32_16x16x32_bf16 v[152:155], a[232:235], v[92:95], v[152:155]
    v_fmac_f32 v101, v53, v21
    v_mul_f32 v44, v100, v22
    v_mfma_f32_16x16x32_bf16 v[152:155], a[248:251], v[88:91], v[152:155]
    v_mul_f32 v45, v101, v22
    v_fmac_f32 v102, v54, v21
    v_mfma_f32_16x16x32_bf16 v[148:151], a[244:247], v[88:91], v[148:151]
    ds_read_b128 v[80:83], v4 offset:10240
    buffer_load_dwordx4 a[116:119], v2, s[40:43], s66 offen offset:2048 sc1
    v_mfma_f32_16x16x32_bf16 v[148:151], a[228:231], v[92:95], v[148:151]
    s_xor_b32 s66, s82, 2
    v_fmac_f32 v103, v55, v21
    v_mul_f32 v46, v102, v22
    v_mfma_f32_16x16x32_bf16 v[144:147], a[224:227], v[92:95], v[144:147]
    s_mul_i32 s66, s66, 15360
    v_mul_f32 v47, v103, v22
    s_add_u32 s66, s66, s83
    v_mfma_f32_16x16x32_bf16 v[144:147], a[240:243], v[88:91], v[144:147]
    s_waitcnt lgkmcnt(1)
    ds_read_b128 v[84:87], v5 offset:10240
    v_mfma_f32_16x16x32_bf16 v[160:163], a[240:243], a[216:219], v[160:163]
    buffer_load_dwordx4 a[120:123], v2, s[40:43], s66 offen offset:0 sc1
    v_mfma_f32_16x16x32_bf16 v[160:163], a[224:227], a[220:223], v[160:163]
    v_exp_f32 v40, v40
    v_mfma_f32_16x16x32_bf16 v[164:167], a[228:231], a[220:223], v[164:167]
    v_fmac_f32 v104, v56, v21
    v_fmac_f32 v105, v57, v21
    v_mfma_f32_16x16x32_bf16 v[164:167], a[244:247], a[216:219], v[164:167]
    v_exp_f32 v41, v41
    v_mfma_f32_16x16x32_bf16 v[168:171], a[248:251], a[216:219], v[168:171]
    ds_read_b128 v[88:91], v4 offset:12288
    buffer_load_dwordx4 a[124:127], v2, s[40:43], s66 offen offset:1024 sc1
    v_mfma_f32_16x16x32_bf16 v[168:171], a[232:235], a[220:223], v[168:171]
    v_mul_f32 v96, v96, v104
    v_mul_f32 v97, v97, v105
    v_mfma_f32_16x16x32_bf16 v[172:175], a[236:239], a[220:223], v[172:175]
    v_exp_f32 v42, v42
    v_mfma_f32_16x16x32_bf16 v[172:175], a[252:255], a[216:219], v[172:175]
    s_waitcnt lgkmcnt(1)
    ds_read_b128 v[92:95], v5 offset:12288
    v_fmac_f32 v106, v58, v21
    v_mfma_f32_16x16x32_bf16 v[188:191], a[252:255], v[80:83], v[188:191]
    buffer_load_dwordx4 a[128:131], v2, s[40:43], s66 offen offset:2048 sc1
    v_mfma_f32_16x16x32_bf16 v[188:191], a[236:239], v[84:87], v[188:191]
    v_fmac_f32 v107, v59, v21
    v_fma_f32 v40, v40, v23, v23
    v_mfma_f32_16x16x32_bf16 v[184:187], a[232:235], v[84:87], v[184:187]
    v_fma_f32 v41, v41, v23, v23
    v_mfma_f32_16x16x32_bf16 v[184:187], a[248:251], v[80:83], v[184:187]
    v_exp_f32 v43, v43
    v_mfma_f32_16x16x32_bf16 v[180:183], a[244:247], v[80:83], v[180:183]
    ds_read_b128 a[216:219], v4 offset:14336
    buffer_load_dwordx4 a[132:135], v2, s[40:43], s66 offen offset:3072 sc1
    v_mfma_f32_16x16x32_bf16 v[180:183], a[228:231], v[84:87], v[180:183]
    s_add_u32 s66, s66, 4096
    v_mul_f32 v98, v98, v106
    v_mul_f32 v99, v99, v107
    v_mfma_f32_16x16x32_bf16 v[176:179], a[224:227], v[84:87], v[176:179]
    v_exp_f32 v44, v44
    v_mfma_f32_16x16x32_bf16 v[176:179], a[240:243], v[80:83], v[176:179]
    s_waitcnt lgkmcnt(1)
    ds_read_b128 a[220:223], v5 offset:14336
    v_fmac_f32 v108, v60, v21
    v_mfma_f32_16x16x32_bf16 v[192:195], a[240:243], v[88:91], v[192:195]
    buffer_load_dwordx4 a[136:139], v2, s[40:43], s66 offen offset:0 sc1
    v_mfma_f32_16x16x32_bf16 v[192:195], a[224:227], v[92:95], v[192:195]
    v_fmac_f32 v109, v61, v21
    v_fma_f32 v42, v42, v23, v23
    v_mfma_f32_16x16x32_bf16 v[196:199], a[228:231], v[92:95], v[196:199]
    v_fma_f32 v43, v43, v23, v23
    v_mfma_f32_16x16x32_bf16 v[196:199], a[244:247], v[88:91], v[196:199]
    v_exp_f32 v45, v45
    v_mfma_f32_16x16x32_bf16 v[200:203], a[248:251], v[88:91], v[200:203]
    ds_read_b128 v[80:83], v4 offset:16384
    buffer_load_dwordx4 a[140:143], v2, s[40:43], s66 offen offset:1024 sc1
    v_mfma_f32_16x16x32_bf16 v[200:203], a[232:235], v[92:95], v[200:203]
    v_mul_f32 v100, v100, v108
    v_mul_f32 v101, v101, v109
    v_mfma_f32_16x16x32_bf16 v[204:207], a[236:239], v[92:95], v[204:207]
    v_exp_f32 v46, v46
    v_mfma_f32_16x16x32_bf16 v[204:207], a[252:255], v[88:91], v[204:207]
    s_waitcnt lgkmcnt(1)
    ds_read_b128 v[84:87], v5 offset:16384
    v_fmac_f32 v110, v62, v21
    v_mfma_f32_16x16x32_bf16 v[220:223], a[252:255], a[216:219], v[220:223]
    buffer_load_dwordx4 a[144:147], v2, s[40:43], s66 offen offset:2048 sc1
    v_mfma_f32_16x16x32_bf16 v[220:223], a[236:239], a[220:223], v[220:223]
    v_fmac_f32 v111, v63, v21
    v_fma_f32 v44, v44, v23, v23
    v_mfma_f32_16x16x32_bf16 v[216:219], a[232:235], a[220:223], v[216:219]
    v_fma_f32 v45, v45, v23, v23
    v_mfma_f32_16x16x32_bf16 v[216:219], a[248:251], a[216:219], v[216:219]
    v_exp_f32 v47, v47
    v_mfma_f32_16x16x32_bf16 v[212:215], a[244:247], a[216:219], v[212:215]
    buffer_load_dwordx4 a[148:151], v2, s[40:43], s66 offen offset:3072 sc1
    s_add_u32 s66, s66, 4096
    v_mfma_f32_16x16x32_bf16 v[212:215], a[228:231], a[220:223], v[212:215]
    v_mul_f32 v102, v102, v110
    v_mul_f32 v103, v103, v111
    v_mfma_f32_16x16x32_bf16 v[208:211], a[224:227], a[220:223], v[208:211]
    v_rcp_f32 v40, v40
    v_mfma_f32_16x16x32_bf16 v[208:211], a[240:243], a[216:219], v[208:211]
    s_waitcnt lgkmcnt(0)
    v_fma_f32 v46, v46, v23, v23
    v_fma_f32 v47, v47, v23, v23
    v_mfma_f32_16x16x32_bf16 v[224:227], a[240:243], v[80:83], v[224:227]
    buffer_load_dwordx4 a[152:155], v2, s[40:43], s66 offen offset:0 sc1
    v_mfma_f32_16x16x32_bf16 v[224:227], a[224:227], v[84:87], v[224:227]
    v_fmac_f32 v112, v48, v25
    v_fmac_f32 v113, v49, v25
    v_mfma_f32_16x16x32_bf16 v[228:231], a[228:231], v[84:87], v[228:231]
    v_rcp_f32 v41, v41
    v_mfma_f32_16x16x32_bf16 v[228:231], a[244:247], v[80:83], v[228:231]
    v_mul_f32 v64, v112, v26
    v_mul_f32 v65, v113, v26
    v_mfma_f32_16x16x32_bf16 v[232:235], a[248:251], v[80:83], v[232:235]
    buffer_load_dwordx4 a[156:159], v2, s[40:43], s66 offen offset:1024 sc1
    v_mfma_f32_16x16x32_bf16 v[232:235], a[232:235], v[84:87], v[232:235]
    v_rcp_f32 v42, v42
    v_mfma_f32_16x16x32_bf16 v[236:239], a[236:239], v[84:87], v[236:239]
    v_fmac_f32 v114, v50, v25
    v_fmac_f32 v115, v51, v25
    v_mfma_f32_16x16x32_bf16 v[236:239], a[252:255], v[80:83], v[236:239]
    v_mul_f32 v96, v96, v40
    v_mul_f32 v97, v97, v41
    v_rcp_f32 v43, v43
    v_pk_mul_f32 v[66:67], v[114:115], v[26:27] op_sel_hi:[1,0]
    v_cvt_pk_bf16_f32 v72, v96, v97
    v_rcp_f32 v44, v44
    v_pk_fma_f32 v[116:117], v[52:53], v[24:25], v[116:117] op_sel:[0,1,0]
    v_pk_mul_f32 v[98:99], v[98:99], v[42:43]
    v_rcp_f32 v45, v45
    v_pk_mul_f32 v[68:69], v[116:117], v[26:27] op_sel_hi:[1,0]
    v_cvt_pk_bf16_f32 v73, v98, v99
    v_rcp_f32 v46, v46
    v_pk_fma_f32 v[118:119], v[54:55], v[24:25], v[118:119] op_sel:[0,1,0]
    v_pk_mul_f32 v[100:101], v[100:101], v[44:45]
    v_rcp_f32 v47, v47
    v_pk_mul_f32 v[70:71], v[118:119], v[26:27] op_sel_hi:[1,0]
    v_cvt_pk_bf16_f32 v74, v100, v101
    v_pk_mul_f32 v[102:103], v[102:103], v[46:47]
    v_cvt_pk_bf16_f32 v75, v102, v103
    buffer_store_dwordx4 v[72:75], v12, s[36:39], s70 offen sc1
    ds_read_b128 v[20:23], v14 offset:34048
    buffer_load_dwordx4 a[160:163], v2, s[40:43], s66 offen offset:2048 sc1
    v_exp_f32 v64, v64
    v_pk_fma_f32 v[120:121], v[56:57], v[24:25], v[120:121] op_sel:[0,1,0]
    v_exp_f32 v65, v65
    v_pk_mul_f32 v[112:113], v[112:113], v[120:121]
    v_exp_f32 v66, v66
    v_pk_fma_f32 v[122:123], v[58:59], v[24:25], v[122:123] op_sel:[0,1,0]
    v_pk_fma_f32 v[64:65], v[64:65], v[26:27], v[26:27] op_sel:[0,1,1]
    v_exp_f32 v67, v67
    v_pk_mul_f32 v[114:115], v[114:115], v[122:123]
    v_exp_f32 v68, v68
    v_pk_fma_f32 v[124:125], v[60:61], v[24:25], v[124:125] op_sel:[0,1,0]
    v_pk_fma_f32 v[66:67], v[66:67], v[26:27], v[26:27] op_sel:[0,1,1]
    v_exp_f32 v69, v69
    v_pk_mul_f32 v[116:117], v[116:117], v[124:125]
    v_exp_f32 v70, v70
    v_pk_fma_f32 v[126:127], v[62:63], v[24:25], v[126:127] op_sel:[0,1,0]
    v_pk_fma_f32 v[68:69], v[68:69], v[26:27], v[26:27] op_sel:[0,1,1]
    v_exp_f32 v71, v71
    v_pk_mul_f32 v[118:119], v[118:119], v[126:127]
    v_rcp_f32 v64, v64
    v_pk_fma_f32 v[70:71], v[70:71], v[26:27], v[26:27] op_sel:[0,1,1]
    v_pk_fma_f32 v[128:129], v[48:49], v[28:29], v[128:129] op_sel:[0,1,0]
    v_rcp_f32 v65, v65
    v_pk_mul_f32 v[40:41], v[128:129], v[30:31] op_sel_hi:[1,0]
    v_rcp_f32 v66, v66
    v_pk_fma_f32 v[130:131], v[50:51], v[28:29], v[130:131] op_sel:[0,1,0]
    v_pk_mul_f32 v[112:113], v[112:113], v[64:65]
    v_rcp_f32 v67, v67
    v_pk_mul_f32 v[42:43], v[130:131], v[30:31] op_sel_hi:[1,0]
    v_cvt_pk_bf16_f32 v76, v112, v113
    v_rcp_f32 v68, v68
    v_pk_fma_f32 v[132:133], v[52:53], v[28:29], v[132:133] op_sel:[0,1,0]
    v_pk_mul_f32 v[114:115], v[114:115], v[66:67]
    v_rcp_f32 v69, v69
    v_pk_mul_f32 v[44:45], v[132:133], v[30:31] op_sel_hi:[1,0]
    v_cvt_pk_bf16_f32 v77, v114, v115
    v_rcp_f32 v70, v70
    v_pk_fma_f32 v[134:135], v[54:55], v[28:29], v[134:135] op_sel:[0,1,0]
    v_pk_mul_f32 v[116:117], v[116:117], v[68:69]
    v_rcp_f32 v71, v71
    v_pk_mul_f32 v[46:47], v[134:135], v[30:31] op_sel_hi:[1,0]
    v_cvt_pk_bf16_f32 v78, v116, v117
    v_pk_mul_f32 v[118:119], v[118:119], v[70:71]
    v_cvt_pk_bf16_f32 v79, v118, v119
    s_add_u32 s70, s70, 69632
    buffer_store_dwordx4 v[76:79], v12, s[36:39], s70 offen sc1
    ds_read_b128 v[24:27], v14 offset:34304
    buffer_load_dwordx4 a[164:167], v2, s[40:43], s66 offen offset:3072 sc1
    v_exp_f32 v40, v40
    v_pk_fma_f32 v[136:137], v[56:57], v[28:29], v[136:137] op_sel:[0,1,0]
    v_exp_f32 v41, v41
    v_pk_mul_f32 v[128:129], v[128:129], v[136:137]
    v_exp_f32 v42, v42
    v_pk_fma_f32 v[138:139], v[58:59], v[28:29], v[138:139] op_sel:[0,1,0]
    v_pk_fma_f32 v[40:41], v[40:41], v[30:31], v[30:31] op_sel:[0,1,1]
    v_exp_f32 v43, v43
    v_pk_mul_f32 v[130:131], v[130:131], v[138:139]
    v_exp_f32 v44, v44
    v_pk_fma_f32 v[140:141], v[60:61], v[28:29], v[140:141] op_sel:[0,1,0]
    v_pk_fma_f32 v[42:43], v[42:43], v[30:31], v[30:31] op_sel:[0,1,1]
    v_exp_f32 v45, v45
    v_pk_mul_f32 v[132:133], v[132:133], v[140:141]
    v_exp_f32 v46, v46
    v_pk_fma_f32 v[142:143], v[62:63], v[28:29], v[142:143] op_sel:[0,1,0]
    v_pk_fma_f32 v[44:45], v[44:45], v[30:31], v[30:31] op_sel:[0,1,1]
    v_exp_f32 v47, v47
    v_pk_mul_f32 v[134:135], v[134:135], v[142:143]
    v_rcp_f32 v40, v40
    v_pk_fma_f32 v[46:47], v[46:47], v[30:31], v[30:31] op_sel:[0,1,1]
    v_pk_fma_f32 v[144:145], v[48:49], v[32:33], v[144:145] op_sel:[0,1,0]
    v_rcp_f32 v41, v41
    v_pk_mul_f32 v[64:65], v[144:145], v[34:35] op_sel_hi:[1,0]
    v_rcp_f32 v42, v42
    v_pk_fma_f32 v[146:147], v[50:51], v[32:33], v[146:147] op_sel:[0,1,0]
    v_pk_mul_f32 v[128:129], v[128:129], v[40:41]
    v_rcp_f32 v43, v43
    v_pk_mul_f32 v[66:67], v[146:147], v[34:35] op_sel_hi:[1,0]
    v_cvt_pk_bf16_f32 v72, v128, v129
    v_rcp_f32 v44, v44
    v_pk_fma_f32 v[148:149], v[52:53], v[32:33], v[148:149] op_sel:[0,1,0]
    v_pk_mul_f32 v[130:131], v[130:131], v[42:43]
    v_rcp_f32 v45, v45
    v_pk_mul_f32 v[68:69], v[148:149], v[34:35] op_sel_hi:[1,0]
    v_cvt_pk_bf16_f32 v73, v130, v131
    v_rcp_f32 v46, v46
    v_pk_fma_f32 v[150:151], v[54:55], v[32:33], v[150:151] op_sel:[0,1,0]
    v_pk_mul_f32 v[132:133], v[132:133], v[44:45]
    v_rcp_f32 v47, v47
    v_pk_mul_f32 v[70:71], v[150:151], v[34:35] op_sel_hi:[1,0]
    v_cvt_pk_bf16_f32 v74, v132, v133
    v_pk_mul_f32 v[134:135], v[134:135], v[46:47]
    v_cvt_pk_bf16_f32 v75, v134, v135
    s_add_u32 s70, s70, 69632
    buffer_store_dwordx4 v[72:75], v12, s[36:39], s70 offen sc1
    ds_read_b128 v[28:31], v14 offset:34560
    s_add_u32 s66, s66, 4096
    buffer_load_dwordx4 a[168:171], v2, s[40:43], s66 offen offset:0 sc1
    v_exp_f32 v64, v64
    v_pk_fma_f32 v[152:153], v[56:57], v[32:33], v[152:153] op_sel:[0,1,0]
    v_exp_f32 v65, v65
    v_pk_mul_f32 v[144:145], v[144:145], v[152:153]
    v_exp_f32 v66, v66
    v_pk_fma_f32 v[154:155], v[58:59], v[32:33], v[154:155] op_sel:[0,1,0]
    v_pk_fma_f32 v[64:65], v[64:65], v[34:35], v[34:35] op_sel:[0,1,1]
    v_exp_f32 v67, v67
    v_pk_mul_f32 v[146:147], v[146:147], v[154:155]
    v_exp_f32 v68, v68
    v_pk_fma_f32 v[156:157], v[60:61], v[32:33], v[156:157] op_sel:[0,1,0]
    v_pk_fma_f32 v[66:67], v[66:67], v[34:35], v[34:35] op_sel:[0,1,1]
    v_exp_f32 v69, v69
    v_pk_mul_f32 v[148:149], v[148:149], v[156:157]
    v_exp_f32 v70, v70
    v_pk_fma_f32 v[158:159], v[62:63], v[32:33], v[158:159] op_sel:[0,1,0]
    v_pk_fma_f32 v[68:69], v[68:69], v[34:35], v[34:35] op_sel:[0,1,1]
    v_exp_f32 v71, v71
    v_pk_mul_f32 v[150:151], v[150:151], v[158:159]
    v_rcp_f32 v64, v64
    v_pk_fma_f32 v[70:71], v[70:71], v[34:35], v[34:35] op_sel:[0,1,1]
    v_pk_fma_f32 v[160:161], v[48:49], v[36:37], v[160:161] op_sel:[0,1,0]
    v_rcp_f32 v65, v65
    v_pk_mul_f32 v[40:41], v[160:161], v[38:39] op_sel_hi:[1,0]
    v_rcp_f32 v66, v66
    v_pk_fma_f32 v[162:163], v[50:51], v[36:37], v[162:163] op_sel:[0,1,0]
    v_pk_mul_f32 v[144:145], v[144:145], v[64:65]
    v_rcp_f32 v67, v67
    v_pk_mul_f32 v[42:43], v[162:163], v[38:39] op_sel_hi:[1,0]
    v_cvt_pk_bf16_f32 v76, v144, v145
    v_rcp_f32 v68, v68
    v_pk_fma_f32 v[164:165], v[52:53], v[36:37], v[164:165] op_sel:[0,1,0]
    v_pk_mul_f32 v[146:147], v[146:147], v[66:67]
    v_rcp_f32 v69, v69
    v_pk_mul_f32 v[44:45], v[164:165], v[38:39] op_sel_hi:[1,0]
    v_cvt_pk_bf16_f32 v77, v146, v147
    v_rcp_f32 v70, v70
    v_pk_fma_f32 v[166:167], v[54:55], v[36:37], v[166:167] op_sel:[0,1,0]
F_PG4:
    s_cbranch_execz F_TRET
    v_pk_mul_f32 v[148:149], v[148:149], v[68:69]
    v_rcp_f32 v71, v71
    v_pk_mul_f32 v[46:47], v[166:167], v[38:39] op_sel_hi:[1,0]
    v_cvt_pk_bf16_f32 v78, v148, v149
    v_pk_mul_f32 v[150:151], v[150:151], v[70:71]
    v_cvt_pk_bf16_f32 v79, v150, v151
    s_add_u32 s70, s70, 69632
    buffer_store_dwordx4 v[76:79], v12, s[36:39], s70 offen sc1
    ds_read_b128 v[32:35], v14 offset:34816
    buffer_load_dwordx4 a[172:175], v2, s[40:43], s66 offen offset:1024 sc1
    v_exp_f32 v40, v40
    v_pk_fma_f32 v[168:169], v[56:57], v[36:37], v[168:169] op_sel:[0,1,0]
    v_exp_f32 v41, v41
    v_pk_mul_f32 v[160:161], v[160:161], v[168:169]
    v_exp_f32 v42, v42
    v_pk_fma_f32 v[170:171], v[58:59], v[36:37], v[170:171] op_sel:[0,1,0]
    v_pk_fma_f32 v[40:41], v[40:41], v[38:39], v[38:39] op_sel:[0,1,1]
    v_exp_f32 v43, v43
    v_pk_mul_f32 v[162:163], v[162:163], v[170:171]
    v_exp_f32 v44, v44
    v_pk_fma_f32 v[172:173], v[60:61], v[36:37], v[172:173] op_sel:[0,1,0]
    v_pk_fma_f32 v[42:43], v[42:43], v[38:39], v[38:39] op_sel:[0,1,1]
    v_exp_f32 v45, v45
    v_pk_mul_f32 v[164:165], v[164:165], v[172:173]
    v_exp_f32 v46, v46
    v_pk_fma_f32 v[174:175], v[62:63], v[36:37], v[174:175] op_sel:[0,1,0]
    v_pk_fma_f32 v[44:45], v[44:45], v[38:39], v[38:39] op_sel:[0,1,1]
    v_exp_f32 v47, v47
    v_pk_mul_f32 v[166:167], v[166:167], v[174:175]
    s_waitcnt lgkmcnt(3)
    v_rcp_f32 v40, v40
    v_pk_fma_f32 v[46:47], v[46:47], v[38:39], v[38:39] op_sel:[0,1,1]
    v_pk_fma_f32 v[176:177], v[48:49], v[20:21], v[176:177] op_sel:[0,1,0]
    v_rcp_f32 v41, v41
    v_pk_mul_f32 v[64:65], v[176:177], v[22:23] op_sel_hi:[1,0]
    v_rcp_f32 v42, v42
    v_pk_fma_f32 v[178:179], v[50:51], v[20:21], v[178:179] op_sel:[0,1,0]
    v_pk_mul_f32 v[160:161], v[160:161], v[40:41]
    v_rcp_f32 v43, v43
    v_pk_mul_f32 v[66:67], v[178:179], v[22:23] op_sel_hi:[1,0]
    v_cvt_pk_bf16_f32 v72, v160, v161
    v_rcp_f32 v44, v44
    v_pk_fma_f32 v[180:181], v[52:53], v[20:21], v[180:181] op_sel:[0,1,0]
    v_pk_mul_f32 v[162:163], v[162:163], v[42:43]
    v_rcp_f32 v45, v45
    v_pk_mul_f32 v[68:69], v[180:181], v[22:23] op_sel_hi:[1,0]
    v_cvt_pk_bf16_f32 v73, v162, v163
    v_rcp_f32 v46, v46
    v_pk_fma_f32 v[182:183], v[54:55], v[20:21], v[182:183] op_sel:[0,1,0]
    v_pk_mul_f32 v[164:165], v[164:165], v[44:45]
    v_rcp_f32 v47, v47
    v_pk_mul_f32 v[70:71], v[182:183], v[22:23] op_sel_hi:[1,0]
    v_cvt_pk_bf16_f32 v74, v164, v165
    v_pk_mul_f32 v[166:167], v[166:167], v[46:47]
    v_cvt_pk_bf16_f32 v75, v166, v167
    s_add_u32 s70, s70, 69632
    buffer_store_dwordx4 v[72:75], v12, s[36:39], s70 offen sc1
    ds_read_b128 v[36:39], v14 offset:35072
    buffer_load_dwordx4 a[176:179], v2, s[40:43], s66 offen offset:2048 sc1
    v_exp_f32 v64, v64
    v_pk_fma_f32 v[184:185], v[56:57], v[20:21], v[184:185] op_sel:[0,1,0]
    v_exp_f32 v65, v65
    v_pk_mul_f32 v[176:177], v[176:177], v[184:185]
    v_exp_f32 v66, v66
    v_pk_fma_f32 v[186:187], v[58:59], v[20:21], v[186:187] op_sel:[0,1,0]
    v_pk_fma_f32 v[64:65], v[64:65], v[22:23], v[22:23] op_sel:[0,1,1]
    v_exp_f32 v67, v67
    v_pk_mul_f32 v[178:179], v[178:179], v[186:187]
    v_exp_f32 v68, v68
    v_pk_fma_f32 v[188:189], v[60:61], v[20:21], v[188:189] op_sel:[0,1,0]
    v_pk_fma_f32 v[66:67], v[66:67], v[22:23], v[22:23] op_sel:[0,1,1]
    v_exp_f32 v69, v69
    v_pk_mul_f32 v[180:181], v[180:181], v[188:189]
    v_exp_f32 v70, v70
    v_pk_fma_f32 v[190:191], v[62:63], v[20:21], v[190:191] op_sel:[0,1,0]
    v_pk_fma_f32 v[68:69], v[68:69], v[22:23], v[22:23] op_sel:[0,1,1]
    v_exp_f32 v71, v71
    v_pk_mul_f32 v[182:183], v[182:183], v[190:191]
    s_waitcnt lgkmcnt(3)
    v_rcp_f32 v64, v64
    v_pk_fma_f32 v[70:71], v[70:71], v[22:23], v[22:23] op_sel:[0,1,1]
    v_pk_fma_f32 v[192:193], v[48:49], v[24:25], v[192:193] op_sel:[0,1,0]
    v_rcp_f32 v65, v65
    v_pk_mul_f32 v[40:41], v[192:193], v[26:27] op_sel_hi:[1,0]
    v_rcp_f32 v66, v66
    v_pk_fma_f32 v[194:195], v[50:51], v[24:25], v[194:195] op_sel:[0,1,0]
    v_pk_mul_f32 v[176:177], v[176:177], v[64:65]
    v_rcp_f32 v67, v67
    v_pk_mul_f32 v[42:43], v[194:195], v[26:27] op_sel_hi:[1,0]
    v_cvt_pk_bf16_f32 v76, v176, v177
    v_rcp_f32 v68, v68
    v_pk_fma_f32 v[196:197], v[52:53], v[24:25], v[196:197] op_sel:[0,1,0]
    v_pk_mul_f32 v[178:179], v[178:179], v[66:67]
    v_rcp_f32 v69, v69
    v_pk_mul_f32 v[44:45], v[196:197], v[26:27] op_sel_hi:[1,0]
    v_cvt_pk_bf16_f32 v77, v178, v179
    v_rcp_f32 v70, v70
    v_pk_fma_f32 v[198:199], v[54:55], v[24:25], v[198:199] op_sel:[0,1,0]
    v_pk_mul_f32 v[180:181], v[180:181], v[68:69]
    v_rcp_f32 v71, v71
    v_pk_mul_f32 v[46:47], v[198:199], v[26:27] op_sel_hi:[1,0]
    v_cvt_pk_bf16_f32 v78, v180, v181
    v_pk_mul_f32 v[182:183], v[182:183], v[70:71]
    v_cvt_pk_bf16_f32 v79, v182, v183
    s_add_u32 s70, s70, 69632
    buffer_store_dwordx4 v[76:79], v12, s[36:39], s70 offen sc1
    s_xor_b32 s66, s82, 3
    s_mul_i32 s66, s66, 15360
    s_add_u32 s66, s66, s83
    buffer_load_dwordx4 a[180:183], v2, s[40:43], s66 offen offset:0 sc1
    v_exp_f32 v40, v40
    v_pk_fma_f32 v[200:201], v[56:57], v[24:25], v[200:201] op_sel:[0,1,0]
    v_exp_f32 v41, v41
    v_pk_mul_f32 v[192:193], v[192:193], v[200:201]
    v_exp_f32 v42, v42
    v_pk_fma_f32 v[202:203], v[58:59], v[24:25], v[202:203] op_sel:[0,1,0]
    v_pk_fma_f32 v[40:41], v[40:41], v[26:27], v[26:27] op_sel:[0,1,1]
    v_exp_f32 v43, v43
    v_pk_mul_f32 v[194:195], v[194:195], v[202:203]
    v_exp_f32 v44, v44
    v_pk_fma_f32 v[204:205], v[60:61], v[24:25], v[204:205] op_sel:[0,1,0]
    v_pk_fma_f32 v[42:43], v[42:43], v[26:27], v[26:27] op_sel:[0,1,1]
    v_exp_f32 v45, v45
    v_pk_mul_f32 v[196:197], v[196:197], v[204:205]
    v_exp_f32 v46, v46
    v_pk_fma_f32 v[206:207], v[62:63], v[24:25], v[206:207] op_sel:[0,1,0]
    v_pk_fma_f32 v[44:45], v[44:45], v[26:27], v[26:27] op_sel:[0,1,1]
    v_exp_f32 v47, v47
    v_pk_mul_f32 v[198:199], v[198:199], v[206:207]
    s_waitcnt lgkmcnt(2)
    v_rcp_f32 v40, v40
    v_pk_fma_f32 v[46:47], v[46:47], v[26:27], v[26:27] op_sel:[0,1,1]
    v_pk_fma_f32 v[208:209], v[48:49], v[28:29], v[208:209] op_sel:[0,1,0]
    v_rcp_f32 v41, v41
    v_pk_mul_f32 v[64:65], v[208:209], v[30:31] op_sel_hi:[1,0]
    v_rcp_f32 v42, v42
    v_pk_fma_f32 v[210:211], v[50:51], v[28:29], v[210:211] op_sel:[0,1,0]
    v_pk_mul_f32 v[192:193], v[192:193], v[40:41]
    v_rcp_f32 v43, v43
    v_pk_mul_f32 v[66:67], v[210:211], v[30:31] op_sel_hi:[1,0]
    v_cvt_pk_bf16_f32 v72, v192, v193
    v_rcp_f32 v44, v44
    v_pk_fma_f32 v[212:213], v[52:53], v[28:29], v[212:213] op_sel:[0,1,0]
    v_pk_mul_f32 v[194:195], v[194:195], v[42:43]
    v_rcp_f32 v45, v45
    v_pk_mul_f32 v[68:69], v[212:213], v[30:31] op_sel_hi:[1,0]
    v_cvt_pk_bf16_f32 v73, v194, v195
    v_rcp_f32 v46, v46
    v_pk_fma_f32 v[214:215], v[54:55], v[28:29], v[214:215] op_sel:[0,1,0]
    v_pk_mul_f32 v[196:197], v[196:197], v[44:45]
    v_rcp_f32 v47, v47
    v_pk_mul_f32 v[70:71], v[214:215], v[30:31] op_sel_hi:[1,0]
    v_cvt_pk_bf16_f32 v74, v196, v197
    v_pk_mul_f32 v[198:199], v[198:199], v[46:47]
    v_cvt_pk_bf16_f32 v75, v198, v199
    s_add_u32 s70, s70, 69632
    buffer_store_dwordx4 v[72:75], v12, s[36:39], s70 offen sc1
    buffer_load_dwordx4 a[184:187], v2, s[40:43], s66 offen offset:1024 sc1
    v_exp_f32 v64, v64
    v_pk_fma_f32 v[216:217], v[56:57], v[28:29], v[216:217] op_sel:[0,1,0]
    v_exp_f32 v65, v65
    v_pk_mul_f32 v[208:209], v[208:209], v[216:217]
    v_exp_f32 v66, v66
    v_pk_fma_f32 v[218:219], v[58:59], v[28:29], v[218:219] op_sel:[0,1,0]
    v_pk_fma_f32 v[64:65], v[64:65], v[30:31], v[30:31] op_sel:[0,1,1]
    v_exp_f32 v67, v67
    v_pk_mul_f32 v[210:211], v[210:211], v[218:219]
    v_exp_f32 v68, v68
    v_pk_fma_f32 v[220:221], v[60:61], v[28:29], v[220:221] op_sel:[0,1,0]
    v_pk_fma_f32 v[66:67], v[66:67], v[30:31], v[30:31] op_sel:[0,1,1]
    v_exp_f32 v69, v69
    v_pk_mul_f32 v[212:213], v[212:213], v[220:221]
    v_exp_f32 v70, v70
    v_pk_fma_f32 v[222:223], v[62:63], v[28:29], v[222:223] op_sel:[0,1,0]
    v_pk_fma_f32 v[68:69], v[68:69], v[30:31], v[30:31] op_sel:[0,1,1]
    v_exp_f32 v71, v71
    v_pk_mul_f32 v[214:215], v[214:215], v[222:223]
    s_waitcnt lgkmcnt(1)
    v_rcp_f32 v64, v64
    v_pk_fma_f32 v[70:71], v[70:71], v[30:31], v[30:31] op_sel:[0,1,1]
    v_pk_fma_f32 v[224:225], v[48:49], v[32:33], v[224:225] op_sel:[0,1,0]
    v_rcp_f32 v65, v65
    v_pk_mul_f32 v[40:41], v[224:225], v[34:35] op_sel_hi:[1,0]
    v_rcp_f32 v66, v66
    v_pk_fma_f32 v[226:227], v[50:51], v[32:33], v[226:227] op_sel:[0,1,0]
    v_pk_mul_f32 v[208:209], v[208:209], v[64:65]
    v_rcp_f32 v67, v67
    v_pk_mul_f32 v[42:43], v[226:227], v[34:35] op_sel_hi:[1,0]
    v_cvt_pk_bf16_f32 v76, v208, v209
    v_rcp_f32 v68, v68
    v_pk_fma_f32 v[228:229], v[52:53], v[32:33], v[228:229] op_sel:[0,1,0]
    v_pk_mul_f32 v[210:211], v[210:211], v[66:67]
    v_rcp_f32 v69, v69
    v_pk_mul_f32 v[44:45], v[228:229], v[34:35] op_sel_hi:[1,0]
    v_cvt_pk_bf16_f32 v77, v210, v211
    v_rcp_f32 v70, v70
    v_pk_fma_f32 v[230:231], v[54:55], v[32:33], v[230:231] op_sel:[0,1,0]
    v_pk_mul_f32 v[212:213], v[212:213], v[68:69]
    v_rcp_f32 v71, v71
    v_pk_mul_f32 v[46:47], v[230:231], v[34:35] op_sel_hi:[1,0]
    v_cvt_pk_bf16_f32 v78, v212, v213
    v_pk_mul_f32 v[214:215], v[214:215], v[70:71]
    v_cvt_pk_bf16_f32 v79, v214, v215
    s_add_u32 s70, s70, 69632
    buffer_store_dwordx4 v[76:79], v12, s[36:39], s70 offen sc1
    buffer_load_dwordx4 a[188:191], v2, s[40:43], s66 offen offset:2048 sc1
    v_exp_f32 v40, v40
    v_pk_fma_f32 v[232:233], v[56:57], v[32:33], v[232:233] op_sel:[0,1,0]
    v_exp_f32 v41, v41
    v_pk_mul_f32 v[224:225], v[224:225], v[232:233]
    v_exp_f32 v42, v42
    v_pk_fma_f32 v[234:235], v[58:59], v[32:33], v[234:235] op_sel:[0,1,0]
    v_pk_fma_f32 v[40:41], v[40:41], v[34:35], v[34:35] op_sel:[0,1,1]
    v_exp_f32 v43, v43
    v_pk_mul_f32 v[226:227], v[226:227], v[234:235]
    v_exp_f32 v44, v44
    v_pk_fma_f32 v[236:237], v[60:61], v[32:33], v[236:237] op_sel:[0,1,0]
    v_pk_fma_f32 v[42:43], v[42:43], v[34:35], v[34:35] op_sel:[0,1,1]
    v_exp_f32 v45, v45
    v_pk_mul_f32 v[228:229], v[228:229], v[236:237]
    v_exp_f32 v46, v46
    v_pk_fma_f32 v[238:239], v[62:63], v[32:33], v[238:239] op_sel:[0,1,0]
    v_pk_fma_f32 v[44:45], v[44:45], v[34:35], v[34:35] op_sel:[0,1,1]
    v_exp_f32 v47, v47
    v_pk_mul_f32 v[230:231], v[230:231], v[238:239]
    s_waitcnt lgkmcnt(0)
    v_rcp_f32 v40, v40
    v_pk_fma_f32 v[46:47], v[46:47], v[34:35], v[34:35] op_sel:[0,1,1]
    v_pk_fma_f32 v[240:241], v[48:49], v[36:37], v[240:241] op_sel:[0,1,0]
    v_rcp_f32 v41, v41
    v_pk_mul_f32 v[64:65], v[240:241], v[38:39] op_sel_hi:[1,0]
    v_rcp_f32 v42, v42
    v_pk_fma_f32 v[242:243], v[50:51], v[36:37], v[242:243] op_sel:[0,1,0]
    v_pk_mul_f32 v[224:225], v[224:225], v[40:41]
    v_rcp_f32 v43, v43
    v_pk_mul_f32 v[66:67], v[242:243], v[38:39] op_sel_hi:[1,0]
    v_cvt_pk_bf16_f32 v72, v224, v225
    v_rcp_f32 v44, v44
    v_pk_fma_f32 v[244:245], v[52:53], v[36:37], v[244:245] op_sel:[0,1,0]
    v_pk_mul_f32 v[226:227], v[226:227], v[42:43]
    v_rcp_f32 v45, v45
    v_pk_mul_f32 v[68:69], v[244:245], v[38:39] op_sel_hi:[1,0]
    v_cvt_pk_bf16_f32 v73, v226, v227
    v_rcp_f32 v46, v46
    v_pk_fma_f32 v[246:247], v[54:55], v[36:37], v[246:247] op_sel:[0,1,0]
    v_pk_mul_f32 v[228:229], v[228:229], v[44:45]
    v_rcp_f32 v47, v47
    v_pk_mul_f32 v[70:71], v[246:247], v[38:39] op_sel_hi:[1,0]
    v_cvt_pk_bf16_f32 v74, v228, v229
    v_pk_mul_f32 v[230:231], v[230:231], v[46:47]
    v_cvt_pk_bf16_f32 v75, v230, v231
    s_add_u32 s70, s70, 69632
    buffer_store_dwordx4 v[72:75], v12, s[36:39], s70 offen sc1
    buffer_load_dwordx4 a[192:195], v2, s[40:43], s66 offen offset:3072 sc1
    v_exp_f32 v64, v64
    v_pk_fma_f32 v[248:249], v[56:57], v[36:37], v[248:249] op_sel:[0,1,0]
    v_exp_f32 v65, v65
    v_pk_mul_f32 v[240:241], v[240:241], v[248:249]
    v_exp_f32 v66, v66
    v_pk_fma_f32 v[250:251], v[58:59], v[36:37], v[250:251] op_sel:[0,1,0]
    v_pk_fma_f32 v[64:65], v[64:65], v[38:39], v[38:39] op_sel:[0,1,1]
    v_exp_f32 v67, v67
    v_pk_mul_f32 v[242:243], v[242:243], v[250:251]
    v_exp_f32 v68, v68
    v_pk_fma_f32 v[252:253], v[60:61], v[36:37], v[252:253] op_sel:[0,1,0]
    v_pk_fma_f32 v[66:67], v[66:67], v[38:39], v[38:39] op_sel:[0,1,1]
    v_exp_f32 v69, v69
    v_pk_mul_f32 v[244:245], v[244:245], v[252:253]
    v_exp_f32 v70, v70
    v_pk_fma_f32 v[254:255], v[62:63], v[36:37], v[254:255] op_sel:[0,1,0]
    v_pk_fma_f32 v[68:69], v[68:69], v[38:39], v[38:39] op_sel:[0,1,1]
    v_exp_f32 v71, v71
    v_pk_mul_f32 v[246:247], v[246:247], v[254:255]
    v_rcp_f32 v64, v64
    v_pk_fma_f32 v[70:71], v[70:71], v[38:39], v[38:39] op_sel:[0,1,1]
    v_rcp_f32 v65, v65
    v_rcp_f32 v66, v66
    v_pk_mul_f32 v[240:241], v[240:241], v[64:65]
    v_rcp_f32 v67, v67
    v_cvt_pk_bf16_f32 v76, v240, v241
    v_rcp_f32 v68, v68
    v_pk_mul_f32 v[242:243], v[242:243], v[66:67]
    v_rcp_f32 v69, v69
    v_cvt_pk_bf16_f32 v77, v242, v243
    v_rcp_f32 v70, v70
    v_pk_mul_f32 v[244:245], v[244:245], v[68:69]
    v_rcp_f32 v71, v71
    v_cvt_pk_bf16_f32 v78, v244, v245
    v_pk_mul_f32 v[246:247], v[246:247], v[70:71]
    v_cvt_pk_bf16_f32 v79, v246, v247
    buffer_store_dwordx4 v[76:79], v13, s[36:39], 0 offen sc1
    v_lshrrev_b32 v15, 5, v1
    s_add_u32 s66, s66, 4096
    buffer_load_dwordx4 a[196:199], v2, s[40:43], s66 offen offset:0 sc1
    v_mul_u32_u24 v15, 63, v15
    v_lshl_add_u32 v15, s60, 6, v15
    v_mul_u32_u24 v15, 6637, v15
    buffer_load_dwordx4 a[200:203], v2, s[40:43], s66 offen offset:1024 sc1
    v_lshrrev_b32 v15, 20, v15
    v_and_b32 v14, 15, v1
    buffer_load_dwordx4 a[204:207], v2, s[40:43], s66 offen offset:2048 sc1
    v_min_u32 v14, 2, v14
    v_mad_u32_u24 v15, v15, 12, v14
    v_lshl_add_u32 v14, v15, 7, s23
    buffer_load_dwordx4 a[208:211], v2, s[40:43], s66 offen offset:3072 sc1
    v_bfe_u32 v15, v1, 3, 1
    v_mul_u32_u24 v7, 34816, v15
    s_add_u32 s66, s66, 4096
    buffer_load_dwordx4 a[212:215], v2, s[40:43], s66 offen offset:0 sc1
    v_lshrrev_b32 v15, 4, v1
    v_lshl_add_u32 v7, v15, 7, v7
    buffer_load_dwordx4 a[216:219], v2, s[40:43], s66 offen offset:1024 sc1
    v_and_b32 v15, 7, v1
    v_lshl_add_u32 v7, v15, 4, v7
    v_add_u32 v4, s14, v7
    buffer_load_dwordx4 a[220:223], v2, s[40:43], s66 offen offset:2048 sc1
    v_add_u32 v5, s15, v7
    v_add_u32 v6, s16, v7
    buffer_load_dwordx4 a[224:227], v2, s[40:43], s66 offen offset:3072 sc1
    v_add_u32 v7, s17, v7
    v_mov_b32 v12, 1
    s_waitcnt vmcnt(8)
    s_barrier
    buffer_store_dword v12, v3, s[40:43], s69 offen sc1
    s_add_u32 s66, s66, 4096
    buffer_load_dwordx4 a[228:231], v2, s[40:43], s66 offen offset:0 sc1
    buffer_load_dwordx4 a[232:235], v2, s[40:43], s66 offen offset:1024 sc1
    buffer_load_dwordx4 a[236:239], v2, s[40:43], s66 offen offset:2048 sc1
    buffer_load_dwordx4 a[240:243], v2, s[40:43], s67 offen offset:0 sc1
    buffer_load_dwordx4 a[244:247], v2, s[40:43], s67 offen offset:1024 sc1
    buffer_load_dwordx4 a[248:251], v2, s[40:43], s67 offen offset:2048 sc1
    buffer_load_dwordx4 a[252:255], v2, s[40:43], s67 offen offset:3072 sc1
    s_add_u32 s67, s67, 4096
    buffer_load_dwordx4 v[96:99], v2, s[40:43], s67 offen offset:0 sc1
    buffer_load_dwordx4 v[100:103], v2, s[40:43], s67 offen offset:1024 sc1
    buffer_load_dwordx4 v[104:107], v2, s[40:43], s67 offen offset:2048 sc1
    buffer_load_dwordx4 v[108:111], v2, s[40:43], s67 offen offset:3072 sc1
    s_add_u32 s67, s67, 4096
    buffer_load_dwordx4 v[112:115], v2, s[40:43], s67 offen offset:0 sc1
    buffer_load_dword v15, v14, s[40:43], 0 offen sc1
    buffer_load_dwordx4 v[116:119], v2, s[40:43], s67 offen offset:1024 sc1
    buffer_load_dwordx4 v[120:123], v2, s[40:43], s67 offen offset:2048 sc1
    buffer_load_dwordx4 v[124:127], v2, s[40:43], s67 offen offset:3072 sc1
    s_add_u32 s67, s67, 4096
    buffer_load_dwordx4 v[128:131], v2, s[40:43], s67 offen offset:0 sc1
    buffer_load_dwordx4 v[132:135], v2, s[40:43], s67 offen offset:1024 sc1
    buffer_load_dwordx4 v[136:139], v2, s[40:43], s67 offen offset:2048 sc1
    buffer_load_dwordx4 v[140:143], v2, s[40:43], s67 offen offset:3072 sc1
    s_add_u32 s67, s67, 4096
    buffer_load_dwordx4 v[144:147], v2, s[40:43], s67 offen offset:0 sc1
    buffer_load_dwordx4 v[148:151], v2, s[40:43], s67 offen offset:1024 sc1
    buffer_load_dwordx4 v[152:155], v2, s[40:43], s67 offen offset:2048 sc1
    s_waitcnt vmcnt(10)
    v_cmp_eq_u32 vcc, 0, v15
    s_cbranch_vccz F_GO
F_P2:
F_POLL:
    buffer_load_dword v12, v14, s[40:43], 0 offen sc1
    s_waitcnt vmcnt(0)
    v_cmp_eq_u32 vcc, 0, v12
    s_cbranch_vccz F_GO
    s_sub_u32 s68, s68, 1
    s_cbranch_scc0 F_POLL
    s_mov_b32 s68, 0
F_GO:
    buffer_load_dwordx4 v[208:211], v4, s[36:39], s4 offen offset:0 sc1
    buffer_load_dwordx4 v[212:215], v4, s[36:39], s4 offen offset:512 sc1
    buffer_load_dwordx4 v[216:219], v4, s[36:39], s4 offen offset:1024 sc1
    buffer_load_dwordx4 v[220:223], v5, s[36:39], s4 offen offset:0 sc1
    buffer_load_dwordx4 v[224:227], v5, s[36:39], s4 offen offset:512 sc1
    buffer_load_dwordx4 v[228:231], v5, s[36:39], s4 offen offset:1024 sc1
    buffer_load_dwordx4 v[232:235], v6, s[36:39], s4 offen offset:0 sc1
    buffer_load_dwordx4 v[236:239], v6, s[36:39], s4 offen offset:512 sc1
    buffer_load_dwordx4 v[240:243], v6, s[36:39], s4 offen offset:1024 sc1
    buffer_load_dwordx4 v[244:247], v7, s[36:39], s4 offen offset:0 sc1
    buffer_load_dwordx4 v[248:251], v7, s[36:39], s4 offen offset:512 sc1
    buffer_load_dwordx4 v[252:255], v7, s[36:39], s4 offen offset:1024 sc1
    s_waitcnt vmcnt(11)
    v_mfma_f32_16x16x32_bf16 v[16:19], a[0:3], v[208:211], 0
    v_lshlrev_b32 v36, 2, v1
    s_add_u32 s71, s3, 1
    v_mfma_f32_16x16x32_bf16 v[20:23], a[4:7], v[208:211], 0
    s_and_b32 s71, s71, 3
    buffer_load_dwordx4 v[156:159], v2, s[40:43], s67 offen offset:3072 sc1
    s_mul_i32 s72, s71, 15360
    v_mfma_f32_16x16x32_bf16 v[24:27], a[8:11], v[208:211], 0
    v_add_u32 v8, s72, v36
    s_add_u32 s71, s3, 2
    v_mfma_f32_16x16x32_bf16 v[28:31], a[12:15], v[208:211], 0
    s_and_b32 s71, s71, 3
    s_mul_i32 s72, s71, 15360
    v_mfma_f32_16x16x32_bf16 v[32:35], a[16:19], v[208:211], 0
    s_waitcnt vmcnt(11)
    v_add_u32 v9, s72, v36
    s_add_u32 s71, s3, 3
    v_mfma_f32_16x16x32_bf16 v[16:19], a[20:23], v[212:215], v[16:19]
    s_and_b32 s71, s71, 3
    s_mul_i32 s72, s71, 15360
    v_mfma_f32_16x16x32_bf16 v[20:23], a[24:27], v[212:215], v[20:23]
    v_add_u32 v10, s72, v36
    s_add_u32 s71, s3, 4
    v_mfma_f32_16x16x32_bf16 v[24:27], a[28:31], v[212:215], v[24:27]
    s_and_b32 s71, s71, 3
    s_mul_i32 s72, s71, 15360
    v_mfma_f32_16x16x32_bf16 v[28:31], a[32:35], v[212:215], v[28:31]
    v_add_u32 v11, s72, v36
    s_lshl2_add_u32 s71, s60, s71
    v_mfma_f32_16x16x32_bf16 v[32:35], a[36:39], v[212:215], v[32:35]
    s_waitcnt vmcnt(9)
    v_and_b32 v36, 15, v1
    v_lshl_add_u32 v36, s71, 4, v36
    v_mfma_f32_16x16x32_bf16 v[16:19], a[40:43], v[216:219], v[16:19]
    v_bfe_u32 v37, v36, 2, 1
    v_and_or_b32 v37, v36, -8, v37
    v_mfma_f32_16x16x32_bf16 v[16:19], a[60:63], v[220:223], v[16:19]
    v_and_b32 v13, 3, v36
    v_lshl_add_u32 v13, v13, 1, v37
    v_mfma_f32_16x16x32_bf16 v[20:23], a[64:67], v[220:223], v[20:23]
    v_mul_u32_u24 v13, 1280, v13
    s_mul_i32 s72, s61, 160
    v_mfma_f32_16x16x32_bf16 v[20:23], a[44:47], v[216:219], v[20:23]
    v_lshrrev_b32 v36, 4, v1
    v_add_u32 v13, s72, v13
    v_mfma_f32_16x16x32_bf16 v[24:27], a[48:51], v[216:219], v[24:27]
    buffer_load_dwordx4 v[208:211], v4, s[36:39], s5 offen offset:0 sc1
    v_mfma_f32_16x16x32_bf16 v[24:27], a[68:71], v[220:223], v[24:27]
    v_lshl_add_u32 v0, v36, 3, v13
    v_and_b32 v37, 16, v1
    v_mfma_f32_16x16x32_bf16 v[28:31], a[72:75], v[220:223], v[28:31]
    s_add_u32 s67, s67, 4096
    buffer_load_dwordx4 v[160:163], v2, s[40:43], s67 offen offset:0 sc1
    v_mfma_f32_16x16x32_bf16 v[28:31], a[52:55], v[216:219], v[28:31]
    v_lshl_add_u32 v0, v37, 26, v0
    v_lshl_add_u32 v13, v36, 5, v13
    v_mfma_f32_16x16x32_bf16 v[32:35], a[56:59], v[216:219], v[32:35]
    v_and_b32 v37, 1, v1
    v_mul_u32_u24 v37, 2544, v37
    v_mfma_f32_16x16x32_bf16 v[32:35], a[76:79], v[220:223], v[32:35]
    s_waitcnt vmcnt(9)
    buffer_load_dwordx4 v[212:215], v4, s[36:39], s5 offen offset:512 sc1
    v_mfma_f32_16x16x32_bf16 v[16:19], a[80:83], v[224:227], v[16:19]
    v_sub_u32 v13, v13, v37
    s_mul_i32 s71, s56, 256
    v_mfma_f32_16x16x32_bf16 v[16:19], a[100:103], v[228:231], v[16:19]
    s_add_u32 s71, s71, 3232768
    v_lshrrev_b32 v36, 5, v1
    v_mul_u32_u24 v36, 63, v36
    v_mfma_f32_16x16x32_bf16 v[20:23], a[104:107], v[228:231], v[20:23]
    v_lshl_add_u32 v36, s60, 6, v36
    v_mul_u32_u24 v36, 5958, v36
    v_mfma_f32_16x16x32_bf16 v[20:23], a[84:87], v[224:227], v[20:23]
    v_lshrrev_b32 v36, 20, v36
    v_and_b32 v14, 15, v1
    v_mfma_f32_16x16x32_bf16 v[24:27], a[88:91], v[224:227], v[24:27]
    buffer_load_dwordx4 v[216:219], v4, s[36:39], s5 offen offset:1024 sc1
    v_mfma_f32_16x16x32_bf16 v[24:27], a[108:111], v[228:231], v[24:27]
    v_min_u32 v14, 1, v14
    v_mad_u32_u24 v36, v36, 8, v14
    v_mfma_f32_16x16x32_bf16 v[28:31], a[112:115], v[228:231], v[28:31]
    v_lshl_add_u32 v14, v36, 7, s71
    s_mov_b32 s75, 0xbfb8aa3b
    v_mfma_f32_16x16x32_bf16 v[28:31], a[92:95], v[224:227], v[28:31]
    v_mfma_f32_16x16x32_bf16 v[32:35], a[96:99], v[224:227], v[32:35]
    v_mfma_f32_16x16x32_bf16 v[32:35], a[116:119], v[228:231], v[32:35]
    s_waitcnt vmcnt(9)
    buffer_load_dwordx4 v[220:223], v5, s[36:39], s5 offen offset:0 sc1
    v_mfma_f32_16x16x32_bf16 v[16:19], a[120:123], v[232:235], v[16:19]
    v_mfma_f32_16x16x32_bf16 v[16:19], a[140:143], v[236:239], v[16:19]
    buffer_load_dwordx4 v[164:167], v2, s[40:43], s67 offen offset:1024 sc1
    v_mfma_f32_16x16x32_bf16 v[20:23], a[144:147], v[236:239], v[20:23]
    v_mfma_f32_16x16x32_bf16 v[20:23], a[124:127], v[232:235], v[20:23]
    v_mfma_f32_16x16x32_bf16 v[24:27], a[128:131], v[232:235], v[24:27]
    buffer_load_dwordx4 v[224:227], v5, s[36:39], s5 offen offset:512 sc1
    v_mfma_f32_16x16x32_bf16 v[24:27], a[148:151], v[236:239], v[24:27]
    v_mfma_f32_16x16x32_bf16 v[28:31], a[152:155], v[236:239], v[28:31]
    buffer_load_dwordx4 v[180:183], v13, s[24:27], 0 offen
    v_mfma_f32_16x16x32_bf16 v[28:31], a[132:135], v[232:235], v[28:31]
    v_mfma_f32_16x16x32_bf16 v[32:35], a[136:139], v[232:235], v[32:35]
    v_mfma_f32_16x16x32_bf16 v[32:35], a[156:159], v[236:239], v[32:35]
    s_waitcnt vmcnt(11)
    buffer_load_dwordx4 v[228:231], v5, s[36:39], s5 offen offset:1024 sc1
    v_mfma_f32_16x16x32_bf16 v[16:19], a[160:163], v[240:243], v[16:19]
    v_mfma_f32_16x16x32_bf16 v[16:19], a[180:183], v[244:247], v[16:19]
    v_mfma_f32_16x16x32_bf16 v[20:23], a[184:187], v[244:247], v[20:23]
    v_mfma_f32_16x16x32_bf16 v[20:23], a[164:167], v[240:243], v[20:23]
    v_mfma_f32_16x16x32_bf16 v[24:27], a[168:171], v[240:243], v[24:27]
    buffer_load_dwordx4 v[232:235], v6, s[36:39], s5 offen offset:0 sc1
    v_mfma_f32_16x16x32_bf16 v[24:27], a[188:191], v[244:247], v[24:27]
    v_mfma_f32_16x16x32_bf16 v[28:31], a[192:195], v[244:247], v[28:31]
    buffer_load_dwordx4 v[184:187], v13, s[24:27], 0 offen offset:2560
    v_mfma_f32_16x16x32_bf16 v[28:31], a[172:175], v[240:243], v[28:31]
    buffer_load_dwordx4 v[168:171], v2, s[40:43], s67 offen offset:2048 sc1
    v_mfma_f32_16x16x32_bf16 v[32:35], a[176:179], v[240:243], v[32:35]
    v_mfma_f32_16x16x32_bf16 v[32:35], a[196:199], v[244:247], v[32:35]
    s_waitcnt vmcnt(13)
    buffer_load_dwordx4 v[236:239], v6, s[36:39], s5 offen offset:512 sc1
    v_mfma_f32_16x16x32_bf16 v[16:19], a[200:203], v[248:251], v[16:19]
    v_mfma_f32_16x16x32_bf16 v[16:19], a[220:223], v[252:255], v[16:19]
    v_mfma_f32_16x16x32_bf16 v[20:23], a[224:227], v[252:255], v[20:23]
    v_mfma_f32_16x16x32_bf16 v[20:23], a[204:207], v[248:251], v[20:23]
    v_mfma_f32_16x16x32_bf16 v[24:27], a[208:211], v[248:251], v[24:27]
    buffer_load_dwordx4 v[240:243], v6, s[36:39], s5 offen offset:1024 sc1
    v_mfma_f32_16x16x32_bf16 v[24:27], a[228:231], v[252:255], v[24:27]
    v_mfma_f32_16x16x32_bf16 v[28:31], a[232:235], v[252:255], v[28:31]
    buffer_load_dwordx4 v[188:191], v0, s[24:27], 0 offen offset:128
    v_mfma_f32_16x16x32_bf16 v[28:31], a[212:215], v[248:251], v[28:31]
    s_barrier
    v_mfma_f32_16x16x32_bf16 v[32:35], a[216:219], v[248:251], v[32:35]
    v_mfma_f32_16x16x32_bf16 v[32:35], a[236:239], v[252:255], v[32:35]
    s_waitcnt vmcnt(12)
    buffer_load_dwordx4 v[244:247], v7, s[36:39], s5 offen offset:0 sc1
    v_mfma_f32_16x16x32_bf16 v[56:59], a[0:3], v[208:211], 0
    v_mfma_f32_16x16x32_bf16 v[56:59], a[20:23], v[212:215], v[56:59]
    ds_write_b32 v8, v16 offset:0
    v_mfma_f32_16x16x32_bf16 v[60:63], a[24:27], v[212:215], 0
    ds_write_b32 v8, v17 offset:256
    v_mfma_f32_16x16x32_bf16 v[60:63], a[4:7], v[208:211], v[60:63]
    ds_write_b32 v8, v18 offset:512
    v_mfma_f32_16x16x32_bf16 v[64:67], a[8:11], v[208:211], 0
    buffer_load_dwordx4 v[248:251], v7, s[36:39], s5 offen offset:512 sc1
    v_mfma_f32_16x16x32_bf16 v[64:67], a[28:31], v[212:215], v[64:67]
    ds_write_b32 v8, v19 offset:768
    v_mfma_f32_16x16x32_bf16 v[68:71], a[32:35], v[212:215], 0
    ds_write_b32 v8, v20 offset:1024
    v_mfma_f32_16x16x32_bf16 v[68:71], a[12:15], v[208:211], v[68:71]
    ds_write_b32 v8, v21 offset:1280
    v_mfma_f32_16x16x32_bf16 v[72:75], a[16:19], v[208:211], 0
    ds_write_b32 v8, v22 offset:1536
    v_mfma_f32_16x16x32_bf16 v[72:75], a[36:39], v[212:215], v[72:75]
    s_waitcnt vmcnt(12)
    buffer_load_dwordx4 v[252:255], v7, s[36:39], s5 offen offset:1024 sc1
    v_mfma_f32_16x16x32_bf16 v[56:59], a[40:43], v[216:219], v[56:59]
    ds_write_b32 v8, v23 offset:1792
    v_mfma_f32_16x16x32_bf16 v[56:59], a[60:63], v[220:223], v[56:59]
    ds_write_b32 v8, v24 offset:2048
    v_mfma_f32_16x16x32_bf16 v[60:63], a[64:67], v[220:223], v[60:63]
    ds_write_b32 v8, v25 offset:2304
    v_mfma_f32_16x16x32_bf16 v[60:63], a[44:47], v[216:219], v[60:63]
    ds_write_b32 v8, v26 offset:2560
    v_mfma_f32_16x16x32_bf16 v[64:67], a[48:51], v[216:219], v[64:67]
    buffer_load_dwordx4 v[208:211], v4, s[36:39], s6 offen offset:0 sc1
    v_mfma_f32_16x16x32_bf16 v[64:67], a[68:71], v[220:223], v[64:67]
    ds_write_b32 v8, v27 offset:2816
    v_mfma_f32_16x16x32_bf16 v[68:71], a[72:75], v[220:223], v[68:71]
    ds_write_b32 v8, v28 offset:3072
    v_mfma_f32_16x16x32_bf16 v[68:71], a[52:55], v[216:219], v[68:71]
    ds_write_b32 v8, v29 offset:3328
    v_mfma_f32_16x16x32_bf16 v[72:75], a[56:59], v[216:219], v[72:75]
    ds_write_b32 v8, v30 offset:3584
    v_mfma_f32_16x16x32_bf16 v[72:75], a[76:79], v[220:223], v[72:75]
    s_waitcnt vmcnt(10)
    buffer_load_dwordx4 v[212:215], v4, s[36:39], s6 offen offset:512 sc1
    v_mfma_f32_16x16x32_bf16 v[56:59], a[80:83], v[224:227], v[56:59]
    ds_write_b32 v8, v31 offset:3840
    v_mfma_f32_16x16x32_bf16 v[56:59], a[100:103], v[228:231], v[56:59]
    ds_write_b32 v8, v32 offset:4096
    v_mfma_f32_16x16x32_bf16 v[60:63], a[104:107], v[228:231], v[60:63]
    ds_write_b32 v8, v33 offset:4352
    v_mfma_f32_16x16x32_bf16 v[60:63], a[84:87], v[224:227], v[60:63]
    ds_write_b32 v8, v34 offset:4608
    v_mfma_f32_16x16x32_bf16 v[64:67], a[88:91], v[224:227], v[64:67]
    buffer_load_dwordx4 v[216:219], v4, s[36:39], s6 offen offset:1024 sc1
    v_mfma_f32_16x16x32_bf16 v[64:67], a[108:111], v[228:231], v[64:67]
    ds_write_b32 v8, v35 offset:4864
    v_mfma_f32_16x16x32_bf16 v[68:71], a[112:115], v[228:231], v[68:71]
    buffer_load_dwordx4 v[172:175], v2, s[40:43], s67 offen offset:3072 sc1
    s_add_u32 s67, s67, 4096
    v_mfma_f32_16x16x32_bf16 v[68:71], a[92:95], v[224:227], v[68:71]
    buffer_load_dwordx4 v[176:179], v2, s[40:43], s67 offen offset:0 sc1
    v_mfma_f32_16x16x32_bf16 v[72:75], a[96:99], v[224:227], v[72:75]
    v_mfma_f32_16x16x32_bf16 v[72:75], a[116:119], v[228:231], v[72:75]
    s_waitcnt vmcnt(10)
    buffer_load_dwordx4 v[220:223], v5, s[36:39], s6 offen offset:0 sc1
    v_mfma_f32_16x16x32_bf16 v[56:59], a[120:123], v[232:235], v[56:59]
    s_waitcnt lgkmcnt(0)
    s_barrier
    ds_read2st64_b32 v[16:17], v10 offset0:0 offset1:1
    v_mfma_f32_16x16x32_bf16 v[56:59], a[140:143], v[236:239], v[56:59]
    ds_read2st64_b32 v[18:19], v10 offset0:2 offset1:3
    v_mfma_f32_16x16x32_bf16 v[60:63], a[144:147], v[236:239], v[60:63]
    ds_read2st64_b32 v[20:21], v10 offset0:4 offset1:5
    v_mfma_f32_16x16x32_bf16 v[60:63], a[124:127], v[232:235], v[60:63]
    ds_read2st64_b32 v[22:23], v10 offset0:6 offset1:7
    v_mfma_f32_16x16x32_bf16 v[64:67], a[128:131], v[232:235], v[64:67]
    buffer_load_dwordx4 v[224:227], v5, s[36:39], s6 offen offset:512 sc1
    v_mfma_f32_16x16x32_bf16 v[64:67], a[148:151], v[236:239], v[64:67]
    ds_read2st64_b32 v[24:25], v10 offset0:8 offset1:9
    v_mfma_f32_16x16x32_bf16 v[68:71], a[152:155], v[236:239], v[68:71]
    ds_read2st64_b32 v[26:27], v10 offset0:10 offset1:11
    v_mfma_f32_16x16x32_bf16 v[68:71], a[132:135], v[232:235], v[68:71]
    ds_read2st64_b32 v[28:29], v10 offset0:12 offset1:13
    v_mfma_f32_16x16x32_bf16 v[72:75], a[136:139], v[232:235], v[72:75]
    ds_read2st64_b32 v[30:31], v10 offset0:14 offset1:15
    v_mfma_f32_16x16x32_bf16 v[72:75], a[156:159], v[236:239], v[72:75]
    s_waitcnt vmcnt(9)
    buffer_load_dwordx4 v[228:231], v5, s[36:39], s6 offen offset:1024 sc1
    v_mfma_f32_16x16x32_bf16 v[56:59], a[160:163], v[240:243], v[56:59]
    ds_read2st64_b32 v[32:33], v10 offset0:16 offset1:17
F_PG5:
    s_cbranch_execz F_TRET
    v_mfma_f32_16x16x32_bf16 v[56:59], a[180:183], v[244:247], v[56:59]
    ds_read2st64_b32 v[34:35], v10 offset0:18 offset1:19
    v_mfma_f32_16x16x32_bf16 v[60:63], a[184:187], v[244:247], v[60:63]
    v_mfma_f32_16x16x32_bf16 v[60:63], a[164:167], v[240:243], v[60:63]
    v_mfma_f32_16x16x32_bf16 v[64:67], a[168:171], v[240:243], v[64:67]
    buffer_load_dwordx4 v[232:235], v6, s[36:39], s6 offen offset:0 sc1
    v_mfma_f32_16x16x32_bf16 v[64:67], a[188:191], v[244:247], v[64:67]
    v_mfma_f32_16x16x32_bf16 v[68:71], a[192:195], v[244:247], v[68:71]
    s_mov_b32 vcc_lo, 0x55555555
    v_mfma_f32_16x16x32_bf16 v[68:71], a[172:175], v[240:243], v[68:71]
    s_mov_b32 vcc_hi, 0x55555555
    v_permlane16_swap_b32 v188, v190
    v_permlane16_swap_b32 v189, v191
    v_mfma_f32_16x16x32_bf16 v[72:75], a[176:179], v[240:243], v[72:75]
    v_lshlrev_b32 v196, 16, v188
    v_and_b32 v197, 0xffff0000, v188
    v_mfma_f32_16x16x32_bf16 v[72:75], a[196:199], v[244:247], v[72:75]
    s_waitcnt vmcnt(9)
    buffer_load_dwordx4 v[236:239], v6, s[36:39], s6 offen offset:512 sc1
    v_mfma_f32_16x16x32_bf16 v[56:59], a[200:203], v[248:251], v[56:59]
    v_lshlrev_b32 v198, 16, v189
    v_and_b32 v199, 0xffff0000, v189
    v_mfma_f32_16x16x32_bf16 v[56:59], a[220:223], v[252:255], v[56:59]
    v_cndmask_b32_dpp v188, v184, v180, vcc quad_perm:[1,0,3,2] row_mask:0xf bank_mask:0xf
    v_cndmask_b32_dpp v189, v185, v181, vcc quad_perm:[1,0,3,2] row_mask:0xf bank_mask:0xf
    v_mfma_f32_16x16x32_bf16 v[60:63], a[224:227], v[252:255], v[60:63]
    v_cndmask_b32_dpp v190, v186, v182, vcc quad_perm:[1,0,3,2] row_mask:0xf bank_mask:0xf
    v_cndmask_b32_dpp v191, v187, v183, vcc quad_perm:[1,0,3,2] row_mask:0xf bank_mask:0xf
    v_mfma_f32_16x16x32_bf16 v[60:63], a[204:207], v[248:251], v[60:63]
    s_not_b64 vcc, vcc
    v_cndmask_b32_dpp v192, v180, v184, vcc quad_perm:[1,0,3,2] row_mask:0xf bank_mask:0xf
    v_cndmask_b32_dpp v193, v181, v185, vcc quad_perm:[1,0,3,2] row_mask:0xf bank_mask:0xf
    v_mfma_f32_16x16x32_bf16 v[64:67], a[208:211], v[248:251], v[64:67]
    buffer_load_dwordx4 v[240:243], v6, s[36:39], s6 offen offset:1024 sc1
    v_mfma_f32_16x16x32_bf16 v[64:67], a[228:231], v[252:255], v[64:67]
    v_cndmask_b32_dpp v194, v182, v186, vcc quad_perm:[1,0,3,2] row_mask:0xf bank_mask:0xf
    v_cndmask_b32_dpp v195, v183, v187, vcc quad_perm:[1,0,3,2] row_mask:0xf bank_mask:0xf
    v_mfma_f32_16x16x32_bf16 v[68:71], a[232:235], v[252:255], v[68:71]
    v_lshlrev_b32 v180, 16, v188
    v_and_b32 v181, 0xffff0000, v188
    v_mfma_f32_16x16x32_bf16 v[68:71], a[212:215], v[248:251], v[68:71]
    v_lshlrev_b32 v182, 16, v189
    v_and_b32 v183, 0xffff0000, v189
    v_mfma_f32_16x16x32_bf16 v[72:75], a[216:219], v[248:251], v[72:75]
    v_lshlrev_b32 v184, 16, v190
    v_and_b32 v185, 0xffff0000, v190
    v_mfma_f32_16x16x32_bf16 v[72:75], a[236:239], v[252:255], v[72:75]
    s_waitcnt lgkmcnt(0) vmcnt(9)
    buffer_load_dwordx4 v[244:247], v7, s[36:39], s6 offen offset:0 sc1
    v_mfma_f32_16x16x32_bf16 v[16:19], a[0:3], v[208:211], v[16:19]
    v_lshlrev_b32 v186, 16, v191
    v_and_b32 v187, 0xffff0000, v191
    v_mfma_f32_16x16x32_bf16 v[16:19], a[20:23], v[212:215], v[16:19]
    ds_write_b32 v9, v56 offset:5120
    v_mfma_f32_16x16x32_bf16 v[20:23], a[24:27], v[212:215], v[20:23]
    ds_write_b32 v9, v57 offset:5376
    v_mfma_f32_16x16x32_bf16 v[20:23], a[4:7], v[208:211], v[20:23]
    ds_write_b32 v9, v58 offset:5632
    v_mfma_f32_16x16x32_bf16 v[24:27], a[8:11], v[208:211], v[24:27]
    buffer_load_dwordx4 v[248:251], v7, s[36:39], s6 offen offset:512 sc1
    v_mfma_f32_16x16x32_bf16 v[24:27], a[28:31], v[212:215], v[24:27]
    ds_write_b32 v9, v59 offset:5888
    v_mfma_f32_16x16x32_bf16 v[28:31], a[32:35], v[212:215], v[28:31]
    ds_write_b32 v9, v60 offset:6144
    v_mfma_f32_16x16x32_bf16 v[28:31], a[12:15], v[208:211], v[28:31]
    ds_write_b32 v9, v61 offset:6400
    v_mfma_f32_16x16x32_bf16 v[32:35], a[16:19], v[208:211], v[32:35]
    ds_write_b32 v9, v62 offset:6656
    v_mfma_f32_16x16x32_bf16 v[32:35], a[36:39], v[212:215], v[32:35]
    s_waitcnt vmcnt(7)
    buffer_load_dwordx4 v[252:255], v7, s[36:39], s6 offen offset:1024 sc1
    v_mfma_f32_16x16x32_bf16 v[16:19], a[40:43], v[216:219], v[16:19]
    ds_write_b32 v9, v63 offset:6912
    v_mfma_f32_16x16x32_bf16 v[16:19], a[60:63], v[220:223], v[16:19]
    ds_write_b32 v9, v64 offset:7168
    v_mfma_f32_16x16x32_bf16 v[20:23], a[64:67], v[220:223], v[20:23]
    ds_write_b32 v9, v65 offset:7424
    v_mfma_f32_16x16x32_bf16 v[20:23], a[44:47], v[216:219], v[20:23]
    ds_write_b32 v9, v66 offset:7680
    v_mfma_f32_16x16x32_bf16 v[24:27], a[48:51], v[216:219], v[24:27]
    buffer_load_dwordx4 v[208:211], v4, s[36:39], s7 offen offset:0 sc1
    v_mfma_f32_16x16x32_bf16 v[24:27], a[68:71], v[220:223], v[24:27]
    ds_write_b32 v9, v67 offset:7936
    v_mfma_f32_16x16x32_bf16 v[28:31], a[72:75], v[220:223], v[28:31]
    ds_write_b32 v9, v68 offset:8192
    v_mfma_f32_16x16x32_bf16 v[28:31], a[52:55], v[216:219], v[28:31]
    ds_write_b32 v9, v69 offset:8448
    v_mfma_f32_16x16x32_bf16 v[32:35], a[56:59], v[216:219], v[32:35]
    ds_write_b32 v9, v70 offset:8704
    v_mfma_f32_16x16x32_bf16 v[32:35], a[76:79], v[220:223], v[32:35]
    s_waitcnt vmcnt(7)
    buffer_load_dwordx4 v[212:215], v4, s[36:39], s7 offen offset:512 sc1
    v_mfma_f32_16x16x32_bf16 v[16:19], a[80:83], v[224:227], v[16:19]
    ds_write_b32 v9, v71 offset:8960
    v_mfma_f32_16x16x32_bf16 v[16:19], a[100:103], v[228:231], v[16:19]
    ds_write_b32 v9, v72 offset:9216
    v_mfma_f32_16x16x32_bf16 v[20:23], a[104:107], v[228:231], v[20:23]
    ds_write_b32 v9, v73 offset:9472
    v_mfma_f32_16x16x32_bf16 v[20:23], a[84:87], v[224:227], v[20:23]
    ds_write_b32 v9, v74 offset:9728
    v_mfma_f32_16x16x32_bf16 v[24:27], a[88:91], v[224:227], v[24:27]
    buffer_load_dwordx4 v[216:219], v4, s[36:39], s7 offen offset:1024 sc1
    v_mfma_f32_16x16x32_bf16 v[24:27], a[108:111], v[228:231], v[24:27]
    ds_write_b32 v9, v75 offset:9984
    v_mfma_f32_16x16x32_bf16 v[28:31], a[112:115], v[228:231], v[28:31]
    buffer_load_dword v12, v14, s[40:43], 0 offen sc1
    v_mfma_f32_16x16x32_bf16 v[28:31], a[92:95], v[224:227], v[28:31]
    v_lshlrev_b32 v188, 16, v192
    v_and_b32 v189, 0xffff0000, v192
    v_mfma_f32_16x16x32_bf16 v[32:35], a[96:99], v[224:227], v[32:35]
    v_lshlrev_b32 v190, 16, v193
    v_and_b32 v191, 0xffff0000, v193
    v_mfma_f32_16x16x32_bf16 v[32:35], a[116:119], v[228:231], v[32:35]
    s_waitcnt vmcnt(8)
    buffer_load_dwordx4 v[220:223], v5, s[36:39], s7 offen offset:0 sc1
    v_mfma_f32_16x16x32_bf16 v[16:19], a[120:123], v[232:235], v[16:19]
    s_waitcnt lgkmcnt(0)
    s_barrier
    ds_read2st64_b32 v[56:57], v11 offset0:20 offset1:21
    v_mfma_f32_16x16x32_bf16 v[16:19], a[140:143], v[236:239], v[16:19]
    ds_read2st64_b32 v[58:59], v11 offset0:22 offset1:23
    v_lshlrev_b32 v192, 16, v194
    v_mfma_f32_16x16x32_bf16 v[20:23], a[144:147], v[236:239], v[20:23]
    ds_read2st64_b32 v[60:61], v11 offset0:24 offset1:25
    v_and_b32 v193, 0xffff0000, v194
    v_mfma_f32_16x16x32_bf16 v[20:23], a[124:127], v[232:235], v[20:23]
    ds_read2st64_b32 v[62:63], v11 offset0:26 offset1:27
    v_lshlrev_b32 v194, 16, v195
    v_mfma_f32_16x16x32_bf16 v[24:27], a[128:131], v[232:235], v[24:27]
    buffer_load_dwordx4 v[224:227], v5, s[36:39], s7 offen offset:512 sc1
    v_mfma_f32_16x16x32_bf16 v[24:27], a[148:151], v[236:239], v[24:27]
    ds_read2st64_b32 v[64:65], v11 offset0:28 offset1:29
    v_and_b32 v195, 0xffff0000, v195
    v_mfma_f32_16x16x32_bf16 v[28:31], a[152:155], v[236:239], v[28:31]
    ds_read2st64_b32 v[66:67], v11 offset0:30 offset1:31
    v_mad_u32_u24 v8, v1, 12, v8
    v_mfma_f32_16x16x32_bf16 v[28:31], a[132:135], v[232:235], v[28:31]
    ds_read2st64_b32 v[68:69], v11 offset0:32 offset1:33
    v_mad_u32_u24 v9, v1, 12, v9
    v_mfma_f32_16x16x32_bf16 v[32:35], a[136:139], v[232:235], v[32:35]
    ds_read2st64_b32 v[70:71], v11 offset0:34 offset1:35
    v_mfma_f32_16x16x32_bf16 v[32:35], a[156:159], v[236:239], v[32:35]
    s_waitcnt vmcnt(8)
    buffer_load_dwordx4 v[228:231], v5, s[36:39], s7 offen offset:1024 sc1
    v_mfma_f32_16x16x32_bf16 v[16:19], a[160:163], v[240:243], v[16:19]
    ds_read2st64_b32 v[72:73], v11 offset0:36 offset1:37
    v_mfma_f32_16x16x32_bf16 v[16:19], a[180:183], v[244:247], v[16:19]
    ds_read2st64_b32 v[74:75], v11 offset0:38 offset1:39
    v_mfma_f32_16x16x32_bf16 v[20:23], a[184:187], v[244:247], v[20:23]
    v_mfma_f32_16x16x32_bf16 v[20:23], a[164:167], v[240:243], v[20:23]
    v_mfma_f32_16x16x32_bf16 v[24:27], a[168:171], v[240:243], v[24:27]
    buffer_load_dwordx4 v[232:235], v6, s[36:39], s7 offen offset:0 sc1
    v_mfma_f32_16x16x32_bf16 v[24:27], a[188:191], v[244:247], v[24:27]
    v_mfma_f32_16x16x32_bf16 v[28:31], a[192:195], v[244:247], v[28:31]
    v_mfma_f32_16x16x32_bf16 v[28:31], a[172:175], v[240:243], v[28:31]
    v_mfma_f32_16x16x32_bf16 v[32:35], a[176:179], v[240:243], v[32:35]
    v_mfma_f32_16x16x32_bf16 v[32:35], a[196:199], v[244:247], v[32:35]
    s_waitcnt vmcnt(8)
    buffer_load_dwordx4 v[236:239], v6, s[36:39], s7 offen offset:512 sc1
    v_mfma_f32_16x16x32_bf16 v[16:19], a[200:203], v[248:251], v[16:19]
    v_mfma_f32_16x16x32_bf16 v[16:19], a[220:223], v[252:255], v[16:19]
    v_mfma_f32_16x16x32_bf16 v[20:23], a[224:227], v[252:255], v[20:23]
    v_mfma_f32_16x16x32_bf16 v[20:23], a[204:207], v[248:251], v[20:23]
    v_mfma_f32_16x16x32_bf16 v[24:27], a[208:211], v[248:251], v[24:27]
    buffer_load_dwordx4 v[240:243], v6, s[36:39], s7 offen offset:1024 sc1
    v_mfma_f32_16x16x32_bf16 v[24:27], a[228:231], v[252:255], v[24:27]
    v_mfma_f32_16x16x32_bf16 v[28:31], a[232:235], v[252:255], v[28:31]
    v_mfma_f32_16x16x32_bf16 v[28:31], a[212:215], v[248:251], v[28:31]
    v_mfma_f32_16x16x32_bf16 v[32:35], a[216:219], v[248:251], v[32:35]
    v_mfma_f32_16x16x32_bf16 v[32:35], a[236:239], v[252:255], v[32:35]
    s_waitcnt lgkmcnt(0) vmcnt(8)
    buffer_load_dwordx4 v[244:247], v7, s[36:39], s7 offen offset:0 sc1
    v_mfma_f32_16x16x32_bf16 v[56:59], a[0:3], v[208:211], v[56:59]
    v_mfma_f32_16x16x32_bf16 v[56:59], a[20:23], v[212:215], v[56:59]
    ds_write_b32 v10, v16 offset:10240
    v_mfma_f32_16x16x32_bf16 v[60:63], a[24:27], v[212:215], v[60:63]
    ds_write_b32 v10, v17 offset:10496
    v_mfma_f32_16x16x32_bf16 v[60:63], a[4:7], v[208:211], v[60:63]
    ds_write_b32 v10, v18 offset:10752
    v_mfma_f32_16x16x32_bf16 v[64:67], a[8:11], v[208:211], v[64:67]
    buffer_load_dwordx4 v[248:251], v7, s[36:39], s7 offen offset:512 sc1
    v_mfma_f32_16x16x32_bf16 v[64:67], a[28:31], v[212:215], v[64:67]
    s_waitcnt vmcnt(8)
    ds_write_b32 v10, v19 offset:11008
    v_cmp_eq_u32 vcc, 0, v12
    v_mfma_f32_16x16x32_bf16 v[68:71], a[32:35], v[212:215], v[68:71]
    s_cbranch_vccnz F_SPIN_O
F_BACK_O:
    ds_write_b32 v10, v20 offset:11264
    s_mov_b32 vcc_lo, 0xaaaaaaaa
    v_mfma_f32_16x16x32_bf16 v[68:71], a[12:15], v[208:211], v[68:71]
    s_mov_b32 vcc_hi, 0xaaaaaaaa
    ds_write_b32 v10, v21 offset:11520
    v_mfma_f32_16x16x32_bf16 v[72:75], a[16:19], v[208:211], v[72:75]
    ds_write_b32 v10, v22 offset:11776
    v_mfma_f32_16x16x32_bf16 v[72:75], a[36:39], v[212:215], v[72:75]
    s_waitcnt vmcnt(7)
    buffer_load_dwordx4 v[252:255], v7, s[36:39], s7 offen offset:1024 sc1
    v_mfma_f32_16x16x32_bf16 v[56:59], a[40:43], v[216:219], v[56:59]
    ds_write_b32 v10, v23 offset:12032
    v_mfma_f32_16x16x32_bf16 v[56:59], a[60:63], v[220:223], v[56:59]
    ds_write_b32 v10, v24 offset:12288
    v_mfma_f32_16x16x32_bf16 v[60:63], a[64:67], v[220:223], v[60:63]
    ds_write_b32 v10, v25 offset:12544
    v_mfma_f32_16x16x32_bf16 v[60:63], a[44:47], v[216:219], v[60:63]
    ds_write_b32 v10, v26 offset:12800
    v_mfma_f32_16x16x32_bf16 v[64:67], a[48:51], v[216:219], v[64:67]
    buffer_load_dwordx4 v[208:211], v4, s[36:39], s8 offen offset:0 sc1
    v_mfma_f32_16x16x32_bf16 v[64:67], a[68:71], v[220:223], v[64:67]
    ds_write_b32 v10, v27 offset:13056
    v_mfma_f32_16x16x32_bf16 v[68:71], a[72:75], v[220:223], v[68:71]
    ds_write_b32 v10, v28 offset:13312
    v_mfma_f32_16x16x32_bf16 v[68:71], a[52:55], v[216:219], v[68:71]
    ds_write_b32 v10, v29 offset:13568
    v_mfma_f32_16x16x32_bf16 v[72:75], a[56:59], v[216:219], v[72:75]
    ds_write_b32 v10, v30 offset:13824
    v_mfma_f32_16x16x32_bf16 v[72:75], a[76:79], v[220:223], v[72:75]
    s_waitcnt vmcnt(7)
    buffer_load_dwordx4 v[212:215], v4, s[36:39], s8 offen offset:512 sc1
    v_mfma_f32_16x16x32_bf16 v[56:59], a[80:83], v[224:227], v[56:59]
    ds_write_b32 v10, v31 offset:14080
    v_mfma_f32_16x16x32_bf16 v[56:59], a[100:103], v[228:231], v[56:59]
    ds_write_b32 v10, v32 offset:14336
    v_mfma_f32_16x16x32_bf16 v[60:63], a[104:107], v[228:231], v[60:63]
    ds_write_b32 v10, v33 offset:14592
    v_mfma_f32_16x16x32_bf16 v[60:63], a[84:87], v[224:227], v[60:63]
    ds_write_b32 v10, v34 offset:14848
    v_mfma_f32_16x16x32_bf16 v[64:67], a[88:91], v[224:227], v[64:67]
    buffer_load_dwordx4 v[216:219], v4, s[36:39], s8 offen offset:1024 sc1
    v_mfma_f32_16x16x32_bf16 v[64:67], a[108:111], v[228:231], v[64:67]
    ds_write_b32 v10, v35 offset:15104
    v_mfma_f32_16x16x32_bf16 v[68:71], a[112:115], v[228:231], v[68:71]
    v_mfma_f32_16x16x32_bf16 v[68:71], a[92:95], v[224:227], v[68:71]
    v_mfma_f32_16x16x32_bf16 v[72:75], a[96:99], v[224:227], v[72:75]
    v_mfma_f32_16x16x32_bf16 v[72:75], a[116:119], v[228:231], v[72:75]
    s_waitcnt vmcnt(7)
    buffer_load_dwordx4 v[220:223], v4, s[36:39], s8 offen offset:1536 sc1
    v_mfma_f32_16x16x32_bf16 v[56:59], a[120:123], v[232:235], v[56:59]
    s_waitcnt lgkmcnt(0)
    s_barrier
    ds_read2st64_b32 v[16:17], v11 offset0:40 offset1:41
    v_mfma_f32_16x16x32_bf16 v[56:59], a[140:143], v[236:239], v[56:59]
    ds_read2st64_b32 v[18:19], v11 offset0:42 offset1:43
    v_mad_u32_u24 v10, v1, 12, v10
    v_mfma_f32_16x16x32_bf16 v[60:63], a[144:147], v[236:239], v[60:63]
    ds_read2st64_b32 v[20:21], v11 offset0:44 offset1:45
    v_mfma_f32_16x16x32_bf16 v[60:63], a[124:127], v[232:235], v[60:63]
    ds_read2st64_b32 v[22:23], v11 offset0:46 offset1:47
    v_mfma_f32_16x16x32_bf16 v[64:67], a[128:131], v[232:235], v[64:67]
    buffer_load_dwordx4 v[224:227], v4, s[36:39], s8 offen offset:2048 sc1
    v_mfma_f32_16x16x32_bf16 v[64:67], a[148:151], v[236:239], v[64:67]
    ds_read2st64_b32 v[24:25], v11 offset0:48 offset1:49
    v_mfma_f32_16x16x32_bf16 v[68:71], a[152:155], v[236:239], v[68:71]
    ds_read2st64_b32 v[26:27], v11 offset0:50 offset1:51
    v_mfma_f32_16x16x32_bf16 v[68:71], a[132:135], v[232:235], v[68:71]
    ds_read2st64_b32 v[28:29], v11 offset0:52 offset1:53
    v_mfma_f32_16x16x32_bf16 v[72:75], a[136:139], v[232:235], v[72:75]
    s_waitcnt lgkmcnt(5)
    ds_read2st64_b32 v[30:31], v11 offset0:54 offset1:55
    v_mul_f32 v16, s75, v16
    v_mfma_f32_16x16x32_bf16 v[72:75], a[156:159], v[236:239], v[72:75]
    s_waitcnt vmcnt(7)
    buffer_load_dwordx4 v[228:231], v4, s[36:39], s9 offen offset:0 sc1
    v_mfma_f32_16x16x32_bf16 v[56:59], a[160:163], v[240:243], v[56:59]
    ds_read2st64_b32 v[32:33], v11 offset0:56 offset1:57
    v_mul_f32 v17, s75, v17
    v_mfma_f32_16x16x32_bf16 v[56:59], a[180:183], v[244:247], v[56:59]
    ds_read2st64_b32 v[34:35], v11 offset0:58 offset1:59
    v_mul_f32 v18, s75, v18
    v_mfma_f32_16x16x32_bf16 v[60:63], a[184:187], v[244:247], v[60:63]
    v_mul_f32 v19, s75, v19
    s_waitcnt lgkmcnt(6)
    v_mfma_f32_16x16x32_bf16 v[60:63], a[164:167], v[240:243], v[60:63]
    v_mad_u32_u24 v11, v1, 12, v11
    v_mul_f32 v20, s75, v20
    v_mfma_f32_16x16x32_bf16 v[64:67], a[168:171], v[240:243], v[64:67]
    buffer_load_dwordx4 v[232:235], v4, s[36:39], s9 offen offset:512 sc1
    v_mfma_f32_16x16x32_bf16 v[64:67], a[188:191], v[244:247], v[64:67]
    v_mul_f32 v21, s75, v21
    v_mul_f32 v22, s75, v22
    v_mfma_f32_16x16x32_bf16 v[68:71], a[192:195], v[244:247], v[68:71]
    v_mul_f32 v23, s75, v23
    s_waitcnt lgkmcnt(4)
    v_mfma_f32_16x16x32_bf16 v[68:71], a[172:175], v[240:243], v[68:71]
    v_mul_f32 v24, s75, v24
    v_mul_f32 v25, s75, v25
    v_mfma_f32_16x16x32_bf16 v[72:75], a[176:179], v[240:243], v[72:75]
    v_mul_f32 v26, s75, v26
    v_mul_f32 v27, s75, v27
    v_mfma_f32_16x16x32_bf16 v[72:75], a[196:199], v[244:247], v[72:75]
    s_waitcnt vmcnt(7)
    buffer_load_dwordx4 v[236:239], v4, s[36:39], s9 offen offset:1024 sc1
    s_waitcnt lgkmcnt(2)
    v_mfma_f32_16x16x32_bf16 v[56:59], a[200:203], v[248:251], v[56:59]
    v_mul_f32 v28, s75, v28
    v_mul_f32 v29, s75, v29
    v_mfma_f32_16x16x32_bf16 v[56:59], a[220:223], v[252:255], v[56:59]
    v_mul_f32 v30, s75, v30
    v_mul_f32 v31, s75, v31
    v_mfma_f32_16x16x32_bf16 v[60:63], a[224:227], v[252:255], v[60:63]
    s_waitcnt lgkmcnt(0)
    v_mul_f32 v32, s75, v32
    v_mul_f32 v33, s75, v33
    v_mfma_f32_16x16x32_bf16 v[60:63], a[204:207], v[248:251], v[60:63]
    v_mul_f32 v34, s75, v34
    v_mul_f32 v35, s75, v35
    v_mfma_f32_16x16x32_bf16 v[64:67], a[208:211], v[248:251], v[64:67]
    buffer_load_dwordx4 v[240:243], v4, s[36:39], s9 offen offset:1536 sc1
    v_mfma_f32_16x16x32_bf16 v[64:67], a[228:231], v[252:255], v[64:67]
    v_mfma_f32_16x16x32_bf16 v[68:71], a[232:235], v[252:255], v[68:71]
    v_mfma_f32_16x16x32_bf16 v[68:71], a[212:215], v[248:251], v[68:71]
    v_mfma_f32_16x16x32_bf16 v[72:75], a[216:219], v[248:251], v[72:75]
    v_mfma_f32_16x16x32_bf16 v[72:75], a[236:239], v[252:255], v[72:75]
    s_waitcnt vmcnt(7)
    buffer_load_dwordx4 v[244:247], v4, s[36:39], s9 offen offset:2048 sc1
    v_mfma_f32_16x16x32_bf16 v[36:39], a[240:243], v[208:211], 0
    v_fma_f32 v56, v56, s75, v16
    v_fma_f32 v57, v57, s75, v17
    v_mfma_f32_16x16x32_bf16 v[36:39], v[100:103], v[212:215], v[36:39]
    v_exp_f32 v16, v56
    v_mfma_f32_16x16x32_bf16 v[40:43], v[104:107], v[212:215], 0
    v_exp_f32 v17, v57
    v_mfma_f32_16x16x32_bf16 v[40:43], a[244:247], v[208:211], v[40:43]
    v_fma_f32 v16, v16, s75, s75
    v_fma_f32 v17, v17, s75, s75
    v_mfma_f32_16x16x32_bf16 v[44:47], a[248:251], v[208:211], 0
    buffer_load_dwordx4 v[248:251], v4, s[36:39], s10 offen offset:0 sc1
    v_mfma_f32_16x16x32_bf16 v[44:47], v[108:111], v[212:215], v[44:47]
    v_rcp_f32 v16, v16
    v_mfma_f32_16x16x32_bf16 v[48:51], v[112:115], v[212:215], 0
    v_rcp_f32 v17, v17
    v_mfma_f32_16x16x32_bf16 v[48:51], a[252:255], v[208:211], v[48:51]
    v_mul_f32 v56, v56, v16
    v_mul_f32 v57, v57, v17
    v_mfma_f32_16x16x32_bf16 v[52:55], v[96:99], v[208:211], 0
    v_fma_f32 v60, v60, s75, v20
    v_fma_f32 v61, v61, s75, v21
    v_mfma_f32_16x16x32_bf16 v[52:55], v[116:119], v[212:215], v[52:55]
    s_waitcnt vmcnt(6)
    buffer_load_dwordx4 v[252:255], v4, s[36:39], s10 offen offset:512 sc1
    v_mfma_f32_16x16x32_bf16 v[36:39], v[120:123], v[216:219], v[36:39]
    v_exp_f32 v20, v60
    v_mfma_f32_16x16x32_bf16 v[36:39], v[140:143], v[220:223], v[36:39]
    v_exp_f32 v21, v61
    v_mfma_f32_16x16x32_bf16 v[36:39], v[160:163], v[224:227], v[36:39]
    v_fma_f32 v20, v20, s75, s75
    v_fma_f32 v21, v21, s75, s75
    v_mfma_f32_16x16x32_bf16 v[40:43], v[164:167], v[224:227], v[40:43]
    v_rcp_f32 v20, v20
    v_mfma_f32_16x16x32_bf16 v[40:43], v[144:147], v[220:223], v[40:43]
    buffer_load_dwordx4 v[208:211], v4, s[36:39], s10 offen offset:1024 sc1
    v_mfma_f32_16x16x32_bf16 v[40:43], v[124:127], v[216:219], v[40:43]
    v_rcp_f32 v21, v21
    v_mfma_f32_16x16x32_bf16 v[44:47], v[128:131], v[216:219], v[44:47]
    v_mul_f32 v60, v60, v20
    v_mul_f32 v61, v61, v21
    v_mfma_f32_16x16x32_bf16 v[44:47], v[148:151], v[220:223], v[44:47]
    ds_write_b128 v8, v[36:39] offset:0
    v_mfma_f32_16x16x32_bf16 v[44:47], v[168:171], v[224:227], v[44:47]
    v_fma_f32 v64, v64, s75, v24
    v_fma_f32 v65, v65, s75, v25
    v_mfma_f32_16x16x32_bf16 v[48:51], v[172:175], v[224:227], v[48:51]
    buffer_load_dwordx4 v[212:215], v4, s[36:39], s10 offen offset:1536 sc1
    v_mfma_f32_16x16x32_bf16 v[48:51], v[152:155], v[220:223], v[48:51]
    ds_write_b128 v8, v[40:43] offset:1024
    v_mfma_f32_16x16x32_bf16 v[48:51], v[132:135], v[216:219], v[48:51]
    v_exp_f32 v24, v64
    v_mfma_f32_16x16x32_bf16 v[52:55], v[136:139], v[216:219], v[52:55]
    v_exp_f32 v25, v65
    v_mfma_f32_16x16x32_bf16 v[52:55], v[156:159], v[220:223], v[52:55]
    ds_write_b128 v8, v[44:47] offset:2048
    v_mfma_f32_16x16x32_bf16 v[52:55], v[176:179], v[224:227], v[52:55]
    s_waitcnt vmcnt(7)
    buffer_load_dwordx4 v[216:219], v4, s[36:39], s10 offen offset:2048 sc1
    v_mfma_f32_16x16x32_bf16 v[76:79], a[240:243], v[228:231], 0
    v_fma_f32 v24, v24, s75, s75
    v_fma_f32 v25, v25, s75, s75
    v_mfma_f32_16x16x32_bf16 v[76:79], v[100:103], v[232:235], v[76:79]
    ds_write_b128 v8, v[48:51] offset:3072
    v_mfma_f32_16x16x32_bf16 v[80:83], v[104:107], v[232:235], 0
    v_rcp_f32 v24, v24
    v_mfma_f32_16x16x32_bf16 v[80:83], a[244:247], v[228:231], v[80:83]
    v_rcp_f32 v25, v25
    v_mfma_f32_16x16x32_bf16 v[84:87], a[248:251], v[228:231], 0
    buffer_load_dwordx4 v[220:223], v4, s[36:39], s11 offen offset:0 sc1
    v_mfma_f32_16x16x32_bf16 v[84:87], v[108:111], v[232:235], v[84:87]
    ds_write_b128 v8, v[52:55] offset:4096
    v_mfma_f32_16x16x32_bf16 v[88:91], v[112:115], v[232:235], 0
    v_mul_f32 v64, v64, v24
    v_mul_f32 v65, v65, v25
    v_mfma_f32_16x16x32_bf16 v[88:91], a[252:255], v[228:231], v[88:91]
    v_fma_f32 v68, v68, s75, v28
    v_fma_f32 v69, v69, s75, v29
    v_mfma_f32_16x16x32_bf16 v[92:95], v[96:99], v[228:231], 0
    v_exp_f32 v28, v68
    v_mfma_f32_16x16x32_bf16 v[92:95], v[116:119], v[232:235], v[92:95]
    s_waitcnt vmcnt(6)
    buffer_load_dwordx4 v[224:227], v4, s[36:39], s11 offen offset:512 sc1
    v_mfma_f32_16x16x32_bf16 v[76:79], v[120:123], v[236:239], v[76:79]
    v_exp_f32 v29, v69
    v_mfma_f32_16x16x32_bf16 v[76:79], v[140:143], v[240:243], v[76:79]
    v_fma_f32 v28, v28, s75, s75
    v_fma_f32 v29, v29, s75, s75
    v_mfma_f32_16x16x32_bf16 v[76:79], v[160:163], v[244:247], v[76:79]
    s_waitcnt lgkmcnt(0)
    s_barrier
    ds_read_b128 v[36:39], v10 offset:0
    v_mfma_f32_16x16x32_bf16 v[80:83], v[164:167], v[244:247], v[80:83]
    ds_read_b128 v[40:43], v10 offset:1024
    v_fma_f32 v58, v58, s75, v18
    v_mfma_f32_16x16x32_bf16 v[80:83], v[144:147], v[240:243], v[80:83]
    buffer_load_dwordx4 v[228:231], v4, s[36:39], s11 offen offset:1024 sc1
    v_mfma_f32_16x16x32_bf16 v[80:83], v[124:127], v[236:239], v[80:83]
    ds_read_b128 v[44:47], v10 offset:2048
    v_fma_f32 v59, v59, s75, v19
    v_mfma_f32_16x16x32_bf16 v[84:87], v[128:131], v[236:239], v[84:87]
    ds_read_b128 v[48:51], v10 offset:3072
    v_mfma_f32_16x16x32_bf16 v[84:87], v[148:151], v[240:243], v[84:87]
    ds_read_b128 v[52:55], v10 offset:4096
    v_mfma_f32_16x16x32_bf16 v[84:87], v[168:171], v[244:247], v[84:87]
    ds_write_b128 v9, v[76:79] offset:5120
    v_mfma_f32_16x16x32_bf16 v[88:91], v[172:175], v[244:247], v[88:91]
    buffer_load_dwordx4 v[232:235], v4, s[36:39], s11 offen offset:1536 sc1
    v_mfma_f32_16x16x32_bf16 v[88:91], v[152:155], v[240:243], v[88:91]
    ds_write_b128 v9, v[80:83] offset:6144
    v_mfma_f32_16x16x32_bf16 v[88:91], v[132:135], v[236:239], v[88:91]
    v_rcp_f32 v28, v28
    v_mfma_f32_16x16x32_bf16 v[92:95], v[136:139], v[236:239], v[92:95]
    v_rcp_f32 v29, v29
    v_mfma_f32_16x16x32_bf16 v[92:95], v[156:159], v[240:243], v[92:95]
    ds_write_b128 v9, v[84:87] offset:7168
    v_mfma_f32_16x16x32_bf16 v[92:95], v[176:179], v[244:247], v[92:95]
    s_waitcnt lgkmcnt(6) vmcnt(7)
    buffer_load_dwordx4 v[236:239], v4, s[36:39], s11 offen offset:2048 sc1
    v_mfma_f32_16x16x32_bf16 v[36:39], a[240:243], v[248:251], v[36:39]
    v_mul_f32 v68, v68, v28
    v_mul_f32 v69, v69, v29
    v_mfma_f32_16x16x32_bf16 v[36:39], v[100:103], v[252:255], v[36:39]
    ds_write_b128 v9, v[88:91] offset:8192
    v_mfma_f32_16x16x32_bf16 v[40:43], v[104:107], v[252:255], v[40:43]
    v_fma_f32 v72, v72, s75, v32
    v_fma_f32 v73, v73, s75, v33
    v_mfma_f32_16x16x32_bf16 v[40:43], a[244:247], v[248:251], v[40:43]
    s_waitcnt lgkmcnt(5)
    v_exp_f32 v32, v72
    v_mfma_f32_16x16x32_bf16 v[44:47], a[248:251], v[248:251], v[44:47]
    ds_write_b128 v9, v[92:95] offset:9216
    v_mfma_f32_16x16x32_bf16 v[44:47], v[108:111], v[252:255], v[44:47]
    v_exp_f32 v33, v73
    v_mfma_f32_16x16x32_bf16 v[48:51], v[112:115], v[252:255], v[48:51]
    v_fma_f32 v32, v32, s75, s75
    v_fma_f32 v33, v33, s75, s75
    v_mfma_f32_16x16x32_bf16 v[48:51], a[252:255], v[248:251], v[48:51]
    s_waitcnt lgkmcnt(5)
    v_rcp_f32 v32, v32
    v_mfma_f32_16x16x32_bf16 v[52:55], v[96:99], v[248:251], v[52:55]
    v_rcp_f32 v33, v33
    v_mfma_f32_16x16x32_bf16 v[52:55], v[116:119], v[252:255], v[52:55]
    s_waitcnt vmcnt(5)
    v_mul_f32 v72, v72, v32
    v_mul_f32 v73, v73, v33
    v_mfma_f32_16x16x32_bf16 v[36:39], v[120:123], v[208:211], v[36:39]
    v_exp_f32 v18, v58
    v_mfma_f32_16x16x32_bf16 v[36:39], v[140:143], v[212:215], v[36:39]
    v_exp_f32 v19, v59
    v_mfma_f32_16x16x32_bf16 v[36:39], v[160:163], v[216:219], v[36:39]
    s_waitcnt lgkmcnt(0)
    s_barrier
    ds_read_b128 v[76:79], v11 offset:5120
    v_mfma_f32_16x16x32_bf16 v[40:43], v[164:167], v[216:219], v[40:43]
    ds_read_b128 v[80:83], v11 offset:6144
    v_fma_f32 v18, v18, s75, s75
    v_mfma_f32_16x16x32_bf16 v[40:43], v[144:147], v[212:215], v[40:43]
    ds_read_b128 v[84:87], v11 offset:7168
    v_fma_f32 v19, v19, s75, s75
    v_mfma_f32_16x16x32_bf16 v[40:43], v[124:127], v[208:211], v[40:43]
    ds_read_b128 v[88:91], v11 offset:8192
    v_mfma_f32_16x16x32_bf16 v[44:47], v[128:131], v[208:211], v[44:47]
    ds_read_b128 v[92:95], v11 offset:9216
    v_mfma_f32_16x16x32_bf16 v[44:47], v[148:151], v[212:215], v[44:47]
    ds_write_b128 v10, v[36:39] offset:10240
    v_mfma_f32_16x16x32_bf16 v[44:47], v[168:171], v[216:219], v[44:47]
    v_rcp_f32 v18, v18
    v_mfma_f32_16x16x32_bf16 v[48:51], v[172:175], v[216:219], v[48:51]
    v_rcp_f32 v19, v19
    v_mfma_f32_16x16x32_bf16 v[48:51], v[152:155], v[212:215], v[48:51]
    ds_write_b128 v10, v[40:43] offset:11264
    v_mfma_f32_16x16x32_bf16 v[48:51], v[132:135], v[208:211], v[48:51]
    v_mul_f32 v58, v58, v18
    v_mul_f32 v59, v59, v19
    v_mfma_f32_16x16x32_bf16 v[52:55], v[136:139], v[208:211], v[52:55]
    v_fma_f32 v62, v62, s75, v22
    v_fma_f32 v63, v63, s75, v23
    v_mfma_f32_16x16x32_bf16 v[52:55], v[156:159], v[212:215], v[52:55]
    ds_write_b128 v10, v[44:47] offset:12288
    v_mfma_f32_16x16x32_bf16 v[52:55], v[176:179], v[216:219], v[52:55]
    s_waitcnt lgkmcnt(6) vmcnt(3)
    v_exp_f32 v22, v62
    v_mfma_f32_16x16x32_bf16 v[76:79], a[240:243], v[220:223], v[76:79]
    v_exp_f32 v23, v63
    v_mfma_f32_16x16x32_bf16 v[76:79], v[100:103], v[224:227], v[76:79]
    ds_write_b128 v10, v[48:51] offset:13312
    v_mfma_f32_16x16x32_bf16 v[80:83], v[104:107], v[224:227], v[80:83]
    v_fma_f32 v22, v22, s75, s75
    v_fma_f32 v23, v23, s75, s75
    v_mfma_f32_16x16x32_bf16 v[80:83], a[244:247], v[220:223], v[80:83]
    s_waitcnt lgkmcnt(5)
    v_rcp_f32 v22, v22
    v_mfma_f32_16x16x32_bf16 v[84:87], a[248:251], v[220:223], v[84:87]
    ds_write_b128 v10, v[52:55] offset:14336
    v_mfma_f32_16x16x32_bf16 v[84:87], v[108:111], v[224:227], v[84:87]
    v_rcp_f32 v23, v23
    v_mfma_f32_16x16x32_bf16 v[88:91], v[112:115], v[224:227], v[88:91]
    v_mul_f32 v62, v62, v22
    v_mul_f32 v63, v63, v23
    v_mfma_f32_16x16x32_bf16 v[88:91], a[252:255], v[220:223], v[88:91]
    s_waitcnt lgkmcnt(5)
    v_fma_f32 v66, v66, s75, v26
    v_fma_f32 v67, v67, s75, v27
    v_mfma_f32_16x16x32_bf16 v[92:95], v[96:99], v[220:223], v[92:95]
    v_exp_f32 v26, v66
    v_mfma_f32_16x16x32_bf16 v[92:95], v[116:119], v[224:227], v[92:95]
    s_waitcnt vmcnt(0)
    v_exp_f32 v27, v67
    v_mfma_f32_16x16x32_bf16 v[92:95], v[136:139], v[228:231], v[92:95]
    v_fma_f32 v26, v26, s75, s75
    v_fma_f32 v27, v27, s75, s75
    v_mfma_f32_16x16x32_bf16 v[92:95], v[156:159], v[232:235], v[92:95]
    v_rcp_f32 v26, v26
    v_mfma_f32_16x16x32_bf16 v[92:95], v[176:179], v[236:239], v[92:95]
    s_waitcnt lgkmcnt(0)
    s_barrier
    ds_read_b128 v[36:39], v11 offset:10240
    v_mfma_f32_16x16x32_bf16 v[76:79], v[160:163], v[236:239], v[76:79]
    ds_read_b128 v[40:43], v11 offset:11264
    v_mfma_f32_16x16x32_bf16 v[76:79], v[140:143], v[232:235], v[76:79]
    ds_read_b128 v[44:47], v11 offset:12288
    v_mfma_f32_16x16x32_bf16 v[76:79], v[120:123], v[228:231], v[76:79]
    ds_read_b128 v[48:51], v11 offset:13312
    v_mfma_f32_16x16x32_bf16 v[80:83], v[124:127], v[228:231], v[80:83]
    ds_read_b128 v[52:55], v11 offset:14336
    v_mfma_f32_16x16x32_bf16 v[80:83], v[144:147], v[232:235], v[80:83]
    v_rcp_f32 v27, v27
    v_mfma_f32_16x16x32_bf16 v[80:83], v[164:167], v[236:239], v[80:83]
    v_mul_f32 v66, v66, v26
    v_mul_f32 v67, v67, v27
    v_mfma_f32_16x16x32_bf16 v[84:87], v[168:171], v[236:239], v[84:87]
    v_fma_f32 v70, v70, s75, v30
    v_fma_f32 v71, v71, s75, v31
    v_mfma_f32_16x16x32_bf16 v[84:87], v[148:151], v[232:235], v[84:87]
    v_exp_f32 v30, v70
    v_mfma_f32_16x16x32_bf16 v[84:87], v[128:131], v[228:231], v[84:87]
    v_exp_f32 v31, v71
    v_mfma_f32_16x16x32_bf16 v[88:91], v[132:135], v[228:231], v[88:91]
    v_fma_f32 v30, v30, s75, s75
    v_fma_f32 v31, v31, s75, s75
    v_mfma_f32_16x16x32_bf16 v[88:91], v[152:155], v[232:235], v[88:91]
    v_rcp_f32 v30, v30
    v_mfma_f32_16x16x32_bf16 v[88:91], v[172:175], v[236:239], v[88:91]
    v_rcp_f32 v31, v31
    v_mul_f32 v70, v70, v30
    v_mul_f32 v71, v71, v31
    v_fma_f32 v74, v74, s75, v34
    v_fma_f32 v75, v75, s75, v35
    v_exp_f32 v34, v74
    v_exp_f32 v35, v75
    v_fma_f32 v34, v34, s75, s75
    v_fma_f32 v35, v35, s75, s75
    v_rcp_f32 v34, v34
    v_rcp_f32 v35, v35
    v_mul_f32 v74, v74, v34
    v_mul_f32 v75, v75, v35
    s_waitcnt lgkmcnt(0)
    v_pk_add_f32 v[92:93], v[92:93], v[52:53]
    v_pk_fma_f32 v[92:93], v[92:93], v[72:73], v[196:197]
    v_cvt_pk_bf16_f32 v24, v92, v93
    v_pk_add_f32 v[94:95], v[94:95], v[54:55]
    v_pk_fma_f32 v[94:95], v[94:95], v[74:75], v[198:199]
    v_cvt_pk_bf16_f32 v25, v94, v95
    v_pk_add_f32 v[76:77], v[76:77], v[36:37]
    v_pk_fma_f32 v[76:77], v[76:77], v[56:57], v[180:181]
F_PG6:
    s_cbranch_execz F_TRET
    v_permlane16_swap_b32 v24, v26
    v_permlane16_swap_b32 v25, v27
    buffer_store_dwordx4 v[24:27], v0, s[44:47], 0 offen offset:128
    v_cvt_pk_bf16_f32 v16, v76, v77
    v_pk_add_f32 v[78:79], v[78:79], v[38:39]
    v_pk_fma_f32 v[78:79], v[78:79], v[58:59], v[182:183]
    v_cvt_pk_bf16_f32 v17, v78, v79
    v_pk_add_f32 v[80:81], v[80:81], v[40:41]
    v_pk_fma_f32 v[80:81], v[80:81], v[60:61], v[184:185]
    v_cvt_pk_bf16_f32 v18, v80, v81
    v_pk_add_f32 v[82:83], v[82:83], v[42:43]
    v_pk_fma_f32 v[82:83], v[82:83], v[62:63], v[186:187]
    v_cvt_pk_bf16_f32 v19, v82, v83
    v_pk_add_f32 v[84:85], v[84:85], v[44:45]
    v_pk_fma_f32 v[84:85], v[84:85], v[64:65], v[188:189]
    v_cvt_pk_bf16_f32 v20, v84, v85
    v_pk_add_f32 v[86:87], v[86:87], v[46:47]
    v_pk_fma_f32 v[86:87], v[86:87], v[66:67], v[190:191]
    v_cvt_pk_bf16_f32 v21, v86, v87
    v_pk_add_f32 v[88:89], v[88:89], v[48:49]
    v_pk_fma_f32 v[88:89], v[88:89], v[68:69], v[192:193]
    v_cvt_pk_bf16_f32 v22, v88, v89
    v_pk_add_f32 v[90:91], v[90:91], v[50:51]
    v_pk_fma_f32 v[90:91], v[90:91], v[70:71], v[194:195]
    v_cvt_pk_bf16_f32 v23, v90, v91
    v_cndmask_b32_dpp v32, v16, v20, vcc quad_perm:[1,0,3,2] row_mask:0xf bank_mask:0xf
    v_cndmask_b32_dpp v33, v17, v21, vcc quad_perm:[1,0,3,2] row_mask:0xf bank_mask:0xf
    v_cndmask_b32_dpp v34, v18, v22, vcc quad_perm:[1,0,3,2] row_mask:0xf bank_mask:0xf
    v_cndmask_b32_dpp v35, v19, v23, vcc quad_perm:[1,0,3,2] row_mask:0xf bank_mask:0xf
    s_not_b64 vcc, vcc
    v_cndmask_b32_dpp v28, v20, v16, vcc quad_perm:[1,0,3,2] row_mask:0xf bank_mask:0xf
    v_cndmask_b32_dpp v29, v21, v17, vcc quad_perm:[1,0,3,2] row_mask:0xf bank_mask:0xf
    v_cndmask_b32_dpp v30, v22, v18, vcc quad_perm:[1,0,3,2] row_mask:0xf bank_mask:0xf
    v_cndmask_b32_dpp v31, v23, v19, vcc quad_perm:[1,0,3,2] row_mask:0xf bank_mask:0xf
    buffer_store_dwordx4 v[32:35], v13, s[44:47], 0 offen offset:2560
    buffer_store_dwordx4 v[28:31], v13, s[44:47], 0 offen
    s_endpgm
F_SPIN_D:
    buffer_load_dword v20, off, s[52:55], 0 offset:0 sc1
    s_waitcnt vmcnt(0)
    v_cmp_gt_u32 vcc, 4, v20
    s_cbranch_vccz F_BACK_D
    s_sub_u32 s68, s68, 1
    s_cbranch_scc0 F_SPIN_D
    s_mov_b32 s68, 0
    s_branch F_BACK_D
F_SPIN_S:
    buffer_load_dword v22, v21, s[40:43], 0 offen sc1
    s_waitcnt vmcnt(0)
    v_cmp_eq_u32 vcc, 0, v22
    s_cbranch_vccz F_BACK_S
    s_sub_u32 s68, s68, 1
    s_cbranch_scc0 F_SPIN_S
    s_mov_b32 s68, 0
    s_branch F_BACK_S
F_SPIN_T:
    buffer_load_dword v20, v22, s[40:43], 0 offen sc1
    s_waitcnt vmcnt(0)
    v_cmp_eq_u32 vcc, 0, v20
    s_cbranch_vccz F_BACK_T
    s_sub_u32 s68, s68, 1
    s_cbranch_scc0 F_SPIN_T
    s_mov_b32 s68, 0
    s_branch F_BACK_T
F_SPIN_O:
    buffer_load_dword v12, v14, s[40:43], 0 offen sc1
    s_waitcnt vmcnt(0)
    v_cmp_eq_u32 vcc, 0, v12
    s_cbranch_vccz F_BACK_O
    s_sub_u32 s68, s68, 1
    s_cbranch_scc0 F_SPIN_O
    s_mov_b32 s68, 0
    s_branch F_BACK_O
.p2align 12
Q_BODY:
    s_waitcnt vmcnt(6) lgkmcnt(0)
    s_barrier
    ds_read_b64_tr_b16 v[56:57], v8 offset:184
    ds_read_b64_tr_b16 v[58:59], v8 offset:7864
    ds_read_b128 v[44:47], v6 offset:0
    ds_read_b128 v[48:51], v4 offset:2048
    ds_read_b128 v[52:55], v4 offset:4096
    ds_read_b64_tr_b16 v[60:61], v8 offset:192
    ds_read_b64_tr_b16 v[62:63], v8 offset:7872
    ds_read_b64_tr_b16 v[64:65], v8 offset:320
    ds_read_b64_tr_b16 v[66:67], v8 offset:8000
    ds_read_b64_tr_b16 v[68:69], v8 offset:328
    ds_read_b64_tr_b16 v[70:71], v8 offset:8008
    s_waitcnt lgkmcnt(6)
    v_mfma_f32_16x16x32_bf16 v[88:91], v[56:59], v[44:47], 0
    s_add_u32 m0, s62, 108800
    ds_read_b64_tr_b16 v[72:73], v8 offset:336
    v_mfma_f32_16x16x32_bf16 v[188:191], v[56:59], v[48:51], 0
    ds_read_b64_tr_b16 v[74:75], v8 offset:8016
    v_mfma_f32_16x16x32_bf16 v[108:111], v[56:59], v[52:55], 0
    s_waitcnt lgkmcnt(6)
    buffer_load_dwordx4 v12, s[24:27], s64 offen offset:0 lds
    v_mfma_f32_16x16x32_bf16 v[112:115], v[60:63], v[52:55], 0
    ds_read_b64_tr_b16 a[240:241], v8 offset:344
    v_mfma_f32_16x16x32_bf16 v[192:195], v[60:63], v[48:51], 0
    ds_read_b64_tr_b16 a[242:243], v8 offset:8024
    v_mfma_f32_16x16x32_bf16 v[92:95], v[60:63], v[44:47], 0
    s_waitcnt lgkmcnt(6)
    buffer_load_dwordx4 v13, s[24:27], s64 offen offset:1024 lds
    v_mfma_f32_16x16x32_bf16 v[116:119], v[64:67], v[44:47], 0
    ds_read_b64_tr_b16 v[56:57], v8 offset:352
    v_mfma_f32_16x16x32_bf16 v[136:139], v[64:67], v[48:51], 0
    ds_read_b64_tr_b16 v[58:59], v8 offset:8032
    v_mfma_f32_16x16x32_bf16 v[156:159], v[64:67], v[52:55], 0
    s_waitcnt lgkmcnt(6) vmcnt(4)
    s_barrier
    ds_read_b128 a[244:247], v7 offset:0
    v_mfma_f32_16x16x32_bf16 v[160:163], v[68:71], v[52:55], 0
    ds_read_b64_tr_b16 v[60:61], v8 offset:0
    v_mfma_f32_16x16x32_bf16 v[140:143], v[68:71], v[48:51], 0
    ds_read_b64_tr_b16 v[62:63], v8 offset:7680
    v_mfma_f32_16x16x32_bf16 v[120:123], v[68:71], v[44:47], 0
    s_waitcnt lgkmcnt(7)
    ds_read_b128 a[248:251], v5 offset:2048
    v_mfma_f32_16x16x32_bf16 v[124:127], v[72:75], v[44:47], 0
    ds_read_b64_tr_b16 v[64:65], v8 offset:16384
    v_mfma_f32_16x16x32_bf16 v[144:147], v[72:75], v[48:51], 0
    ds_read_b64_tr_b16 v[66:67], v8 offset:24064
    v_mfma_f32_16x16x32_bf16 v[164:167], v[72:75], v[52:55], 0
    s_waitcnt lgkmcnt(8)
    ds_read_b128 a[252:255], v5 offset:4096
    v_mfma_f32_16x16x32_bf16 v[168:171], a[240:243], v[52:55], 0
    ds_read_b64_tr_b16 v[68:69], v8 offset:16392
    v_mfma_f32_16x16x32_bf16 v[148:151], a[240:243], v[48:51], 0
    ds_read_b64_tr_b16 v[70:71], v8 offset:24072
    v_mfma_f32_16x16x32_bf16 v[128:131], a[240:243], v[44:47], 0
    s_waitcnt lgkmcnt(9)
    buffer_load_dwordx4 v14, s[24:27], s64 offen offset:2048 lds
    v_mfma_f32_16x16x32_bf16 v[132:135], v[56:59], v[44:47], 0
    ds_read_b64_tr_b16 v[72:73], v8 offset:8
    v_mfma_f32_16x16x32_bf16 v[152:155], v[56:59], v[48:51], 0
    ds_read_b64_tr_b16 v[74:75], v8 offset:7688
    v_mfma_f32_16x16x32_bf16 v[172:175], v[56:59], v[52:55], 0
    s_waitcnt lgkmcnt(4)
    buffer_load_dwordx4 v15, s[24:27], s64 offen offset:3072 lds
    s_bfe_u32 s65, s77, 0x40004
    v_mfma_f32_16x16x32_bf16 v[196:199], v[60:63], v[44:47], 0
    s_lshl1_add_u32 s65, s65, s76
    ds_read_b64_tr_b16 a[240:241], v8 offset:16
    s_mul_i32 s65, s65, 122880
    v_mfma_f32_16x16x32_bf16 v[196:199], v[64:67], a[244:247], v[196:199]
    s_add_u32 m0, s63, 32768
    ds_read_b64_tr_b16 a[242:243], v8 offset:7696
    v_mfma_f32_16x16x32_bf16 v[216:219], v[64:67], a[248:251], 0
    buffer_load_dwordx4 v16, s[28:31], s65 offen offset:0 lds
    v_mfma_f32_16x16x32_bf16 v[216:219], v[60:63], v[48:51], v[216:219]
    ds_read_b64_tr_b16 v[56:57], v8 offset:16400
    v_mfma_f32_16x16x32_bf16 v[236:239], v[60:63], v[52:55], 0
    ds_read_b64_tr_b16 v[58:59], v8 offset:24080
    v_mfma_f32_16x16x32_bf16 v[236:239], v[64:67], a[252:255], v[236:239]
    s_waitcnt lgkmcnt(4)
    buffer_load_dwordx4 v17, s[28:31], s65 offen offset:1024 lds
    v_mfma_f32_16x16x32_bf16 v[240:243], v[68:71], a[252:255], 0
    ds_read_b64_tr_b16 v[60:61], v8 offset:16408
    v_mfma_f32_16x16x32_bf16 v[240:243], v[72:75], v[52:55], v[240:243]
    ds_read_b64_tr_b16 v[62:63], v8 offset:24088
    v_mfma_f32_16x16x32_bf16 v[220:223], v[72:75], v[48:51], 0
    buffer_load_dwordx4 v18, s[28:31], s65 offen offset:2048 lds
    v_mfma_f32_16x16x32_bf16 v[220:223], v[68:71], a[248:251], v[220:223]
    ds_read_b64_tr_b16 v[64:65], v8 offset:24
    v_mfma_f32_16x16x32_bf16 v[200:203], v[68:71], a[244:247], 0
    ds_read_b64_tr_b16 v[66:67], v8 offset:7704
    v_mfma_f32_16x16x32_bf16 v[200:203], v[72:75], v[44:47], v[200:203]
    s_waitcnt lgkmcnt(4)
    buffer_load_dwordx4 v19, s[28:31], s65 offen offset:3072 lds
    s_add_u32 s65, s65, s101
    v_mfma_f32_16x16x32_bf16 v[204:207], a[240:243], v[44:47], 0
    s_add_u32 m0, s63, 49152
    ds_read_b64_tr_b16 v[68:69], v8 offset:32
    v_mfma_f32_16x16x32_bf16 v[204:207], v[56:59], a[244:247], v[204:207]
    ds_read_b64_tr_b16 v[70:71], v8 offset:7712
    v_mfma_f32_16x16x32_bf16 v[224:227], v[56:59], a[248:251], 0
    buffer_load_dwordx4 v16, s[28:31], s65 offen offset:0 lds
    v_mfma_f32_16x16x32_bf16 v[224:227], a[240:243], v[48:51], v[224:227]
    ds_read_b64_tr_b16 v[72:73], v8 offset:16416
    v_mfma_f32_16x16x32_bf16 v[244:247], a[240:243], v[52:55], 0
    ds_read_b64_tr_b16 v[74:75], v8 offset:24096
    v_mfma_f32_16x16x32_bf16 v[244:247], v[56:59], a[252:255], v[244:247]
    s_waitcnt lgkmcnt(4)
    v_mfma_f32_16x16x32_bf16 v[248:251], v[60:63], a[252:255], 0
    ds_read_b64_tr_b16 a[240:241], v8 offset:16544
    v_mfma_f32_16x16x32_bf16 v[248:251], v[64:67], v[52:55], v[248:251]
    ds_read_b64_tr_b16 a[242:243], v8 offset:24224
    v_mfma_f32_16x16x32_bf16 v[228:231], v[64:67], v[48:51], 0
    v_mfma_f32_16x16x32_bf16 v[228:231], v[60:63], a[248:251], v[228:231]
    ds_read_b64_tr_b16 v[56:57], v8 offset:160
    v_mfma_f32_16x16x32_bf16 v[208:211], v[60:63], a[244:247], 0
    ds_read_b64_tr_b16 v[58:59], v8 offset:7840
    v_mfma_f32_16x16x32_bf16 v[208:211], v[64:67], v[44:47], v[208:211]
    s_waitcnt lgkmcnt(4)
    v_mfma_f32_16x16x32_bf16 v[212:215], v[68:71], v[44:47], 0
    ds_read_b64_tr_b16 v[60:61], v8 offset:168
    v_mfma_f32_16x16x32_bf16 v[212:215], v[72:75], a[244:247], v[212:215]
    ds_read_b64_tr_b16 v[62:63], v8 offset:7848
    v_mfma_f32_16x16x32_bf16 v[232:235], v[72:75], a[248:251], 0
    buffer_load_dwordx4 v17, s[28:31], s65 offen offset:1024 lds
    v_mfma_f32_16x16x32_bf16 v[232:235], v[68:71], v[48:51], v[232:235]
    ds_read_b64_tr_b16 v[64:65], v8 offset:16552
    v_mfma_f32_16x16x32_bf16 v[252:255], v[68:71], v[52:55], 0
    ds_read_b64_tr_b16 v[66:67], v8 offset:24232
    v_mfma_f32_16x16x32_bf16 v[252:255], v[72:75], a[252:255], v[252:255]
    s_waitcnt lgkmcnt(4) vmcnt(2)
    s_barrier
    ds_read_b128 v[32:35], v6 offset:24832
    v_mfma_f32_16x16x32_bf16 v[96:99], a[240:243], a[252:255], 0
    ds_read_b64_tr_b16 v[68:69], v8 offset:16560
    v_mfma_f32_16x16x32_bf16 v[96:99], v[56:59], v[52:55], v[96:99]
    ds_read_b64_tr_b16 v[70:71], v8 offset:24240
    v_mfma_f32_16x16x32_bf16 v[176:179], v[56:59], v[48:51], 0
    buffer_load_dwordx4 v18, s[28:31], s65 offen offset:2048 lds
    v_mfma_f32_16x16x32_bf16 v[176:179], a[240:243], a[248:251], v[176:179]
    ds_read_b64_tr_b16 v[72:73], v8 offset:176
    v_mfma_f32_16x16x32_bf16 v[76:79], a[240:243], a[244:247], 0
    ds_read_b64_tr_b16 v[74:75], v8 offset:7856
    v_mfma_f32_16x16x32_bf16 v[76:79], v[56:59], v[44:47], v[76:79]
    s_waitcnt lgkmcnt(5)
    ds_read_b128 v[36:39], v4 offset:26880
    v_mfma_f32_16x16x32_bf16 v[80:83], v[60:63], v[44:47], 0
    ds_read_b64_tr_b16 a[240:241], v8 offset:16568
    v_mfma_f32_16x16x32_bf16 v[80:83], v[64:67], a[244:247], v[80:83]
    ds_read_b64_tr_b16 a[242:243], v8 offset:24248
    v_mfma_f32_16x16x32_bf16 v[180:183], v[64:67], a[248:251], 0
    buffer_load_dwordx4 v19, s[28:31], s65 offen offset:3072 lds
    s_bfe_u32 s64, s77, 0x40008
    v_mfma_f32_16x16x32_bf16 v[180:183], v[60:63], v[48:51], v[180:183]
    s_lshl_b32 s64, s64, 7
    ds_read_b64_tr_b16 v[56:57], v8 offset:32952
    s_add_u32 m0, s62, 131584
    v_mfma_f32_16x16x32_bf16 v[100:103], v[60:63], v[52:55], 0
    ds_read_b64_tr_b16 v[58:59], v8 offset:40632
    v_mfma_f32_16x16x32_bf16 v[100:103], v[64:67], a[252:255], v[100:103]
    s_waitcnt lgkmcnt(5)
    ds_read_b128 v[40:43], v4 offset:28928
    v_mfma_f32_16x16x32_bf16 v[104:107], v[68:71], a[252:255], 0
    ds_read_b64_tr_b16 v[60:61], v8 offset:32960
    v_mfma_f32_16x16x32_bf16 v[104:107], v[72:75], v[52:55], v[104:107]
    ds_read_b64_tr_b16 v[62:63], v8 offset:40640
    v_mfma_f32_16x16x32_bf16 v[184:187], v[72:75], v[48:51], 0
    buffer_load_dwordx4 v10, s[24:27], s64 offen offset:0 lds
    v_mfma_f32_16x16x32_bf16 v[184:187], v[68:71], a[248:251], v[184:187]
    ds_read_b64_tr_b16 v[64:65], v8 offset:16576
    v_mfma_f32_16x16x32_bf16 v[84:87], v[68:71], a[244:247], 0
    ds_read_b64_tr_b16 v[66:67], v8 offset:24256
    v_mfma_f32_16x16x32_bf16 v[84:87], v[72:75], v[44:47], v[84:87]
    s_waitcnt lgkmcnt(4)
    v_mfma_f32_16x16x32_bf16 v[88:91], a[240:243], a[244:247], v[88:91]
    ds_read_b64_tr_b16 v[68:69], v8 offset:16704
    v_mfma_f32_16x16x32_bf16 v[88:91], v[56:59], v[32:35], v[88:91]
    ds_read_b64_tr_b16 v[70:71], v8 offset:24384
    v_mfma_f32_16x16x32_bf16 v[188:191], v[56:59], v[36:39], v[188:191]
    v_mfma_f32_16x16x32_bf16 v[188:191], a[240:243], a[248:251], v[188:191]
    ds_read_b64_tr_b16 v[72:73], v8 offset:33088
    v_mfma_f32_16x16x32_bf16 v[108:111], a[240:243], a[252:255], v[108:111]
    ds_read_b64_tr_b16 v[74:75], v8 offset:40768
    v_mfma_f32_16x16x32_bf16 v[108:111], v[56:59], v[40:43], v[108:111]
    s_waitcnt lgkmcnt(4)
    buffer_load_dwordx4 v11, s[24:27], s64 offen offset:1024 lds
    s_add_u32 m0, s62, 133632
    v_mfma_f32_16x16x32_bf16 v[112:115], v[60:63], v[40:43], v[112:115]
    ds_read_b64_tr_b16 a[240:241], v8 offset:33096
    v_mfma_f32_16x16x32_bf16 v[112:115], v[64:67], a[252:255], v[112:115]
    ds_read_b64_tr_b16 a[242:243], v8 offset:40776
    v_mfma_f32_16x16x32_bf16 v[192:195], v[64:67], a[248:251], v[192:195]
    v_mfma_f32_16x16x32_bf16 v[192:195], v[60:63], v[36:39], v[192:195]
    ds_read_b64_tr_b16 v[56:57], v8 offset:16712
    v_mfma_f32_16x16x32_bf16 v[92:95], v[60:63], v[32:35], v[92:95]
    ds_read_b64_tr_b16 v[58:59], v8 offset:24392
    v_mfma_f32_16x16x32_bf16 v[92:95], v[64:67], a[244:247], v[92:95]
    s_waitcnt lgkmcnt(4)
    buffer_load_dwordx4 v12, s[24:27], s64 offen offset:0 lds
    v_mfma_f32_16x16x32_bf16 v[116:119], v[68:71], a[244:247], v[116:119]
    ds_read_b64_tr_b16 v[60:61], v8 offset:16720
    v_mfma_f32_16x16x32_bf16 v[116:119], v[72:75], v[32:35], v[116:119]
    ds_read_b64_tr_b16 v[62:63], v8 offset:24400
    v_mfma_f32_16x16x32_bf16 v[136:139], v[72:75], v[36:39], v[136:139]
    v_mfma_f32_16x16x32_bf16 v[136:139], v[68:71], a[248:251], v[136:139]
    ds_read_b64_tr_b16 v[64:65], v8 offset:33104
    v_mfma_f32_16x16x32_bf16 v[156:159], v[68:71], a[252:255], v[156:159]
    ds_read_b64_tr_b16 v[66:67], v8 offset:40784
    v_mfma_f32_16x16x32_bf16 v[156:159], v[72:75], v[40:43], v[156:159]
    s_waitcnt lgkmcnt(4)
    buffer_load_dwordx4 v13, s[24:27], s64 offen offset:1024 lds
    v_mfma_f32_16x16x32_bf16 v[160:163], a[240:243], v[40:43], v[160:163]
    ds_read_b64_tr_b16 v[68:69], v8 offset:33112
    v_mfma_f32_16x16x32_bf16 v[160:163], v[56:59], a[252:255], v[160:163]
    ds_read_b64_tr_b16 v[70:71], v8 offset:40792
    v_mfma_f32_16x16x32_bf16 v[140:143], v[56:59], a[248:251], v[140:143]
    v_mfma_f32_16x16x32_bf16 v[140:143], a[240:243], v[36:39], v[140:143]
    ds_read_b64_tr_b16 v[72:73], v8 offset:16728
    v_mfma_f32_16x16x32_bf16 v[120:123], a[240:243], v[32:35], v[120:123]
    ds_read_b64_tr_b16 v[74:75], v8 offset:24408
    v_mfma_f32_16x16x32_bf16 v[120:123], v[56:59], a[244:247], v[120:123]
    s_waitcnt lgkmcnt(4)
    buffer_load_dwordx4 v14, s[24:27], s64 offen offset:2048 lds
    v_mfma_f32_16x16x32_bf16 v[124:127], v[60:63], a[244:247], v[124:127]
    ds_read_b64_tr_b16 a[240:241], v8 offset:16736
    v_mfma_f32_16x16x32_bf16 v[124:127], v[64:67], v[32:35], v[124:127]
    ds_read_b64_tr_b16 a[242:243], v8 offset:24416
    v_mfma_f32_16x16x32_bf16 v[144:147], v[64:67], v[36:39], v[144:147]
    s_waitcnt vmcnt(5)
    s_barrier
    ds_read_b128 v[44:47], v7 offset:24832
    v_mfma_f32_16x16x32_bf16 v[144:147], v[60:63], a[248:251], v[144:147]
    ds_read_b64_tr_b16 v[56:57], v8 offset:33120
    v_mfma_f32_16x16x32_bf16 v[164:167], v[60:63], a[252:255], v[164:167]
    ds_read_b64_tr_b16 v[58:59], v8 offset:40800
    v_mfma_f32_16x16x32_bf16 v[164:167], v[64:67], v[40:43], v[164:167]
    s_waitcnt lgkmcnt(5)
    ds_read_b128 v[48:51], v5 offset:26880
    v_mfma_f32_16x16x32_bf16 v[168:171], v[68:71], v[40:43], v[168:171]
    ds_read_b64_tr_b16 v[60:61], v8 offset:32768
    v_mfma_f32_16x16x32_bf16 v[168:171], v[72:75], a[252:255], v[168:171]
    ds_read_b64_tr_b16 v[62:63], v8 offset:40448
    v_mfma_f32_16x16x32_bf16 v[148:151], v[72:75], a[248:251], v[148:151]
    ds_read_b128 v[52:55], v5 offset:28928
    v_mfma_f32_16x16x32_bf16 v[148:151], v[68:71], v[36:39], v[148:151]
    ds_read_b64_tr_b16 v[64:65], v8 offset:49152
    v_mfma_f32_16x16x32_bf16 v[128:131], v[68:71], v[32:35], v[128:131]
    ds_read_b64_tr_b16 v[66:67], v8 offset:56832
    v_mfma_f32_16x16x32_bf16 v[128:131], v[72:75], a[244:247], v[128:131]
    s_waitcnt lgkmcnt(6)
    buffer_load_dwordx4 v15, s[24:27], s64 offen offset:3072 lds
    s_bfe_u32 s65, s77, 0x40008
    v_mfma_f32_16x16x32_bf16 v[132:135], a[240:243], a[244:247], v[132:135]
    s_lshl1_add_u32 s65, s65, s76
    ds_read_b64_tr_b16 v[68:69], v8 offset:49160
    s_mul_i32 s65, s65, 122880
    v_mfma_f32_16x16x32_bf16 v[132:135], v[56:59], v[32:35], v[132:135]
    s_add_u32 m0, s63, 65536
    ds_read_b64_tr_b16 v[70:71], v8 offset:56840
    v_mfma_f32_16x16x32_bf16 v[152:155], v[56:59], v[36:39], v[152:155]
    buffer_load_dwordx4 v16, s[28:31], s65 offen offset:0 lds
    v_mfma_f32_16x16x32_bf16 v[152:155], a[240:243], a[248:251], v[152:155]
    ds_read_b64_tr_b16 v[72:73], v8 offset:32776
    v_mfma_f32_16x16x32_bf16 v[172:175], a[240:243], a[252:255], v[172:175]
    ds_read_b64_tr_b16 v[74:75], v8 offset:40456
    v_mfma_f32_16x16x32_bf16 v[172:175], v[56:59], v[40:43], v[172:175]
    s_waitcnt lgkmcnt(4)
    buffer_load_dwordx4 v17, s[28:31], s65 offen offset:1024 lds
    v_mfma_f32_16x16x32_bf16 v[196:199], v[60:63], v[32:35], v[196:199]
    ds_read_b64_tr_b16 a[240:241], v8 offset:32784
    v_mfma_f32_16x16x32_bf16 v[196:199], v[64:67], v[44:47], v[196:199]
    ds_read_b64_tr_b16 a[242:243], v8 offset:40464
    v_mfma_f32_16x16x32_bf16 v[216:219], v[64:67], v[48:51], v[216:219]
    buffer_load_dwordx4 v18, s[28:31], s65 offen offset:2048 lds
    v_mfma_f32_16x16x32_bf16 v[216:219], v[60:63], v[36:39], v[216:219]
    ds_read_b64_tr_b16 v[56:57], v8 offset:49168
    v_mfma_f32_16x16x32_bf16 v[236:239], v[60:63], v[40:43], v[236:239]
    ds_read_b64_tr_b16 v[58:59], v8 offset:56848
    v_mfma_f32_16x16x32_bf16 v[236:239], v[64:67], v[52:55], v[236:239]
    s_waitcnt lgkmcnt(4)
    buffer_load_dwordx4 v19, s[28:31], s65 offen offset:3072 lds
    s_add_u32 s65, s65, s101
    v_mfma_f32_16x16x32_bf16 v[240:243], v[68:71], v[52:55], v[240:243]
    s_add_u32 m0, s63, 0
    ds_read_b64_tr_b16 v[60:61], v8 offset:49176
    v_mfma_f32_16x16x32_bf16 v[240:243], v[72:75], v[40:43], v[240:243]
    ds_read_b64_tr_b16 v[62:63], v8 offset:56856
    v_mfma_f32_16x16x32_bf16 v[220:223], v[72:75], v[36:39], v[220:223]
    buffer_load_dwordx4 v16, s[28:31], s65 offen offset:0 lds
    v_mfma_f32_16x16x32_bf16 v[220:223], v[68:71], v[48:51], v[220:223]
    ds_read_b64_tr_b16 v[64:65], v8 offset:32792
    v_mfma_f32_16x16x32_bf16 v[200:203], v[68:71], v[44:47], v[200:203]
    ds_read_b64_tr_b16 v[66:67], v8 offset:40472
    v_mfma_f32_16x16x32_bf16 v[200:203], v[72:75], v[32:35], v[200:203]
    s_waitcnt lgkmcnt(4)
    v_mfma_f32_16x16x32_bf16 v[204:207], a[240:243], v[32:35], v[204:207]
    ds_read_b64_tr_b16 v[68:69], v8 offset:32800
    v_mfma_f32_16x16x32_bf16 v[204:207], v[56:59], v[44:47], v[204:207]
    ds_read_b64_tr_b16 v[70:71], v8 offset:40480
    v_mfma_f32_16x16x32_bf16 v[224:227], v[56:59], v[48:51], v[224:227]
    buffer_load_dwordx4 v17, s[28:31], s65 offen offset:1024 lds
    v_mfma_f32_16x16x32_bf16 v[224:227], a[240:243], v[36:39], v[224:227]
    ds_read_b64_tr_b16 v[72:73], v8 offset:49184
    v_mfma_f32_16x16x32_bf16 v[244:247], a[240:243], v[40:43], v[244:247]
    ds_read_b64_tr_b16 v[74:75], v8 offset:56864
    v_mfma_f32_16x16x32_bf16 v[244:247], v[56:59], v[52:55], v[244:247]
    s_waitcnt lgkmcnt(4)
    v_mfma_f32_16x16x32_bf16 v[248:251], v[60:63], v[52:55], v[248:251]
    ds_read_b64_tr_b16 a[240:241], v8 offset:49312
    v_mfma_f32_16x16x32_bf16 v[248:251], v[64:67], v[40:43], v[248:251]
    ds_read_b64_tr_b16 a[242:243], v8 offset:56992
    v_mfma_f32_16x16x32_bf16 v[228:231], v[64:67], v[36:39], v[228:231]
    buffer_load_dwordx4 v18, s[28:31], s65 offen offset:2048 lds
    v_mfma_f32_16x16x32_bf16 v[228:231], v[60:63], v[48:51], v[228:231]
    ds_read_b64_tr_b16 v[56:57], v8 offset:32928
    v_mfma_f32_16x16x32_bf16 v[208:211], v[60:63], v[44:47], v[208:211]
    ds_read_b64_tr_b16 v[58:59], v8 offset:40608
    v_mfma_f32_16x16x32_bf16 v[208:211], v[64:67], v[32:35], v[208:211]
    s_waitcnt lgkmcnt(4) vmcnt(3)
    s_barrier
    ds_read_b128 a[244:247], v6 offset:49664
    v_mfma_f32_16x16x32_bf16 v[212:215], v[68:71], v[32:35], v[212:215]
    ds_read_b64_tr_b16 v[60:61], v8 offset:32936
    v_mfma_f32_16x16x32_bf16 v[212:215], v[72:75], v[44:47], v[212:215]
    ds_read_b64_tr_b16 v[62:63], v8 offset:40616
    v_mfma_f32_16x16x32_bf16 v[232:235], v[72:75], v[48:51], v[232:235]
    v_mfma_f32_16x16x32_bf16 v[232:235], v[68:71], v[36:39], v[232:235]
    ds_read_b64_tr_b16 v[64:65], v8 offset:49320
    v_mfma_f32_16x16x32_bf16 v[252:255], v[68:71], v[40:43], v[252:255]
    ds_read_b64_tr_b16 v[66:67], v8 offset:57000
    v_mfma_f32_16x16x32_bf16 v[252:255], v[72:75], v[52:55], v[252:255]
    s_waitcnt lgkmcnt(5)
    v_mfma_f32_16x16x32_bf16 v[96:99], a[240:243], v[52:55], v[96:99]
    ds_read_b64_tr_b16 v[68:69], v8 offset:49328
    v_mfma_f32_16x16x32_bf16 v[96:99], v[56:59], v[40:43], v[96:99]
    ds_read_b64_tr_b16 v[70:71], v8 offset:57008
    v_mfma_f32_16x16x32_bf16 v[176:179], v[56:59], v[36:39], v[176:179]
    ds_read_b128 a[248:251], v4 offset:51712
    v_mfma_f32_16x16x32_bf16 v[176:179], a[240:243], v[48:51], v[176:179]
    ds_read_b64_tr_b16 v[72:73], v8 offset:32944
    v_mfma_f32_16x16x32_bf16 v[76:79], a[240:243], v[44:47], v[76:79]
    ds_read_b64_tr_b16 v[74:75], v8 offset:40624
    v_mfma_f32_16x16x32_bf16 v[76:79], v[56:59], v[32:35], v[76:79]
    s_waitcnt lgkmcnt(5)
    buffer_load_dwordx4 v19, s[28:31], s65 offen offset:3072 lds
    s_bfe_u32 s64, s77, 0x4000c
    v_mfma_f32_16x16x32_bf16 v[80:83], v[60:63], v[32:35], v[80:83]
    s_lshl_b32 s64, s64, 7
    ds_read_b64_tr_b16 a[240:241], v8 offset:49336
    s_add_u32 m0, s62, 81920
    v_mfma_f32_16x16x32_bf16 v[80:83], v[64:67], v[44:47], v[80:83]
    ds_read_b64_tr_b16 a[242:243], v8 offset:57016
    v_mfma_f32_16x16x32_bf16 v[180:183], v[64:67], v[48:51], v[180:183]
    buffer_load_dwordx4 v10, s[24:27], s64 offen offset:0 lds
    v_mfma_f32_16x16x32_bf16 v[180:183], v[60:63], v[36:39], v[180:183]
    ds_read_b64_tr_b16 v[56:57], v9 offset:184
    v_mfma_f32_16x16x32_bf16 v[100:103], v[60:63], v[40:43], v[100:103]
    ds_read_b64_tr_b16 v[58:59], v9 offset:7864
    v_mfma_f32_16x16x32_bf16 v[100:103], v[64:67], v[52:55], v[100:103]
    s_waitcnt lgkmcnt(4)
    ds_read_b128 a[252:255], v4 offset:53760
    v_mfma_f32_16x16x32_bf16 v[104:107], v[68:71], v[52:55], v[104:107]
    ds_read_b64_tr_b16 v[60:61], v9 offset:192
    v_mfma_f32_16x16x32_bf16 v[104:107], v[72:75], v[40:43], v[104:107]
    ds_read_b64_tr_b16 v[62:63], v9 offset:7872
    v_mfma_f32_16x16x32_bf16 v[184:187], v[72:75], v[36:39], v[184:187]
    buffer_load_dwordx4 v11, s[24:27], s64 offen offset:1024 lds
    s_add_u32 m0, s62, 83968
    v_mfma_f32_16x16x32_bf16 v[184:187], v[68:71], v[48:51], v[184:187]
    ds_read_b64_tr_b16 v[64:65], v8 offset:49344
    v_mfma_f32_16x16x32_bf16 v[84:87], v[68:71], v[44:47], v[84:87]
    ds_read_b64_tr_b16 v[66:67], v8 offset:57024
    v_mfma_f32_16x16x32_bf16 v[84:87], v[72:75], v[32:35], v[84:87]
    s_waitcnt lgkmcnt(4)
    v_mfma_f32_16x16x32_bf16 v[88:91], a[240:243], v[44:47], v[88:91]
    ds_read_b64_tr_b16 v[68:69], v8 offset:49472
    v_mfma_f32_16x16x32_bf16 v[88:91], v[56:59], a[244:247], v[88:91]
    ds_read_b64_tr_b16 v[70:71], v8 offset:57152
    v_mfma_f32_16x16x32_bf16 v[188:191], v[56:59], a[248:251], v[188:191]
    buffer_load_dwordx4 v12, s[24:27], s64 offen offset:0 lds
    v_mfma_f32_16x16x32_bf16 v[188:191], a[240:243], v[48:51], v[188:191]
    ds_read_b64_tr_b16 v[72:73], v9 offset:320
    v_mfma_f32_16x16x32_bf16 v[108:111], a[240:243], v[52:55], v[108:111]
    ds_read_b64_tr_b16 v[74:75], v9 offset:8000
    v_mfma_f32_16x16x32_bf16 v[108:111], v[56:59], a[252:255], v[108:111]
    s_waitcnt lgkmcnt(4)
    v_mfma_f32_16x16x32_bf16 v[112:115], v[60:63], a[252:255], v[112:115]
    ds_read_b64_tr_b16 a[240:241], v9 offset:328
    v_mfma_f32_16x16x32_bf16 v[112:115], v[64:67], v[52:55], v[112:115]
    ds_read_b64_tr_b16 a[242:243], v9 offset:8008
    v_mfma_f32_16x16x32_bf16 v[192:195], v[64:67], v[48:51], v[192:195]
    buffer_load_dwordx4 v13, s[24:27], s64 offen offset:1024 lds
    v_mfma_f32_16x16x32_bf16 v[192:195], v[60:63], a[248:251], v[192:195]
    ds_read_b64_tr_b16 v[56:57], v8 offset:49480
    v_mfma_f32_16x16x32_bf16 v[92:95], v[60:63], a[244:247], v[92:95]
    ds_read_b64_tr_b16 v[58:59], v8 offset:57160
    v_mfma_f32_16x16x32_bf16 v[92:95], v[64:67], v[44:47], v[92:95]
    s_waitcnt lgkmcnt(4)
    v_mfma_f32_16x16x32_bf16 v[116:119], v[68:71], v[44:47], v[116:119]
    ds_read_b64_tr_b16 v[60:61], v8 offset:49488
    v_mfma_f32_16x16x32_bf16 v[116:119], v[72:75], a[244:247], v[116:119]
    ds_read_b64_tr_b16 v[62:63], v8 offset:57168
    v_mfma_f32_16x16x32_bf16 v[136:139], v[72:75], a[248:251], v[136:139]
    buffer_load_dwordx4 v14, s[24:27], s64 offen offset:2048 lds
    v_mfma_f32_16x16x32_bf16 v[136:139], v[68:71], v[48:51], v[136:139]
    ds_read_b64_tr_b16 v[64:65], v9 offset:336
    v_mfma_f32_16x16x32_bf16 v[156:159], v[68:71], v[52:55], v[156:159]
    ds_read_b64_tr_b16 v[66:67], v9 offset:8016
    v_mfma_f32_16x16x32_bf16 v[156:159], v[72:75], a[252:255], v[156:159]
    s_waitcnt lgkmcnt(4)
    buffer_load_dwordx4 v15, s[24:27], s64 offen offset:3072 lds
    s_bfe_u32 s65, s77, 0x4000c
    v_mfma_f32_16x16x32_bf16 v[160:163], a[240:243], a[252:255], v[160:163]
    s_lshl1_add_u32 s65, s65, s76
    ds_read_b64_tr_b16 v[68:69], v9 offset:344
    s_mul_i32 s65, s65, 122880
    v_mfma_f32_16x16x32_bf16 v[160:163], v[56:59], v[52:55], v[160:163]
    s_add_u32 m0, s63, 16384
    ds_read_b64_tr_b16 v[70:71], v9 offset:8024
    v_mfma_f32_16x16x32_bf16 v[140:143], v[56:59], v[48:51], v[140:143]
    buffer_load_dwordx4 v16, s[28:31], s65 offen offset:0 lds
    v_mfma_f32_16x16x32_bf16 v[140:143], a[240:243], a[248:251], v[140:143]
    ds_read_b64_tr_b16 v[72:73], v8 offset:49496
    v_mfma_f32_16x16x32_bf16 v[120:123], a[240:243], a[244:247], v[120:123]
    ds_read_b64_tr_b16 v[74:75], v8 offset:57176
    v_mfma_f32_16x16x32_bf16 v[120:123], v[56:59], v[44:47], v[120:123]
    s_waitcnt lgkmcnt(4)
    v_mfma_f32_16x16x32_bf16 v[124:127], v[60:63], v[44:47], v[124:127]
    ds_read_b64_tr_b16 a[240:241], v8 offset:49504
    v_mfma_f32_16x16x32_bf16 v[124:127], v[64:67], a[244:247], v[124:127]
    ds_read_b64_tr_b16 a[242:243], v8 offset:57184
    v_mfma_f32_16x16x32_bf16 v[144:147], v[64:67], a[248:251], v[144:147]
    buffer_load_dwordx4 v17, s[28:31], s65 offen offset:1024 lds
    v_mfma_f32_16x16x32_bf16 v[144:147], v[60:63], v[48:51], v[144:147]
    ds_read_b64_tr_b16 v[56:57], v9 offset:352
    v_mfma_f32_16x16x32_bf16 v[164:167], v[60:63], v[52:55], v[164:167]
    ds_read_b64_tr_b16 v[58:59], v9 offset:8032
    v_mfma_f32_16x16x32_bf16 v[164:167], v[64:67], a[252:255], v[164:167]
    s_waitcnt lgkmcnt(4)
    buffer_load_dwordx4 v18, s[28:31], s65 offen offset:2048 lds
    v_mfma_f32_16x16x32_bf16 v[168:171], v[68:71], a[252:255], v[168:171]
    ds_read_b64_tr_b16 v[60:61], v9 offset:0
    v_mfma_f32_16x16x32_bf16 v[168:171], v[72:75], v[52:55], v[168:171]
    ds_read_b64_tr_b16 v[62:63], v9 offset:7680
    v_mfma_f32_16x16x32_bf16 v[148:151], v[72:75], v[48:51], v[148:151]
    s_waitcnt vmcnt(9)
    s_barrier
    ds_read_b128 v[32:35], v7 offset:49664
    v_mfma_f32_16x16x32_bf16 v[148:151], v[68:71], a[248:251], v[148:151]
    ds_read_b64_tr_b16 v[64:65], v8 offset:0
    v_mfma_f32_16x16x32_bf16 v[128:131], v[68:71], a[244:247], v[128:131]
    ds_read_b64_tr_b16 v[66:67], v8 offset:7680
    v_mfma_f32_16x16x32_bf16 v[128:131], v[72:75], v[44:47], v[128:131]
    s_waitcnt lgkmcnt(5)
    ds_read_b128 v[36:39], v5 offset:51712
    v_mfma_f32_16x16x32_bf16 v[132:135], a[240:243], v[44:47], v[132:135]
    ds_read_b64_tr_b16 v[68:69], v8 offset:8
    v_mfma_f32_16x16x32_bf16 v[132:135], v[56:59], a[244:247], v[132:135]
    ds_read_b64_tr_b16 v[70:71], v8 offset:7688
    v_mfma_f32_16x16x32_bf16 v[152:155], v[56:59], a[248:251], v[152:155]
    ds_read_b128 v[40:43], v5 offset:53760
    v_mfma_f32_16x16x32_bf16 v[152:155], a[240:243], v[48:51], v[152:155]
    ds_read_b64_tr_b16 v[72:73], v9 offset:8
    v_mfma_f32_16x16x32_bf16 v[172:175], a[240:243], v[52:55], v[172:175]
    ds_read_b64_tr_b16 v[74:75], v9 offset:7688
    v_mfma_f32_16x16x32_bf16 v[172:175], v[56:59], a[252:255], v[172:175]
    s_waitcnt lgkmcnt(2)
    buffer_load_dwordx4 v19, s[28:31], s65 offen offset:3072 lds
    s_add_u32 s65, s65, s101
    v_mfma_f32_16x16x32_bf16 v[196:199], v[60:63], a[244:247], v[196:199]
    s_add_u32 m0, s63, 32768
    ds_read_b64_tr_b16 a[240:241], v9 offset:16
    s_xor_b32 s48, s82, 0
    v_mfma_f32_16x16x32_bf16 v[196:199], v[64:67], v[32:35], v[196:199]
    s_mul_i32 s48, s48, 1536
    ds_read_b64_tr_b16 a[242:243], v9 offset:7696
    s_xor_b32 s49, s82, 1
    v_mfma_f32_16x16x32_bf16 v[216:219], v[64:67], v[36:39], v[216:219]
    s_mul_i32 s49, s49, 1536
    buffer_load_dwordx4 v16, s[28:31], s65 offen offset:0 lds
    s_xor_b32 s50, s82, 2
    v_mfma_f32_16x16x32_bf16 v[216:219], v[60:63], a[248:251], v[216:219]
    s_mul_i32 s50, s50, 1536
    ds_read_b64_tr_b16 v[56:57], v8 offset:16
    s_xor_b32 s51, s82, 3
    v_mfma_f32_16x16x32_bf16 v[236:239], v[60:63], a[252:255], v[236:239]
    s_mul_i32 s51, s51, 1536
    ds_read_b64_tr_b16 v[58:59], v8 offset:7696
    s_and_b32 s3, s61, 0
    v_mfma_f32_16x16x32_bf16 v[236:239], v[64:67], v[40:43], v[236:239]
    s_waitcnt lgkmcnt(4)
    buffer_load_dwordx4 v17, s[28:31], s65 offen offset:1024 lds
    s_add_u32 s3, s3, s56
    v_mfma_f32_16x16x32_bf16 v[240:243], v[68:71], v[40:43], v[240:243]
    s_mul_i32 s73, s60, 278528
    ds_read_b64_tr_b16 v[60:61], v8 offset:24
    v_mfma_f32_16x16x32_bf16 v[240:243], v[72:75], a[252:255], v[240:243]
    s_mul_i32 s74, s56, 6144
    ds_read_b64_tr_b16 v[62:63], v8 offset:7704
    s_add_u32 s73, s73, s74
    v_mfma_f32_16x16x32_bf16 v[220:223], v[72:75], a[248:251], v[220:223]
    s_mul_i32 s74, s56, -3584
    s_add_u32 s74, s74, 24576
    v_mfma_f32_16x16x32_bf16 v[220:223], v[68:71], v[36:39], v[220:223]
    s_sub_u32 s74, s74, s48
    ds_read_b64_tr_b16 v[64:65], v9 offset:24
    s_add_u32 s75, s3, 1
    v_mfma_f32_16x16x32_bf16 v[200:203], v[68:71], v[32:35], v[200:203]
    s_and_b32 s75, s75, 3
    ds_read_b64_tr_b16 v[66:67], v9 offset:7704
    s_mul_i32 s75, s75, 69632
    v_mfma_f32_16x16x32_bf16 v[200:203], v[72:75], a[244:247], v[200:203]
    s_waitcnt lgkmcnt(4)
    buffer_load_dwordx4 v18, s[28:31], s65 offen offset:2048 lds
    s_add_u32 s4, s75, s73
    v_mfma_f32_16x16x32_bf16 v[204:207], a[240:243], a[244:247], v[204:207]
    s_add_u32 s8, s4, s74
    ds_read_b64_tr_b16 v[68:69], v9 offset:32
    s_add_u32 s75, s3, 2
    v_mfma_f32_16x16x32_bf16 v[204:207], v[56:59], v[32:35], v[204:207]
    s_and_b32 s75, s75, 3
    ds_read_b64_tr_b16 v[70:71], v9 offset:7712
    s_mul_i32 s75, s75, 69632
    v_mfma_f32_16x16x32_bf16 v[224:227], v[56:59], v[36:39], v[224:227]
    s_add_u32 s5, s75, s73
    s_add_u32 s9, s5, s74
    v_mfma_f32_16x16x32_bf16 v[224:227], a[240:243], a[248:251], v[224:227]
    s_add_u32 s75, s3, 3
    ds_read_b64_tr_b16 v[72:73], v8 offset:32
    s_and_b32 s75, s75, 3
    v_mfma_f32_16x16x32_bf16 v[244:247], a[240:243], a[252:255], v[244:247]
    s_mul_i32 s75, s75, 69632
    ds_read_b64_tr_b16 v[74:75], v8 offset:7712
    s_add_u32 s6, s75, s73
    v_mfma_f32_16x16x32_bf16 v[244:247], v[56:59], v[40:43], v[244:247]
    s_waitcnt lgkmcnt(4)
    buffer_load_dwordx4 v19, s[28:31], s65 offen offset:3072 lds
    s_bfe_u32 s64, s77, 0x40010
    v_mfma_f32_16x16x32_bf16 v[248:251], v[60:63], v[40:43], v[248:251]
    s_lshl_b32 s64, s64, 7
    ds_read_b64_tr_b16 a[240:241], v8 offset:160
    s_add_u32 m0, s62, 106752
    v_mfma_f32_16x16x32_bf16 v[248:251], v[64:67], a[252:255], v[248:251]
    s_add_u32 s10, s6, s74
    ds_read_b64_tr_b16 a[242:243], v8 offset:7840
    s_add_u32 s75, s3, 4
    v_mfma_f32_16x16x32_bf16 v[228:231], v[64:67], a[248:251], v[228:231]
    s_and_b32 s75, s75, 3
    s_mul_i32 s75, s75, 69632
    v_mfma_f32_16x16x32_bf16 v[228:231], v[60:63], v[36:39], v[228:231]
    s_add_u32 s7, s75, s73
    ds_read_b64_tr_b16 v[56:57], v9 offset:160
    s_add_u32 s11, s7, s74
Q_PG1:
    s_cbranch_execz Q_PG5
    v_mfma_f32_16x16x32_bf16 v[208:211], v[60:63], v[32:35], v[208:211]
    s_mul_i32 s23, s56, 384
    ds_read_b64_tr_b16 v[58:59], v9 offset:7840
    v_mfma_f32_16x16x32_bf16 v[208:211], v[64:67], a[244:247], v[208:211]
    s_waitcnt lgkmcnt(4)
    buffer_load_dwordx4 v10, s[24:27], s64 offen offset:0 lds
    s_add_u32 s23, s23, 3212288
    v_mfma_f32_16x16x32_bf16 v[212:215], v[68:71], a[244:247], v[212:215]
    s_mov_b32 s14, 0xeeeeeeee
    ds_read_b64_tr_b16 v[60:61], v9 offset:168
    v_mfma_f32_16x16x32_bf16 v[212:215], v[72:75], v[32:35], v[212:215]
    s_mov_b32 s15, 0xeeeeeeee
    ds_read_b64_tr_b16 v[62:63], v9 offset:7848
    v_mfma_f32_16x16x32_bf16 v[232:235], v[72:75], v[36:39], v[232:235]
    s_mov_b32 s16, 0xcccccccc
    s_mov_b32 s17, 0xcccccccc
    v_mfma_f32_16x16x32_bf16 v[232:235], v[68:71], a[248:251], v[232:235]
    s_mov_b32 s18, 0x88888888
    ds_read_b64_tr_b16 v[64:65], v8 offset:168
    v_mfma_f32_16x16x32_bf16 v[252:255], v[68:71], a[252:255], v[252:255]
    s_mov_b32 s19, 0x88888888
    ds_read_b64_tr_b16 v[66:67], v8 offset:7848
    s_and_b32 s73, s58, 1
    v_mfma_f32_16x16x32_bf16 v[252:255], v[72:75], v[40:43], v[252:255]
    s_waitcnt lgkmcnt(4) vmcnt(5)
    s_barrier
    ds_read_b128 v[44:47], v6 offset:0
    v_mfma_f32_16x16x32_bf16 v[96:99], a[240:243], v[40:43], v[96:99]
    s_mul_i32 s79, s73, -768
    ds_read_b64_tr_b16 v[68:69], v8 offset:176
    v_mfma_f32_16x16x32_bf16 v[96:99], v[56:59], a[252:255], v[96:99]
    s_add_u32 s79, s79, 2048
    ds_read_b64_tr_b16 v[70:71], v8 offset:7856
    s_lshr_b32 s74, s58, 1
    v_mfma_f32_16x16x32_bf16 v[176:179], v[56:59], a[248:251], v[176:179]
    s_mul_i32 s74, s74, 2560
    buffer_load_dwordx4 v11, s[24:27], s64 offen offset:1024 lds
    s_lshl_b32 s73, s73, 10
    v_mfma_f32_16x16x32_bf16 v[176:179], a[240:243], v[36:39], v[176:179]
    s_add_u32 m0, s62, 108800
    ds_read_b64_tr_b16 v[72:73], v9 offset:176
    s_add_u32 s73, s73, s74
    v_mfma_f32_16x16x32_bf16 v[76:79], a[240:243], v[32:35], v[76:79]
    s_mul_i32 s74, s78, 4352
    ds_read_b64_tr_b16 v[74:75], v9 offset:7856
    s_add_u32 s73, s73, s74
    v_mfma_f32_16x16x32_bf16 v[76:79], v[56:59], a[244:247], v[76:79]
    s_waitcnt lgkmcnt(5)
    ds_read_b128 v[48:51], v4 offset:2048
    s_sub_u32 s73, s73, s48
    v_mfma_f32_16x16x32_bf16 v[80:83], v[60:63], a[244:247], v[80:83]
    s_add_u32 s20, s73, 24576
    ds_read_b64_tr_b16 a[240:241], v8 offset:184
    v_mfma_f32_16x16x32_bf16 v[80:83], v[64:67], v[32:35], v[80:83]
    s_add_u32 s21, s20, 69632
    ds_read_b64_tr_b16 a[242:243], v8 offset:7864
    v_mfma_f32_16x16x32_bf16 v[180:183], v[64:67], v[36:39], v[180:183]
    s_add_u32 s22, s20, 139264
    buffer_load_dwordx4 v12, s[24:27], s64 offen offset:0 lds
    s_lshr_b32 s73, 1, s56
    v_mfma_f32_16x16x32_bf16 v[180:183], v[60:63], a[248:251], v[180:183]
    s_lshl_b32 s73, s73, 30
    ds_read_b64_tr_b16 v[56:57], v8 offset:16568
    s_add_u32 s20, s20, s73
    v_mfma_f32_16x16x32_bf16 v[100:103], v[60:63], a[252:255], v[100:103]
    s_lshl3_add_u32 s70, s57, s58
    ds_read_b64_tr_b16 v[58:59], v8 offset:24248
    s_lshl_b32 s70, s70, 7
    v_mfma_f32_16x16x32_bf16 v[100:103], v[64:67], v[40:43], v[100:103]
    s_waitcnt lgkmcnt(5)
    ds_read_b128 v[52:55], v4 offset:4096
    s_lshl_b32 s73, s56, 28
    v_mfma_f32_16x16x32_bf16 v[104:107], v[68:71], v[40:43], v[104:107]
    s_add_u32 s70, s70, s73
    ds_read_b64_tr_b16 v[60:61], v8 offset:16576
    s_add_u32 s70, s70, 3232768
    v_mfma_f32_16x16x32_bf16 v[104:107], v[72:75], a[252:255], v[104:107]
    ds_read_b64_tr_b16 v[62:63], v8 offset:24256
    v_mfma_f32_16x16x32_bf16 v[184:187], v[72:75], a[248:251], v[184:187]
    buffer_load_dwordx4 v13, s[24:27], s64 offen offset:1024 lds
    v_mfma_f32_16x16x32_bf16 v[184:187], v[68:71], v[36:39], v[184:187]
    ds_read_b64_tr_b16 v[64:65], v8 offset:192
    v_mfma_f32_16x16x32_bf16 v[84:87], v[68:71], v[32:35], v[84:87]
    ds_read_b64_tr_b16 v[66:67], v8 offset:7872
    v_mfma_f32_16x16x32_bf16 v[84:87], v[72:75], a[244:247], v[84:87]
    s_waitcnt lgkmcnt(4)
    buffer_load_dwordx4 v14, s[24:27], s64 offen offset:2048 lds
    v_mfma_f32_16x16x32_bf16 v[88:91], a[240:243], v[32:35], v[88:91]
    ds_read_b64_tr_b16 v[68:69], v8 offset:320
    v_mfma_f32_16x16x32_bf16 v[88:91], v[56:59], v[44:47], v[88:91]
    ds_read_b64_tr_b16 v[70:71], v8 offset:8000
    v_mfma_f32_16x16x32_bf16 v[188:191], v[56:59], v[48:51], v[188:191]
    buffer_load_dwordx4 v15, s[24:27], s64 offen offset:3072 lds
    s_bfe_u32 s65, s77, 0x40010
    v_mfma_f32_16x16x32_bf16 v[188:191], a[240:243], v[36:39], v[188:191]
    s_lshl1_add_u32 s65, s65, s76
    ds_read_b64_tr_b16 v[72:73], v8 offset:16704
    s_mul_i32 s65, s65, 122880
    v_mfma_f32_16x16x32_bf16 v[108:111], a[240:243], v[40:43], v[108:111]
    s_add_u32 m0, s63, 49152
    ds_read_b64_tr_b16 v[74:75], v8 offset:24384
    v_mfma_f32_16x16x32_bf16 v[108:111], v[56:59], v[52:55], v[108:111]
    s_waitcnt lgkmcnt(4)
    buffer_load_dwordx4 v16, s[28:31], s65 offen offset:0 lds
    v_mfma_f32_16x16x32_bf16 v[112:115], v[60:63], v[52:55], v[112:115]
    ds_read_b64_tr_b16 a[240:241], v8 offset:16712
    v_mfma_f32_16x16x32_bf16 v[112:115], v[64:67], v[40:43], v[112:115]
    ds_read_b64_tr_b16 a[242:243], v8 offset:24392
    v_mfma_f32_16x16x32_bf16 v[192:195], v[64:67], v[36:39], v[192:195]
    buffer_load_dwordx4 v17, s[28:31], s65 offen offset:1024 lds
    v_mfma_f32_16x16x32_bf16 v[192:195], v[60:63], v[48:51], v[192:195]
    ds_read_b64_tr_b16 v[56:57], v8 offset:328
    v_mfma_f32_16x16x32_bf16 v[92:95], v[60:63], v[44:47], v[92:95]
    ds_read_b64_tr_b16 v[58:59], v8 offset:8008
    v_mfma_f32_16x16x32_bf16 v[92:95], v[64:67], v[32:35], v[92:95]
    s_waitcnt lgkmcnt(4)
    v_mfma_f32_16x16x32_bf16 v[116:119], v[68:71], v[32:35], v[116:119]
    ds_read_b64_tr_b16 v[60:61], v8 offset:336
    v_mfma_f32_16x16x32_bf16 v[116:119], v[72:75], v[44:47], v[116:119]
    ds_read_b64_tr_b16 v[62:63], v8 offset:8016
    v_mfma_f32_16x16x32_bf16 v[136:139], v[72:75], v[48:51], v[136:139]
    buffer_load_dwordx4 v18, s[28:31], s65 offen offset:2048 lds
    v_mfma_f32_16x16x32_bf16 v[136:139], v[68:71], v[36:39], v[136:139]
    ds_read_b64_tr_b16 v[64:65], v8 offset:16720
    v_mfma_f32_16x16x32_bf16 v[156:159], v[68:71], v[40:43], v[156:159]
    ds_read_b64_tr_b16 v[66:67], v8 offset:24400
    v_mfma_f32_16x16x32_bf16 v[156:159], v[72:75], v[52:55], v[156:159]
    s_waitcnt lgkmcnt(4)
    v_mfma_f32_16x16x32_bf16 v[160:163], a[240:243], v[52:55], v[160:163]
    ds_read_b64_tr_b16 v[68:69], v8 offset:16728
    v_mfma_f32_16x16x32_bf16 v[160:163], v[56:59], v[40:43], v[160:163]
    ds_read_b64_tr_b16 v[70:71], v8 offset:24408
    v_mfma_f32_16x16x32_bf16 v[140:143], v[56:59], v[36:39], v[140:143]
    buffer_load_dwordx4 v19, s[28:31], s65 offen offset:3072 lds
    s_add_u32 s65, s65, s101
    v_mfma_f32_16x16x32_bf16 v[140:143], a[240:243], v[48:51], v[140:143]
    ds_read_b64_tr_b16 v[72:73], v8 offset:344
    v_mfma_f32_16x16x32_bf16 v[120:123], a[240:243], v[44:47], v[120:123]
    ds_read_b64_tr_b16 v[74:75], v8 offset:8024
    v_mfma_f32_16x16x32_bf16 v[120:123], v[56:59], v[32:35], v[120:123]
    s_waitcnt lgkmcnt(4)
    v_mfma_f32_16x16x32_bf16 v[124:127], v[60:63], v[32:35], v[124:127]
    ds_read_b64_tr_b16 a[240:241], v8 offset:352
    v_mfma_f32_16x16x32_bf16 v[124:127], v[64:67], v[44:47], v[124:127]
    ds_read_b64_tr_b16 a[242:243], v8 offset:8032
    v_mfma_f32_16x16x32_bf16 v[144:147], v[64:67], v[48:51], v[144:147]
    s_waitcnt vmcnt(10)
    s_barrier
    ds_read_b128 a[244:247], v7 offset:0
    v_mfma_f32_16x16x32_bf16 v[144:147], v[60:63], v[36:39], v[144:147]
    s_add_u32 m0, s63, 65536
    ds_read_b64_tr_b16 v[56:57], v8 offset:16736
    v_mfma_f32_16x16x32_bf16 v[164:167], v[60:63], v[40:43], v[164:167]
    ds_read_b64_tr_b16 v[58:59], v8 offset:24416
    v_mfma_f32_16x16x32_bf16 v[164:167], v[64:67], v[52:55], v[164:167]
    s_waitcnt lgkmcnt(5)
    ds_read_b128 a[248:251], v5 offset:2048
    v_mfma_f32_16x16x32_bf16 v[168:171], v[68:71], v[52:55], v[168:171]
    ds_read_b64_tr_b16 v[60:61], v8 offset:16384
    v_mfma_f32_16x16x32_bf16 v[168:171], v[72:75], v[40:43], v[168:171]
    ds_read_b64_tr_b16 v[62:63], v8 offset:24064
    v_mfma_f32_16x16x32_bf16 v[148:151], v[72:75], v[36:39], v[148:151]
    ds_read_b128 a[252:255], v5 offset:4096
    v_mfma_f32_16x16x32_bf16 v[148:151], v[68:71], v[48:51], v[148:151]
    ds_read_b64_tr_b16 v[64:65], v8 offset:32768
    v_mfma_f32_16x16x32_bf16 v[128:131], v[68:71], v[44:47], v[128:131]
    ds_read_b64_tr_b16 v[66:67], v8 offset:40448
    v_mfma_f32_16x16x32_bf16 v[128:131], v[72:75], v[32:35], v[128:131]
    s_waitcnt lgkmcnt(6)
    buffer_load_dwordx4 v16, s[28:31], s65 offen offset:0 lds
    v_mfma_f32_16x16x32_bf16 v[132:135], a[240:243], v[32:35], v[132:135]
    ds_read_b64_tr_b16 v[68:69], v8 offset:32776
    v_mfma_f32_16x16x32_bf16 v[132:135], v[56:59], v[44:47], v[132:135]
    ds_read_b64_tr_b16 v[70:71], v8 offset:40456
    v_mfma_f32_16x16x32_bf16 v[152:155], v[56:59], v[48:51], v[152:155]
    buffer_load_dwordx4 v17, s[28:31], s65 offen offset:1024 lds
    v_mfma_f32_16x16x32_bf16 v[152:155], a[240:243], v[36:39], v[152:155]
    ds_read_b64_tr_b16 v[72:73], v8 offset:16392
    v_mfma_f32_16x16x32_bf16 v[172:175], a[240:243], v[40:43], v[172:175]
    ds_read_b64_tr_b16 v[74:75], v8 offset:24072
    v_mfma_f32_16x16x32_bf16 v[172:175], v[56:59], v[52:55], v[172:175]
    s_waitcnt lgkmcnt(4)
    buffer_load_dwordx4 v18, s[28:31], s65 offen offset:2048 lds
    v_mfma_f32_16x16x32_bf16 v[196:199], v[60:63], v[44:47], v[196:199]
    ds_read_b64_tr_b16 a[240:241], v8 offset:16400
    v_mfma_f32_16x16x32_bf16 v[196:199], v[64:67], a[244:247], v[196:199]
    ds_read_b64_tr_b16 a[242:243], v8 offset:24080
    v_mfma_f32_16x16x32_bf16 v[216:219], v[64:67], a[248:251], v[216:219]
    buffer_load_dwordx4 v19, s[28:31], s65 offen offset:3072 lds
    s_bfe_u32 s64, s77, 0x40014
    v_mfma_f32_16x16x32_bf16 v[216:219], v[60:63], v[48:51], v[216:219]
    s_lshl_b32 s64, s64, 7
    ds_read_b64_tr_b16 v[56:57], v8 offset:32784
    s_add_u32 m0, s62, 131584
    v_mfma_f32_16x16x32_bf16 v[236:239], v[60:63], v[52:55], v[236:239]
    ds_read_b64_tr_b16 v[58:59], v8 offset:40464
    v_mfma_f32_16x16x32_bf16 v[236:239], v[64:67], a[252:255], v[236:239]
    s_waitcnt lgkmcnt(4)
    v_mfma_f32_16x16x32_bf16 v[240:243], v[68:71], a[252:255], v[240:243]
    ds_read_b64_tr_b16 v[60:61], v8 offset:32792
    v_mfma_f32_16x16x32_bf16 v[240:243], v[72:75], v[52:55], v[240:243]
    ds_read_b64_tr_b16 v[62:63], v8 offset:40472
    v_mfma_f32_16x16x32_bf16 v[220:223], v[72:75], v[48:51], v[220:223]
    buffer_load_dwordx4 v10, s[24:27], s64 offen offset:0 lds
    v_mfma_f32_16x16x32_bf16 v[220:223], v[68:71], a[248:251], v[220:223]
    ds_read_b64_tr_b16 v[64:65], v8 offset:16408
    v_mfma_f32_16x16x32_bf16 v[200:203], v[68:71], a[244:247], v[200:203]
    ds_read_b64_tr_b16 v[66:67], v8 offset:24088
    v_mfma_f32_16x16x32_bf16 v[200:203], v[72:75], v[44:47], v[200:203]
    s_waitcnt lgkmcnt(4)
    v_mfma_f32_16x16x32_bf16 v[204:207], a[240:243], v[44:47], v[204:207]
    ds_read_b64_tr_b16 v[68:69], v8 offset:16416
    v_mfma_f32_16x16x32_bf16 v[204:207], v[56:59], a[244:247], v[204:207]
    ds_read_b64_tr_b16 v[70:71], v8 offset:24096
    v_mfma_f32_16x16x32_bf16 v[224:227], v[56:59], a[248:251], v[224:227]
    buffer_load_dwordx4 v11, s[24:27], s64 offen offset:1024 lds
    s_add_u32 m0, s62, 133632
    v_mfma_f32_16x16x32_bf16 v[224:227], a[240:243], v[48:51], v[224:227]
    ds_read_b64_tr_b16 v[72:73], v8 offset:32800
    v_mfma_f32_16x16x32_bf16 v[244:247], a[240:243], v[52:55], v[244:247]
    ds_read_b64_tr_b16 v[74:75], v8 offset:40480
    v_mfma_f32_16x16x32_bf16 v[244:247], v[56:59], a[252:255], v[244:247]
    s_waitcnt lgkmcnt(4)
    v_mfma_f32_16x16x32_bf16 v[248:251], v[60:63], a[252:255], v[248:251]
    ds_read_b64_tr_b16 a[240:241], v8 offset:32928
    v_mfma_f32_16x16x32_bf16 v[248:251], v[64:67], v[52:55], v[248:251]
    ds_read_b64_tr_b16 a[242:243], v8 offset:40608
    v_mfma_f32_16x16x32_bf16 v[228:231], v[64:67], v[48:51], v[228:231]
    s_waitcnt vmcnt(6)
    s_barrier
    ds_read_b128 v[32:35], v6 offset:24832
    v_mfma_f32_16x16x32_bf16 v[228:231], v[60:63], a[248:251], v[228:231]
    ds_read_b64_tr_b16 v[56:57], v8 offset:16544
    v_mfma_f32_16x16x32_bf16 v[208:211], v[60:63], a[244:247], v[208:211]
    ds_read_b64_tr_b16 v[58:59], v8 offset:24224
    v_mfma_f32_16x16x32_bf16 v[208:211], v[64:67], v[44:47], v[208:211]
    s_waitcnt lgkmcnt(5)
    buffer_load_dwordx4 v12, s[24:27], s64 offen offset:0 lds
    v_mfma_f32_16x16x32_bf16 v[212:215], v[68:71], v[44:47], v[212:215]
    ds_read_b64_tr_b16 v[60:61], v8 offset:16552
    v_mfma_f32_16x16x32_bf16 v[212:215], v[72:75], a[244:247], v[212:215]
    ds_read_b64_tr_b16 v[62:63], v8 offset:24232
    v_mfma_f32_16x16x32_bf16 v[232:235], v[72:75], a[248:251], v[232:235]
    buffer_load_dwordx4 v13, s[24:27], s64 offen offset:1024 lds
    v_mfma_f32_16x16x32_bf16 v[232:235], v[68:71], v[48:51], v[232:235]
    ds_read_b64_tr_b16 v[64:65], v8 offset:32936
    v_mfma_f32_16x16x32_bf16 v[252:255], v[68:71], v[52:55], v[252:255]
    ds_read_b64_tr_b16 v[66:67], v8 offset:40616
    v_mfma_f32_16x16x32_bf16 v[252:255], v[72:75], a[252:255], v[252:255]
    s_waitcnt lgkmcnt(4)
    ds_read_b128 v[36:39], v4 offset:26880
    v_mfma_f32_16x16x32_bf16 v[96:99], a[240:243], a[252:255], v[96:99]
    ds_read_b64_tr_b16 v[68:69], v8 offset:32944
    v_mfma_f32_16x16x32_bf16 v[96:99], v[56:59], v[52:55], v[96:99]
    ds_read_b64_tr_b16 v[70:71], v8 offset:40624
    v_mfma_f32_16x16x32_bf16 v[176:179], v[56:59], v[48:51], v[176:179]
    buffer_load_dwordx4 v14, s[24:27], s64 offen offset:2048 lds
    v_mfma_f32_16x16x32_bf16 v[176:179], a[240:243], a[248:251], v[176:179]
    ds_read_b64_tr_b16 v[72:73], v8 offset:16560
    v_mfma_f32_16x16x32_bf16 v[76:79], a[240:243], a[244:247], v[76:79]
    ds_read_b64_tr_b16 v[74:75], v8 offset:24240
    v_mfma_f32_16x16x32_bf16 v[76:79], v[56:59], v[44:47], v[76:79]
    s_waitcnt lgkmcnt(5)
    buffer_load_dwordx4 v15, s[24:27], s64 offen offset:3072 lds
    s_bfe_u32 s65, s77, 0x40014
    v_mfma_f32_16x16x32_bf16 v[80:83], v[60:63], v[44:47], v[80:83]
    s_lshl1_add_u32 s65, s65, s76
    ds_read_b64_tr_b16 a[240:241], v8 offset:32952
    s_mul_i32 s65, s65, 122880
    v_mfma_f32_16x16x32_bf16 v[80:83], v[64:67], a[244:247], v[80:83]
    s_add_u32 m0, s63, 0
    ds_read_b64_tr_b16 a[242:243], v8 offset:40632
    v_mfma_f32_16x16x32_bf16 v[180:183], v[64:67], a[248:251], v[180:183]
    ds_read_b128 v[40:43], v4 offset:28928
    v_mfma_f32_16x16x32_bf16 v[180:183], v[60:63], v[48:51], v[180:183]
    ds_read_b64_tr_b16 v[56:57], v8 offset:49336
    v_mfma_f32_16x16x32_bf16 v[100:103], v[60:63], v[52:55], v[100:103]
    ds_read_b64_tr_b16 v[58:59], v8 offset:57016
    v_mfma_f32_16x16x32_bf16 v[100:103], v[64:67], a[252:255], v[100:103]
    s_waitcnt lgkmcnt(5)
    buffer_load_dwordx4 v16, s[28:31], s65 offen offset:0 lds
    v_mfma_f32_16x16x32_bf16 v[104:107], v[68:71], a[252:255], v[104:107]
    ds_read_b64_tr_b16 v[60:61], v8 offset:49344
    v_mfma_f32_16x16x32_bf16 v[104:107], v[72:75], v[52:55], v[104:107]
    ds_read_b64_tr_b16 v[62:63], v8 offset:57024
    v_mfma_f32_16x16x32_bf16 v[184:187], v[72:75], v[48:51], v[184:187]
    buffer_load_dwordx4 v17, s[28:31], s65 offen offset:1024 lds
    v_mfma_f32_16x16x32_bf16 v[184:187], v[68:71], a[248:251], v[184:187]
    ds_read_b64_tr_b16 v[64:65], v8 offset:32960
    v_mfma_f32_16x16x32_bf16 v[84:87], v[68:71], a[244:247], v[84:87]
    ds_read_b64_tr_b16 v[66:67], v8 offset:40640
    v_mfma_f32_16x16x32_bf16 v[84:87], v[72:75], v[44:47], v[84:87]
    s_waitcnt lgkmcnt(4)
    buffer_load_dwordx4 v18, s[28:31], s65 offen offset:2048 lds
    v_mfma_f32_16x16x32_bf16 v[88:91], a[240:243], a[244:247], v[88:91]
    ds_read_b64_tr_b16 v[68:69], v8 offset:33088
    v_mfma_f32_16x16x32_bf16 v[88:91], v[56:59], v[32:35], v[88:91]
    ds_read_b64_tr_b16 v[70:71], v8 offset:40768
    v_mfma_f32_16x16x32_bf16 v[188:191], v[56:59], v[36:39], v[188:191]
    buffer_load_dwordx4 v19, s[28:31], s65 offen offset:3072 lds
    s_add_u32 s65, s65, s101
    v_mfma_f32_16x16x32_bf16 v[188:191], a[240:243], a[248:251], v[188:191]
    ds_read_b64_tr_b16 v[72:73], v8 offset:49472
    v_mfma_f32_16x16x32_bf16 v[108:111], a[240:243], a[252:255], v[108:111]
    ds_read_b64_tr_b16 v[74:75], v8 offset:57152
    v_mfma_f32_16x16x32_bf16 v[108:111], v[56:59], v[40:43], v[108:111]
    s_waitcnt lgkmcnt(4)
    v_mfma_f32_16x16x32_bf16 v[112:115], v[60:63], v[40:43], v[112:115]
    ds_read_b64_tr_b16 a[240:241], v8 offset:49480
    v_mfma_f32_16x16x32_bf16 v[112:115], v[64:67], a[252:255], v[112:115]
    ds_read_b64_tr_b16 a[242:243], v8 offset:57160
    v_mfma_f32_16x16x32_bf16 v[192:195], v[64:67], a[248:251], v[192:195]
    v_mfma_f32_16x16x32_bf16 v[192:195], v[60:63], v[36:39], v[192:195]
    ds_read_b64_tr_b16 v[56:57], v8 offset:33096
    v_mfma_f32_16x16x32_bf16 v[92:95], v[60:63], v[32:35], v[92:95]
    ds_read_b64_tr_b16 v[58:59], v8 offset:40776
    v_mfma_f32_16x16x32_bf16 v[92:95], v[64:67], a[244:247], v[92:95]
    s_waitcnt lgkmcnt(4)
    v_mfma_f32_16x16x32_bf16 v[116:119], v[68:71], a[244:247], v[116:119]
    ds_read_b64_tr_b16 v[60:61], v8 offset:33104
    v_mfma_f32_16x16x32_bf16 v[116:119], v[72:75], v[32:35], v[116:119]
    ds_read_b64_tr_b16 v[62:63], v8 offset:40784
    v_mfma_f32_16x16x32_bf16 v[136:139], v[72:75], v[36:39], v[136:139]
    v_mfma_f32_16x16x32_bf16 v[136:139], v[68:71], a[248:251], v[136:139]
    ds_read_b64_tr_b16 v[64:65], v8 offset:49488
    v_mfma_f32_16x16x32_bf16 v[156:159], v[68:71], a[252:255], v[156:159]
    ds_read_b64_tr_b16 v[66:67], v8 offset:57168
    v_mfma_f32_16x16x32_bf16 v[156:159], v[72:75], v[40:43], v[156:159]
    s_waitcnt lgkmcnt(4) vmcnt(10)
    s_barrier
    ds_read_b128 v[44:47], v7 offset:24832
    v_mfma_f32_16x16x32_bf16 v[160:163], a[240:243], v[40:43], v[160:163]
    s_add_u32 m0, s63, 16384
    ds_read_b64_tr_b16 v[68:69], v8 offset:49496
    v_mfma_f32_16x16x32_bf16 v[160:163], v[56:59], a[252:255], v[160:163]
    ds_read_b64_tr_b16 v[70:71], v8 offset:57176
    v_mfma_f32_16x16x32_bf16 v[140:143], v[56:59], a[248:251], v[140:143]
    buffer_load_dwordx4 v16, s[28:31], s65 offen offset:0 lds
    v_mfma_f32_16x16x32_bf16 v[140:143], a[240:243], v[36:39], v[140:143]
    ds_read_b64_tr_b16 v[72:73], v8 offset:33112
    v_mfma_f32_16x16x32_bf16 v[120:123], a[240:243], v[32:35], v[120:123]
    ds_read_b64_tr_b16 v[74:75], v8 offset:40792
    v_mfma_f32_16x16x32_bf16 v[120:123], v[56:59], a[244:247], v[120:123]
    s_waitcnt lgkmcnt(5)
    buffer_load_dwordx4 v17, s[28:31], s65 offen offset:1024 lds
    v_mfma_f32_16x16x32_bf16 v[124:127], v[60:63], a[244:247], v[124:127]
    ds_read_b64_tr_b16 a[240:241], v8 offset:33120
    v_mfma_f32_16x16x32_bf16 v[124:127], v[64:67], v[32:35], v[124:127]
    ds_read_b64_tr_b16 a[242:243], v8 offset:40800
    v_mfma_f32_16x16x32_bf16 v[144:147], v[64:67], v[36:39], v[144:147]
    ds_read_b128 v[48:51], v5 offset:26880
    v_mfma_f32_16x16x32_bf16 v[144:147], v[60:63], a[248:251], v[144:147]
    ds_read_b64_tr_b16 v[56:57], v8 offset:49504
    v_mfma_f32_16x16x32_bf16 v[164:167], v[60:63], a[252:255], v[164:167]
    ds_read_b64_tr_b16 v[58:59], v8 offset:57184
    v_mfma_f32_16x16x32_bf16 v[164:167], v[64:67], v[40:43], v[164:167]
    s_waitcnt lgkmcnt(5)
    buffer_load_dwordx4 v18, s[28:31], s65 offen offset:2048 lds
    v_mfma_f32_16x16x32_bf16 v[168:171], v[68:71], v[40:43], v[168:171]
    ds_read_b64_tr_b16 v[60:61], v8 offset:49152
    v_mfma_f32_16x16x32_bf16 v[168:171], v[72:75], a[252:255], v[168:171]
    ds_read_b64_tr_b16 v[62:63], v8 offset:56832
    v_mfma_f32_16x16x32_bf16 v[148:151], v[72:75], a[248:251], v[148:151]
    buffer_load_dword v20, off, s[52:55], 0 offset:0 sc1
    v_mfma_f32_16x16x32_bf16 v[148:151], v[68:71], v[36:39], v[148:151]
    ds_read_b64_tr_b16 v[64:65], v9 offset:0
    v_mfma_f32_16x16x32_bf16 v[128:131], v[68:71], v[32:35], v[128:131]
    ds_read_b64_tr_b16 v[66:67], v9 offset:7680
    v_mfma_f32_16x16x32_bf16 v[128:131], v[72:75], a[244:247], v[128:131]
    s_waitcnt lgkmcnt(4)
    ds_read_b128 v[52:55], v5 offset:28928
    v_mfma_f32_16x16x32_bf16 v[132:135], a[240:243], a[244:247], v[132:135]
    ds_read_b64_tr_b16 v[68:69], v9 offset:8
    v_mfma_f32_16x16x32_bf16 v[132:135], v[56:59], v[32:35], v[132:135]
    ds_read_b64_tr_b16 v[70:71], v9 offset:7688
    v_mfma_f32_16x16x32_bf16 v[152:155], v[56:59], v[36:39], v[152:155]
    buffer_load_dwordx4 v19, s[28:31], s65 offen offset:3072 lds
    s_bfe_u32 s64, s77, 0x40018
    v_mfma_f32_16x16x32_bf16 v[152:155], a[240:243], a[248:251], v[152:155]
    s_lshl_b32 s64, s64, 7
    ds_read_b64_tr_b16 v[72:73], v8 offset:49160
    s_add_u32 m0, s62, 81920
    v_mfma_f32_16x16x32_bf16 v[172:175], a[240:243], a[252:255], v[172:175]
    ds_read_b64_tr_b16 v[74:75], v8 offset:56840
    v_mfma_f32_16x16x32_bf16 v[172:175], v[56:59], v[40:43], v[172:175]
    s_waitcnt lgkmcnt(4)
    v_mfma_f32_16x16x32_bf16 v[196:199], v[60:63], v[32:35], v[196:199]
    ds_read_b64_tr_b16 a[240:241], v8 offset:49168
    v_mfma_f32_16x16x32_bf16 v[196:199], v[64:67], v[44:47], v[196:199]
    ds_read_b64_tr_b16 a[242:243], v8 offset:56848
    v_mfma_f32_16x16x32_bf16 v[216:219], v[64:67], v[48:51], v[216:219]
    buffer_load_dwordx4 v10, s[24:27], s64 offen offset:0 lds
    v_mfma_f32_16x16x32_bf16 v[216:219], v[60:63], v[36:39], v[216:219]
    ds_read_b64_tr_b16 v[56:57], v9 offset:16
    v_mfma_f32_16x16x32_bf16 v[236:239], v[60:63], v[40:43], v[236:239]
    ds_read_b64_tr_b16 v[58:59], v9 offset:7696
    v_mfma_f32_16x16x32_bf16 v[236:239], v[64:67], v[52:55], v[236:239]
    s_waitcnt lgkmcnt(4)
    v_mfma_f32_16x16x32_bf16 v[240:243], v[68:71], v[52:55], v[240:243]
    ds_read_b64_tr_b16 v[60:61], v9 offset:24
    v_mfma_f32_16x16x32_bf16 v[240:243], v[72:75], v[40:43], v[240:243]
    ds_read_b64_tr_b16 v[62:63], v9 offset:7704
    v_mfma_f32_16x16x32_bf16 v[220:223], v[72:75], v[36:39], v[220:223]
    buffer_load_dwordx4 v11, s[24:27], s64 offen offset:1024 lds
    s_add_u32 m0, s62, 83968
    v_mfma_f32_16x16x32_bf16 v[220:223], v[68:71], v[48:51], v[220:223]
    ds_read_b64_tr_b16 v[64:65], v8 offset:49176
    v_mfma_f32_16x16x32_bf16 v[200:203], v[68:71], v[44:47], v[200:203]
    ds_read_b64_tr_b16 v[66:67], v8 offset:56856
    v_mfma_f32_16x16x32_bf16 v[200:203], v[72:75], v[32:35], v[200:203]
    s_waitcnt lgkmcnt(4)
    v_mfma_f32_16x16x32_bf16 v[204:207], a[240:243], v[32:35], v[204:207]
    ds_read_b64_tr_b16 v[68:69], v8 offset:49184
    v_mfma_f32_16x16x32_bf16 v[204:207], v[56:59], v[44:47], v[204:207]
    ds_read_b64_tr_b16 v[70:71], v8 offset:56864
    v_mfma_f32_16x16x32_bf16 v[224:227], v[56:59], v[48:51], v[224:227]
    buffer_load_dwordx4 v12, s[24:27], s64 offen offset:0 lds
    v_mfma_f32_16x16x32_bf16 v[224:227], a[240:243], v[36:39], v[224:227]
    ds_read_b64_tr_b16 v[72:73], v9 offset:32
    v_mfma_f32_16x16x32_bf16 v[244:247], a[240:243], v[40:43], v[244:247]
    ds_read_b64_tr_b16 v[74:75], v9 offset:7712
    v_mfma_f32_16x16x32_bf16 v[244:247], v[56:59], v[52:55], v[244:247]
    s_waitcnt lgkmcnt(4)
    v_mfma_f32_16x16x32_bf16 v[248:251], v[60:63], v[52:55], v[248:251]
    ds_read_b64_tr_b16 a[240:241], v9 offset:160
    v_mfma_f32_16x16x32_bf16 v[248:251], v[64:67], v[40:43], v[248:251]
    ds_read_b64_tr_b16 a[242:243], v9 offset:7840
    v_mfma_f32_16x16x32_bf16 v[228:231], v[64:67], v[36:39], v[228:231]
    s_waitcnt vmcnt(8)
    s_barrier
    ds_read_b128 a[244:247], v6 offset:49664
    v_mfma_f32_16x16x32_bf16 v[228:231], v[60:63], v[48:51], v[228:231]
    ds_read_b64_tr_b16 v[56:57], v8 offset:49312
    v_mfma_f32_16x16x32_bf16 v[208:211], v[60:63], v[44:47], v[208:211]
    ds_read_b64_tr_b16 v[58:59], v8 offset:56992
    v_mfma_f32_16x16x32_bf16 v[208:211], v[64:67], v[32:35], v[208:211]
    s_waitcnt lgkmcnt(5)
    buffer_load_dwordx4 v13, s[24:27], s64 offen offset:1024 lds
    v_mfma_f32_16x16x32_bf16 v[212:215], v[68:71], v[32:35], v[212:215]
    ds_read_b64_tr_b16 v[60:61], v8 offset:49320
    v_mfma_f32_16x16x32_bf16 v[212:215], v[72:75], v[44:47], v[212:215]
    ds_read_b64_tr_b16 v[62:63], v8 offset:57000
    v_mfma_f32_16x16x32_bf16 v[232:235], v[72:75], v[48:51], v[232:235]
    buffer_load_dwordx4 v14, s[24:27], s64 offen offset:2048 lds
    v_mfma_f32_16x16x32_bf16 v[232:235], v[68:71], v[36:39], v[232:235]
    ds_read_b64_tr_b16 v[64:65], v9 offset:168
    v_mfma_f32_16x16x32_bf16 v[252:255], v[68:71], v[40:43], v[252:255]
    ds_read_b64_tr_b16 v[66:67], v9 offset:7848
    v_mfma_f32_16x16x32_bf16 v[252:255], v[72:75], v[52:55], v[252:255]
    s_waitcnt lgkmcnt(4)
    ds_read_b128 a[248:251], v4 offset:51712
    v_mfma_f32_16x16x32_bf16 v[96:99], a[240:243], v[52:55], v[96:99]
    ds_read_b64_tr_b16 v[68:69], v9 offset:176
    v_mfma_f32_16x16x32_bf16 v[96:99], v[56:59], v[40:43], v[96:99]
    ds_read_b64_tr_b16 v[70:71], v9 offset:7856
    v_mfma_f32_16x16x32_bf16 v[176:179], v[56:59], v[36:39], v[176:179]
    buffer_load_dwordx4 v15, s[24:27], s64 offen offset:3072 lds
    s_bfe_u32 s65, s77, 0x40018
    v_mfma_f32_16x16x32_bf16 v[176:179], a[240:243], v[48:51], v[176:179]
    s_lshl1_add_u32 s65, s65, s76
    ds_read_b64_tr_b16 v[72:73], v8 offset:49328
    s_mul_i32 s65, s65, 122880
    v_mfma_f32_16x16x32_bf16 v[76:79], a[240:243], v[44:47], v[76:79]
    s_waitcnt vmcnt(7)
    ds_read_b64_tr_b16 v[74:75], v8 offset:57008
    v_cmp_gt_u32 vcc, 4, v20
    v_mfma_f32_16x16x32_bf16 v[76:79], v[56:59], v[32:35], v[76:79]
    s_waitcnt lgkmcnt(5)
    s_cbranch_vccnz Q_SPIN_D
Q_BACK_D:
    v_mfma_f32_16x16x32_bf16 v[80:83], v[60:63], v[32:35], v[80:83]
    s_add_u32 m0, s63, 32768
    ds_read_b64_tr_b16 a[240:241], v9 offset:184
    v_min_u32 v21, 16, v1
    v_mfma_f32_16x16x32_bf16 v[80:83], v[64:67], v[44:47], v[80:83]
    s_mul_i32 s71, s56, -7
    ds_read_b64_tr_b16 a[242:243], v9 offset:7864
    s_add_u32 s71, s71, 36
    v_mfma_f32_16x16x32_bf16 v[180:183], v[64:67], v[48:51], v[180:183]
    ds_read_b128 a[252:255], v4 offset:53760
    v_add_u32 v22, 4, v21
    v_mfma_f32_16x16x32_bf16 v[180:183], v[60:63], v[36:39], v[180:183]
    ds_read_b64_tr_b16 v[56:57], v8 offset:184
    v_lshrrev_b32 v22, 4, v22
    v_mfma_f32_16x16x32_bf16 v[100:103], v[60:63], v[40:43], v[100:103]
    ds_read_b64_tr_b16 v[58:59], v8 offset:7864
    v_mad_u32_u24 v21, v22, s71, v21
    v_mfma_f32_16x16x32_bf16 v[100:103], v[64:67], v[52:55], v[100:103]
    s_waitcnt lgkmcnt(5)
    buffer_load_dwordx4 v16, s[28:31], s65 offen offset:0 lds
    s_mul_i32 s71, s56, 24
    v_mfma_f32_16x16x32_bf16 v[104:107], v[68:71], v[52:55], v[104:107]
    s_lshr_b32 s72, s61, 2
    ds_read_b64_tr_b16 v[60:61], v8 offset:192
    s_add_u32 s71, s71, s72
    v_mfma_f32_16x16x32_bf16 v[104:107], v[72:75], v[40:43], v[104:107]
    s_lshl_b32 s71, s71, 7
    ds_read_b64_tr_b16 v[62:63], v8 offset:7872
    s_add_u32 s71, s71, 3245056
    v_mfma_f32_16x16x32_bf16 v[184:187], v[72:75], v[36:39], v[184:187]
    buffer_load_dwordx4 v17, s[28:31], s65 offen offset:1024 lds
    v_mfma_f32_16x16x32_bf16 v[184:187], v[68:71], v[48:51], v[184:187]
    ds_read_b64_tr_b16 v[64:65], v9 offset:192
    v_lshl_add_u32 v21, v21, 8, s71
    v_mfma_f32_16x16x32_bf16 v[84:87], v[68:71], v[44:47], v[84:87]
    ds_read_b64_tr_b16 v[66:67], v9 offset:7872
    v_mfma_f32_16x16x32_bf16 v[84:87], v[72:75], v[32:35], v[84:87]
    s_waitcnt lgkmcnt(4)
    buffer_load_dwordx4 v18, s[28:31], s65 offen offset:2048 lds
    v_mfma_f32_16x16x32_bf16 v[88:91], a[240:243], v[44:47], v[88:91]
    ds_read_b64_tr_b16 v[68:69], v9 offset:320
    v_mfma_f32_16x16x32_bf16 v[88:91], v[56:59], a[244:247], v[88:91]
    ds_read_b64_tr_b16 v[70:71], v9 offset:8000
    v_mfma_f32_16x16x32_bf16 v[188:191], v[56:59], a[248:251], v[188:191]
    buffer_load_dwordx4 v19, s[28:31], s65 offen offset:3072 lds
    s_add_u32 s65, s65, s101
    v_mfma_f32_16x16x32_bf16 v[188:191], a[240:243], v[48:51], v[188:191]
    ds_read_b64_tr_b16 v[72:73], v8 offset:320
    v_mfma_f32_16x16x32_bf16 v[108:111], a[240:243], v[52:55], v[108:111]
    ds_read_b64_tr_b16 v[74:75], v8 offset:8000
    v_mfma_f32_16x16x32_bf16 v[108:111], v[56:59], a[252:255], v[108:111]
    s_waitcnt lgkmcnt(4)
    v_mfma_f32_16x16x32_bf16 v[112:115], v[60:63], a[252:255], v[112:115]
    ds_read_b64_tr_b16 a[240:241], v8 offset:328
    v_mfma_f32_16x16x32_bf16 v[112:115], v[64:67], v[52:55], v[112:115]
    ds_read_b64_tr_b16 a[242:243], v8 offset:8008
    v_mfma_f32_16x16x32_bf16 v[192:195], v[64:67], v[48:51], v[192:195]
    v_mfma_f32_16x16x32_bf16 v[192:195], v[60:63], a[248:251], v[192:195]
    ds_read_b64_tr_b16 v[56:57], v9 offset:328
    v_mfma_f32_16x16x32_bf16 v[92:95], v[60:63], a[244:247], v[92:95]
    ds_read_b64_tr_b16 v[58:59], v9 offset:8008
    v_mfma_f32_16x16x32_bf16 v[92:95], v[64:67], v[44:47], v[92:95]
    s_waitcnt lgkmcnt(4)
    v_mfma_f32_16x16x32_bf16 v[116:119], v[68:71], v[44:47], v[116:119]
    ds_read_b64_tr_b16 v[60:61], v9 offset:336
    v_mfma_f32_16x16x32_bf16 v[116:119], v[72:75], a[244:247], v[116:119]
    ds_read_b64_tr_b16 v[62:63], v9 offset:8016
    v_mfma_f32_16x16x32_bf16 v[136:139], v[72:75], a[248:251], v[136:139]
    v_mfma_f32_16x16x32_bf16 v[136:139], v[68:71], v[48:51], v[136:139]
    ds_read_b64_tr_b16 v[64:65], v8 offset:336
    v_mfma_f32_16x16x32_bf16 v[156:159], v[68:71], v[52:55], v[156:159]
    ds_read_b64_tr_b16 v[66:67], v8 offset:8016
    v_mfma_f32_16x16x32_bf16 v[156:159], v[72:75], a[252:255], v[156:159]
    s_waitcnt lgkmcnt(4) vmcnt(10)
    s_barrier
    ds_read_b128 v[32:35], v7 offset:49664
    v_mfma_f32_16x16x32_bf16 v[160:163], a[240:243], a[252:255], v[160:163]
    s_add_u32 m0, s63, 49152
    ds_read_b64_tr_b16 v[68:69], v8 offset:344
    v_mfma_f32_16x16x32_bf16 v[160:163], v[56:59], v[52:55], v[160:163]
    ds_read_b64_tr_b16 v[70:71], v8 offset:8024
    v_mfma_f32_16x16x32_bf16 v[140:143], v[56:59], v[48:51], v[140:143]
    buffer_load_dwordx4 v16, s[28:31], s65 offen offset:0 lds
Q_PG2:
    s_cbranch_execz Q_PG6
    v_mfma_f32_16x16x32_bf16 v[140:143], a[240:243], a[248:251], v[140:143]
    ds_read_b64_tr_b16 v[72:73], v9 offset:344
    v_mfma_f32_16x16x32_bf16 v[120:123], a[240:243], a[244:247], v[120:123]
    ds_read_b64_tr_b16 v[74:75], v9 offset:8024
    v_mfma_f32_16x16x32_bf16 v[120:123], v[56:59], v[44:47], v[120:123]
    s_waitcnt lgkmcnt(5)
    buffer_load_dword v22, v21, s[40:43], 0 offen sc1
    v_mfma_f32_16x16x32_bf16 v[124:127], v[60:63], v[44:47], v[124:127]
    ds_read_b64_tr_b16 a[240:241], v9 offset:352
    v_mfma_f32_16x16x32_bf16 v[124:127], v[64:67], a[244:247], v[124:127]
    ds_read_b64_tr_b16 a[242:243], v9 offset:8032
    v_mfma_f32_16x16x32_bf16 v[144:147], v[64:67], a[248:251], v[144:147]
    ds_read_b128 v[36:39], v5 offset:51712
    v_mfma_f32_16x16x32_bf16 v[144:147], v[60:63], v[48:51], v[144:147]
    ds_read_b64_tr_b16 v[56:57], v8 offset:352
    v_mfma_f32_16x16x32_bf16 v[164:167], v[60:63], v[52:55], v[164:167]
    ds_read_b64_tr_b16 v[58:59], v8 offset:8032
    v_mfma_f32_16x16x32_bf16 v[164:167], v[64:67], a[252:255], v[164:167]
    s_waitcnt lgkmcnt(5)
    buffer_load_dwordx4 v17, s[28:31], s65 offen offset:1024 lds
    v_mfma_f32_16x16x32_bf16 v[168:171], v[68:71], a[252:255], v[168:171]
    ds_read_b64_tr_b16 v[60:61], v8 offset:0
    v_mfma_f32_16x16x32_bf16 v[168:171], v[72:75], v[52:55], v[168:171]
    ds_read_b64_tr_b16 v[62:63], v8 offset:7680
    v_mfma_f32_16x16x32_bf16 v[148:151], v[72:75], v[48:51], v[148:151]
    buffer_load_dwordx4 v18, s[28:31], s65 offen offset:2048 lds
    v_mfma_f32_16x16x32_bf16 v[148:151], v[68:71], a[248:251], v[148:151]
    ds_read_b64_tr_b16 v[64:65], v8 offset:16384
    v_mfma_f32_16x16x32_bf16 v[128:131], v[68:71], a[244:247], v[128:131]
    ds_read_b64_tr_b16 v[66:67], v8 offset:24064
    v_mfma_f32_16x16x32_bf16 v[128:131], v[72:75], v[44:47], v[128:131]
    s_waitcnt lgkmcnt(4)
    ds_read_b128 v[40:43], v5 offset:53760
    v_mfma_f32_16x16x32_bf16 v[132:135], a[240:243], v[44:47], v[132:135]
    ds_read_b64_tr_b16 v[68:69], v8 offset:16392
    v_mfma_f32_16x16x32_bf16 v[132:135], v[56:59], a[244:247], v[132:135]
    ds_read_b64_tr_b16 v[70:71], v8 offset:24072
    v_mfma_f32_16x16x32_bf16 v[152:155], v[56:59], a[248:251], v[152:155]
    buffer_load_dwordx4 v19, s[28:31], s65 offen offset:3072 lds
    s_bfe_u32 s64, s77, 0x4001c
    v_mfma_f32_16x16x32_bf16 v[152:155], a[240:243], v[48:51], v[152:155]
    s_lshl_b32 s64, s64, 7
    ds_read_b64_tr_b16 v[72:73], v8 offset:8
    s_add_u32 m0, s62, 106752
    v_mfma_f32_16x16x32_bf16 v[172:175], a[240:243], v[52:55], v[172:175]
    ds_read_b64_tr_b16 v[74:75], v8 offset:7688
    v_mfma_f32_16x16x32_bf16 v[172:175], v[56:59], a[252:255], v[172:175]
    s_waitcnt lgkmcnt(4)
    v_mfma_f32_16x16x32_bf16 v[196:199], v[60:63], a[244:247], v[196:199]
    ds_read_b64_tr_b16 a[240:241], v8 offset:16
    v_mfma_f32_16x16x32_bf16 v[196:199], v[64:67], v[32:35], v[196:199]
    ds_read_b64_tr_b16 a[242:243], v8 offset:7696
    v_mfma_f32_16x16x32_bf16 v[216:219], v[64:67], v[36:39], v[216:219]
    buffer_load_dwordx4 v10, s[24:27], s64 offen offset:0 lds
    v_mfma_f32_16x16x32_bf16 v[216:219], v[60:63], a[248:251], v[216:219]
    ds_read_b64_tr_b16 v[56:57], v8 offset:16400
    v_mfma_f32_16x16x32_bf16 v[236:239], v[60:63], a[252:255], v[236:239]
    ds_read_b64_tr_b16 v[58:59], v8 offset:24080
    v_mfma_f32_16x16x32_bf16 v[236:239], v[64:67], v[40:43], v[236:239]
    s_waitcnt lgkmcnt(4)
    v_mfma_f32_16x16x32_bf16 v[240:243], v[68:71], v[40:43], v[240:243]
    ds_read_b64_tr_b16 v[60:61], v8 offset:16408
    v_mfma_f32_16x16x32_bf16 v[240:243], v[72:75], a[252:255], v[240:243]
    ds_read_b64_tr_b16 v[62:63], v8 offset:24088
    v_mfma_f32_16x16x32_bf16 v[220:223], v[72:75], a[248:251], v[220:223]
    buffer_load_dwordx4 v11, s[24:27], s64 offen offset:1024 lds
    s_add_u32 m0, s62, 108800
    v_mfma_f32_16x16x32_bf16 v[220:223], v[68:71], v[36:39], v[220:223]
    ds_read_b64_tr_b16 v[64:65], v8 offset:24
    v_mfma_f32_16x16x32_bf16 v[200:203], v[68:71], v[32:35], v[200:203]
    ds_read_b64_tr_b16 v[66:67], v8 offset:7704
    v_mfma_f32_16x16x32_bf16 v[200:203], v[72:75], a[244:247], v[200:203]
    s_waitcnt lgkmcnt(4)
    v_mfma_f32_16x16x32_bf16 v[204:207], a[240:243], a[244:247], v[204:207]
    ds_read_b64_tr_b16 v[68:69], v8 offset:32
    v_mfma_f32_16x16x32_bf16 v[204:207], v[56:59], v[32:35], v[204:207]
    ds_read_b64_tr_b16 v[70:71], v8 offset:7712
    v_mfma_f32_16x16x32_bf16 v[224:227], v[56:59], v[36:39], v[224:227]
    v_mfma_f32_16x16x32_bf16 v[224:227], a[240:243], a[248:251], v[224:227]
    ds_read_b64_tr_b16 v[72:73], v8 offset:16416
    v_mfma_f32_16x16x32_bf16 v[244:247], a[240:243], a[252:255], v[244:247]
    ds_read_b64_tr_b16 v[74:75], v8 offset:24096
    v_mfma_f32_16x16x32_bf16 v[244:247], v[56:59], v[40:43], v[244:247]
    s_waitcnt lgkmcnt(4)
    buffer_load_dwordx4 v12, s[24:27], s64 offen offset:0 lds
    v_mfma_f32_16x16x32_bf16 v[248:251], v[60:63], v[40:43], v[248:251]
    ds_read_b64_tr_b16 a[240:241], v8 offset:16544
    v_mfma_f32_16x16x32_bf16 v[248:251], v[64:67], a[252:255], v[248:251]
    ds_read_b64_tr_b16 a[242:243], v8 offset:24224
    v_mfma_f32_16x16x32_bf16 v[228:231], v[64:67], a[248:251], v[228:231]
    s_waitcnt vmcnt(8)
    s_barrier
    ds_read_b128 v[44:47], v6 offset:0
    v_mfma_f32_16x16x32_bf16 v[228:231], v[60:63], v[36:39], v[228:231]
    ds_read_b64_tr_b16 v[56:57], v8 offset:160
    v_mfma_f32_16x16x32_bf16 v[208:211], v[60:63], v[32:35], v[208:211]
    s_waitcnt vmcnt(6)
    ds_read_b64_tr_b16 v[58:59], v8 offset:7840
    v_cmp_eq_u32 vcc, 0, v22
    v_mfma_f32_16x16x32_bf16 v[208:211], v[64:67], a[244:247], v[208:211]
    s_waitcnt lgkmcnt(5)
    buffer_load_dwordx4 v13, s[24:27], s64 offen offset:1024 lds
    s_cbranch_vccnz Q_SPIN_S
Q_BACK_S:
    v_mfma_f32_16x16x32_bf16 v[212:215], v[68:71], a[244:247], v[212:215]
    s_movk_i32 s71, 2047
    ds_read_b64_tr_b16 v[60:61], v8 offset:168
    v_min_u32 v26, 47, v1
    v_mfma_f32_16x16x32_bf16 v[212:215], v[72:75], v[32:35], v[212:215]
    ds_read_b64_tr_b16 v[62:63], v8 offset:7848
    v_add_u32 v26, s78, v26
    v_mfma_f32_16x16x32_bf16 v[232:235], v[72:75], v[36:39], v[232:235]
    buffer_load_dwordx4 v14, s[24:27], s64 offen offset:2048 lds
    v_mfma_f32_16x16x32_bf16 v[232:235], v[68:71], a[248:251], v[232:235]
    ds_read_b64_tr_b16 v[64:65], v8 offset:16552
    v_med3_i32 v26, v26, 0, s71
    v_mfma_f32_16x16x32_bf16 v[252:255], v[68:71], a[252:255], v[252:255]
    ds_read_b64_tr_b16 v[66:67], v8 offset:24232
    v_lshrrev_b32 v26, 4, v26
    v_mfma_f32_16x16x32_bf16 v[252:255], v[72:75], v[40:43], v[252:255]
    s_waitcnt lgkmcnt(4)
    ds_read_b128 v[48:51], v4 offset:2048
    v_lshlrev_b32 v26, 7, v26
    v_mfma_f32_16x16x32_bf16 v[96:99], a[240:243], v[40:43], v[96:99]
    ds_read_b64_tr_b16 v[68:69], v8 offset:16560
    v_add_u32 v26, 3265536, v26
    v_mfma_f32_16x16x32_bf16 v[96:99], v[56:59], a[252:255], v[96:99]
    ds_read_b64_tr_b16 v[70:71], v8 offset:24240
    v_mfma_f32_16x16x32_bf16 v[176:179], v[56:59], a[248:251], v[176:179]
    buffer_load_dwordx4 v15, s[24:27], s64 offen offset:3072 lds
    s_bfe_u32 s65, s77, 0x4001c
    v_mfma_f32_16x16x32_bf16 v[176:179], a[240:243], v[36:39], v[176:179]
    s_lshl1_add_u32 s65, s65, s76
    ds_read_b64_tr_b16 v[72:73], v8 offset:176
    s_mul_i32 s65, s65, 122880
    v_mfma_f32_16x16x32_bf16 v[76:79], a[240:243], v[32:35], v[76:79]
    s_add_u32 m0, s63, 65536
    ds_read_b64_tr_b16 v[74:75], v8 offset:7856
    v_mfma_f32_16x16x32_bf16 v[76:79], v[56:59], a[244:247], v[76:79]
    s_waitcnt lgkmcnt(5)
    buffer_load_dwordx4 v16, s[28:31], s65 offen offset:0 lds
    v_mfma_f32_16x16x32_bf16 v[80:83], v[60:63], a[244:247], v[80:83]
    ds_read_b64_tr_b16 a[240:241], v8 offset:16568
    v_mfma_f32_16x16x32_bf16 v[80:83], v[64:67], v[32:35], v[80:83]
    ds_read_b64_tr_b16 a[242:243], v8 offset:24248
    v_mfma_f32_16x16x32_bf16 v[180:183], v[64:67], v[36:39], v[180:183]
    ds_read_b128 v[52:55], v4 offset:4096
    v_mfma_f32_16x16x32_bf16 v[180:183], v[60:63], a[248:251], v[180:183]
    ds_read_b64_tr_b16 v[56:57], v8 offset:32952
    v_mfma_f32_16x16x32_bf16 v[100:103], v[60:63], a[252:255], v[100:103]
    ds_read_b64_tr_b16 v[58:59], v8 offset:40632
    v_mfma_f32_16x16x32_bf16 v[100:103], v[64:67], v[40:43], v[100:103]
    s_waitcnt lgkmcnt(5)
    buffer_load_dwordx4 v17, s[28:31], s65 offen offset:1024 lds
    v_mfma_f32_16x16x32_bf16 v[104:107], v[68:71], v[40:43], v[104:107]
    ds_read_b64_tr_b16 v[60:61], v8 offset:32960
    v_mfma_f32_16x16x32_bf16 v[104:107], v[72:75], a[252:255], v[104:107]
    ds_read_b64_tr_b16 v[62:63], v8 offset:40640
    v_mfma_f32_16x16x32_bf16 v[184:187], v[72:75], a[248:251], v[184:187]
    buffer_load_dwordx4 v18, s[28:31], s65 offen offset:2048 lds
    v_mfma_f32_16x16x32_bf16 v[184:187], v[68:71], v[36:39], v[184:187]
    ds_read_b64_tr_b16 v[64:65], v8 offset:16576
    v_mfma_f32_16x16x32_bf16 v[84:87], v[68:71], v[32:35], v[84:87]
    ds_read_b64_tr_b16 v[66:67], v8 offset:24256
    v_mfma_f32_16x16x32_bf16 v[84:87], v[72:75], a[244:247], v[84:87]
    s_waitcnt lgkmcnt(4)
    v_mfma_f32_16x16x32_bf16 v[88:91], a[240:243], v[32:35], v[88:91]
    ds_read_b64_tr_b16 v[68:69], v8 offset:16704
    v_mfma_f32_16x16x32_bf16 v[88:91], v[56:59], v[44:47], v[88:91]
    ds_read_b64_tr_b16 v[70:71], v8 offset:24384
    v_mfma_f32_16x16x32_bf16 v[188:191], v[56:59], v[48:51], v[188:191]
    buffer_load_dwordx4 v19, s[28:31], s65 offen offset:3072 lds
    s_add_u32 s65, s65, s101
    v_mfma_f32_16x16x32_bf16 v[188:191], a[240:243], v[36:39], v[188:191]
    ds_read_b64_tr_b16 v[72:73], v8 offset:33088
    v_mfma_f32_16x16x32_bf16 v[108:111], a[240:243], v[40:43], v[108:111]
    ds_read_b64_tr_b16 v[74:75], v8 offset:40768
    v_mfma_f32_16x16x32_bf16 v[108:111], v[56:59], v[52:55], v[108:111]
    s_waitcnt lgkmcnt(4)
    v_mfma_f32_16x16x32_bf16 v[112:115], v[60:63], v[52:55], v[112:115]
    ds_read_b64_tr_b16 a[240:241], v8 offset:33096
    v_mfma_f32_16x16x32_bf16 v[112:115], v[64:67], v[40:43], v[112:115]
    ds_read_b64_tr_b16 a[242:243], v8 offset:40776
    v_mfma_f32_16x16x32_bf16 v[192:195], v[64:67], v[36:39], v[192:195]
    buffer_load_dwordx4 a[0:3], v2, s[40:43], s67 offen offset:0 sc1
    v_mfma_f32_16x16x32_bf16 v[192:195], v[60:63], v[48:51], v[192:195]
    ds_read_b64_tr_b16 v[56:57], v8 offset:16712
    v_mfma_f32_16x16x32_bf16 v[92:95], v[60:63], v[44:47], v[92:95]
    ds_read_b64_tr_b16 v[58:59], v8 offset:24392
    v_mfma_f32_16x16x32_bf16 v[92:95], v[64:67], v[32:35], v[92:95]
    s_waitcnt lgkmcnt(4)
    v_mfma_f32_16x16x32_bf16 v[116:119], v[68:71], v[32:35], v[116:119]
    ds_read_b64_tr_b16 v[60:61], v8 offset:16720
    v_mfma_f32_16x16x32_bf16 v[116:119], v[72:75], v[44:47], v[116:119]
    ds_read_b64_tr_b16 v[62:63], v8 offset:24400
    v_mfma_f32_16x16x32_bf16 v[136:139], v[72:75], v[48:51], v[136:139]
    buffer_load_dwordx4 a[4:7], v2, s[40:43], s67 offen offset:1024 sc1
    v_mfma_f32_16x16x32_bf16 v[136:139], v[68:71], v[36:39], v[136:139]
    ds_read_b64_tr_b16 v[64:65], v8 offset:33104
    v_mfma_f32_16x16x32_bf16 v[156:159], v[68:71], v[40:43], v[156:159]
    ds_read_b64_tr_b16 v[66:67], v8 offset:40784
    v_mfma_f32_16x16x32_bf16 v[156:159], v[72:75], v[52:55], v[156:159]
    s_waitcnt lgkmcnt(4) vmcnt(12)
    s_barrier
    ds_read_b128 a[244:247], v7 offset:0
    v_mfma_f32_16x16x32_bf16 v[160:163], a[240:243], v[52:55], v[160:163]
    s_add_u32 m0, s63, 0
    ds_read_b64_tr_b16 v[68:69], v8 offset:33112
    v_mfma_f32_16x16x32_bf16 v[160:163], v[56:59], v[40:43], v[160:163]
    ds_read_b64_tr_b16 v[70:71], v8 offset:40792
    v_mfma_f32_16x16x32_bf16 v[140:143], v[56:59], v[36:39], v[140:143]
    buffer_load_dwordx4 v16, s[28:31], s65 offen offset:0 lds
    v_mfma_f32_16x16x32_bf16 v[140:143], a[240:243], v[48:51], v[140:143]
    ds_read_b64_tr_b16 v[72:73], v8 offset:16728
    v_mfma_f32_16x16x32_bf16 v[120:123], a[240:243], v[44:47], v[120:123]
    ds_read_b64_tr_b16 v[74:75], v8 offset:24408
    v_mfma_f32_16x16x32_bf16 v[120:123], v[56:59], v[32:35], v[120:123]
    s_waitcnt lgkmcnt(5)
    v_mfma_f32_16x16x32_bf16 v[124:127], v[60:63], v[32:35], v[124:127]
    ds_read_b64_tr_b16 a[240:241], v8 offset:16736
    v_mfma_f32_16x16x32_bf16 v[124:127], v[64:67], v[44:47], v[124:127]
    ds_read_b64_tr_b16 a[242:243], v8 offset:24416
    v_mfma_f32_16x16x32_bf16 v[144:147], v[64:67], v[48:51], v[144:147]
    ds_read_b128 a[248:251], v5 offset:2048
    v_mfma_f32_16x16x32_bf16 v[144:147], v[60:63], v[36:39], v[144:147]
    ds_read_b64_tr_b16 v[56:57], v8 offset:33120
    v_mfma_f32_16x16x32_bf16 v[164:167], v[60:63], v[40:43], v[164:167]
    ds_read_b64_tr_b16 v[58:59], v8 offset:40800
    v_mfma_f32_16x16x32_bf16 v[164:167], v[64:67], v[52:55], v[164:167]
    s_waitcnt lgkmcnt(5)
    buffer_load_dwordx4 v17, s[28:31], s65 offen offset:1024 lds
    v_mfma_f32_16x16x32_bf16 v[168:171], v[68:71], v[52:55], v[168:171]
    ds_read_b64_tr_b16 v[60:61], v8 offset:32768
    v_mfma_f32_16x16x32_bf16 v[168:171], v[72:75], v[40:43], v[168:171]
    ds_read_b64_tr_b16 v[62:63], v8 offset:40448
    v_mfma_f32_16x16x32_bf16 v[148:151], v[72:75], v[36:39], v[148:151]
    buffer_load_dwordx4 v18, s[28:31], s65 offen offset:2048 lds
    v_mfma_f32_16x16x32_bf16 v[148:151], v[68:71], v[48:51], v[148:151]
    ds_read_b64_tr_b16 v[64:65], v8 offset:49152
    v_mfma_f32_16x16x32_bf16 v[128:131], v[68:71], v[44:47], v[128:131]
    ds_read_b64_tr_b16 v[66:67], v8 offset:56832
    v_mfma_f32_16x16x32_bf16 v[128:131], v[72:75], v[32:35], v[128:131]
    s_waitcnt lgkmcnt(4)
    ds_read_b128 a[252:255], v5 offset:4096
    v_mfma_f32_16x16x32_bf16 v[132:135], a[240:243], v[32:35], v[132:135]
    ds_read_b64_tr_b16 v[68:69], v8 offset:49160
    v_mfma_f32_16x16x32_bf16 v[132:135], v[56:59], v[44:47], v[132:135]
    ds_read_b64_tr_b16 v[70:71], v8 offset:56840
    v_mfma_f32_16x16x32_bf16 v[152:155], v[56:59], v[48:51], v[152:155]
    buffer_load_dwordx4 v19, s[28:31], s65 offen offset:3072 lds
    s_bfe_u32 s64, s59, 0x40000
    v_mfma_f32_16x16x32_bf16 v[152:155], a[240:243], v[36:39], v[152:155]
    s_lshl_b32 s64, s64, 7
    ds_read_b64_tr_b16 v[72:73], v8 offset:32776
    s_add_u32 m0, s62, 131584
    v_mfma_f32_16x16x32_bf16 v[172:175], a[240:243], v[40:43], v[172:175]
    ds_read_b64_tr_b16 v[74:75], v8 offset:40456
    v_mfma_f32_16x16x32_bf16 v[172:175], v[56:59], v[52:55], v[172:175]
    s_waitcnt lgkmcnt(4)
    buffer_load_dwordx4 v10, s[24:27], s64 offen offset:0 lds
    v_mfma_f32_16x16x32_bf16 v[196:199], v[60:63], v[44:47], v[196:199]
    ds_read_b64_tr_b16 a[240:241], v8 offset:32784
    v_mfma_f32_16x16x32_bf16 v[196:199], v[64:67], a[244:247], v[196:199]
    ds_read_b64_tr_b16 a[242:243], v8 offset:40464
    v_mfma_f32_16x16x32_bf16 v[216:219], v[64:67], a[248:251], v[216:219]
    v_mfma_f32_16x16x32_bf16 v[216:219], v[60:63], v[48:51], v[216:219]
    ds_read_b64_tr_b16 v[56:57], v8 offset:49168
    v_mfma_f32_16x16x32_bf16 v[236:239], v[60:63], v[52:55], v[236:239]
    ds_read_b64_tr_b16 v[58:59], v8 offset:56848
    v_mfma_f32_16x16x32_bf16 v[236:239], v[64:67], a[252:255], v[236:239]
    s_waitcnt lgkmcnt(4)
    buffer_load_dwordx4 v11, s[24:27], s64 offen offset:1024 lds
    s_add_u32 m0, s62, 133632
    v_mfma_f32_16x16x32_bf16 v[240:243], v[68:71], a[252:255], v[240:243]
    ds_read_b64_tr_b16 v[60:61], v8 offset:49176
    v_mfma_f32_16x16x32_bf16 v[240:243], v[72:75], v[52:55], v[240:243]
    ds_read_b64_tr_b16 v[62:63], v8 offset:56856
    v_mfma_f32_16x16x32_bf16 v[220:223], v[72:75], v[48:51], v[220:223]
    v_mfma_f32_16x16x32_bf16 v[220:223], v[68:71], a[248:251], v[220:223]
    ds_read_b64_tr_b16 v[64:65], v8 offset:32792
    v_mfma_f32_16x16x32_bf16 v[200:203], v[68:71], a[244:247], v[200:203]
    ds_read_b64_tr_b16 v[66:67], v8 offset:40472
    v_mfma_f32_16x16x32_bf16 v[200:203], v[72:75], v[44:47], v[200:203]
    s_waitcnt lgkmcnt(4)
    buffer_load_dwordx4 v12, s[24:27], s64 offen offset:0 lds
    v_mfma_f32_16x16x32_bf16 v[204:207], a[240:243], v[44:47], v[204:207]
    ds_read_b64_tr_b16 v[68:69], v8 offset:32800
    v_mfma_f32_16x16x32_bf16 v[204:207], v[56:59], a[244:247], v[204:207]
    ds_read_b64_tr_b16 v[70:71], v8 offset:40480
    v_mfma_f32_16x16x32_bf16 v[224:227], v[56:59], a[248:251], v[224:227]
    v_mfma_f32_16x16x32_bf16 v[224:227], a[240:243], v[48:51], v[224:227]
    ds_read_b64_tr_b16 v[72:73], v8 offset:49184
    v_mfma_f32_16x16x32_bf16 v[244:247], a[240:243], v[52:55], v[244:247]
    ds_read_b64_tr_b16 v[74:75], v8 offset:56864
    v_mfma_f32_16x16x32_bf16 v[244:247], v[56:59], a[252:255], v[244:247]
    s_waitcnt lgkmcnt(4)
    buffer_load_dwordx4 v13, s[24:27], s64 offen offset:1024 lds
    v_mfma_f32_16x16x32_bf16 v[248:251], v[60:63], a[252:255], v[248:251]
    ds_read_b64_tr_b16 a[240:241], v8 offset:49312
    v_mfma_f32_16x16x32_bf16 v[248:251], v[64:67], v[52:55], v[248:251]
    ds_read_b64_tr_b16 a[242:243], v8 offset:56992
    v_mfma_f32_16x16x32_bf16 v[228:231], v[64:67], v[48:51], v[228:231]
    s_waitcnt vmcnt(10)
    s_barrier
    ds_read_b128 v[32:35], v6 offset:24832
    v_mfma_f32_16x16x32_bf16 v[228:231], v[60:63], a[248:251], v[228:231]
    ds_read_b64_tr_b16 v[56:57], v8 offset:32928
    v_mfma_f32_16x16x32_bf16 v[208:211], v[60:63], a[244:247], v[208:211]
    ds_read_b64_tr_b16 v[58:59], v8 offset:40608
    v_mfma_f32_16x16x32_bf16 v[208:211], v[64:67], v[44:47], v[208:211]
    s_waitcnt lgkmcnt(5)
    buffer_load_dwordx4 v14, s[24:27], s64 offen offset:2048 lds
    v_mfma_f32_16x16x32_bf16 v[212:215], v[68:71], v[44:47], v[212:215]
    ds_read_b64_tr_b16 v[60:61], v8 offset:32936
    v_mfma_f32_16x16x32_bf16 v[212:215], v[72:75], a[244:247], v[212:215]
    ds_read_b64_tr_b16 v[62:63], v8 offset:40616
    v_mfma_f32_16x16x32_bf16 v[232:235], v[72:75], a[248:251], v[232:235]
    buffer_load_dwordx4 v15, s[24:27], s64 offen offset:3072 lds
    s_bfe_u32 s65, s59, 0x40000
    v_mfma_f32_16x16x32_bf16 v[232:235], v[68:71], v[48:51], v[232:235]
    s_lshl1_add_u32 s65, s65, s76
    ds_read_b64_tr_b16 v[64:65], v8 offset:49320
    s_mul_i32 s65, s65, 122880
    v_mfma_f32_16x16x32_bf16 v[252:255], v[68:71], v[52:55], v[252:255]
    s_add_u32 m0, s63, 16384
    ds_read_b64_tr_b16 v[66:67], v8 offset:57000
    v_mfma_f32_16x16x32_bf16 v[252:255], v[72:75], a[252:255], v[252:255]
    s_waitcnt lgkmcnt(4)
    ds_read_b128 v[36:39], v4 offset:26880
    v_mfma_f32_16x16x32_bf16 v[96:99], a[240:243], a[252:255], v[96:99]
    ds_read_b64_tr_b16 v[68:69], v8 offset:49328
    v_mfma_f32_16x16x32_bf16 v[96:99], v[56:59], v[52:55], v[96:99]
    ds_read_b64_tr_b16 v[70:71], v8 offset:57008
    v_mfma_f32_16x16x32_bf16 v[176:179], v[56:59], v[48:51], v[176:179]
    buffer_load_dwordx4 v16, s[28:31], s65 offen offset:0 lds
    v_mfma_f32_16x16x32_bf16 v[176:179], a[240:243], a[248:251], v[176:179]
    ds_read_b64_tr_b16 v[72:73], v8 offset:32944
    v_mfma_f32_16x16x32_bf16 v[76:79], a[240:243], a[244:247], v[76:79]
    ds_read_b64_tr_b16 v[74:75], v8 offset:40624
    v_mfma_f32_16x16x32_bf16 v[76:79], v[56:59], v[44:47], v[76:79]
    s_waitcnt lgkmcnt(5)
    buffer_load_dwordx4 v17, s[28:31], s65 offen offset:1024 lds
    v_mfma_f32_16x16x32_bf16 v[80:83], v[60:63], v[44:47], v[80:83]
    ds_read_b64_tr_b16 a[240:241], v8 offset:49336
    v_mfma_f32_16x16x32_bf16 v[80:83], v[64:67], a[244:247], v[80:83]
    ds_read_b64_tr_b16 a[242:243], v8 offset:57016
    v_mfma_f32_16x16x32_bf16 v[180:183], v[64:67], a[248:251], v[180:183]
    ds_read_b128 v[40:43], v4 offset:28928
    v_mfma_f32_16x16x32_bf16 v[180:183], v[60:63], v[48:51], v[180:183]
    ds_read_b64_tr_b16 v[56:57], v9 offset:184
    v_mfma_f32_16x16x32_bf16 v[100:103], v[60:63], v[52:55], v[100:103]
    ds_read_b64_tr_b16 v[58:59], v9 offset:7864
    v_mfma_f32_16x16x32_bf16 v[100:103], v[64:67], a[252:255], v[100:103]
    s_waitcnt lgkmcnt(5)
    buffer_load_dwordx4 v18, s[28:31], s65 offen offset:2048 lds
    v_mfma_f32_16x16x32_bf16 v[104:107], v[68:71], a[252:255], v[104:107]
    ds_read_b64_tr_b16 v[60:61], v9 offset:192
    v_mfma_f32_16x16x32_bf16 v[104:107], v[72:75], v[52:55], v[104:107]
    ds_read_b64_tr_b16 v[62:63], v9 offset:7872
    v_mfma_f32_16x16x32_bf16 v[184:187], v[72:75], v[48:51], v[184:187]
    buffer_load_dwordx4 v19, s[28:31], s65 offen offset:3072 lds
    s_add_u32 s65, s65, s101
    v_mfma_f32_16x16x32_bf16 v[184:187], v[68:71], a[248:251], v[184:187]
    ds_read_b64_tr_b16 v[64:65], v8 offset:49344
    v_mfma_f32_16x16x32_bf16 v[84:87], v[68:71], a[244:247], v[84:87]
    ds_read_b64_tr_b16 v[66:67], v8 offset:57024
    v_mfma_f32_16x16x32_bf16 v[84:87], v[72:75], v[44:47], v[84:87]
    s_waitcnt lgkmcnt(4)
    v_mfma_f32_16x16x32_bf16 v[88:91], a[240:243], a[244:247], v[88:91]
    ds_read_b64_tr_b16 v[68:69], v8 offset:49472
    v_mfma_f32_16x16x32_bf16 v[88:91], v[56:59], v[32:35], v[88:91]
    ds_read_b64_tr_b16 v[70:71], v8 offset:57152
    v_mfma_f32_16x16x32_bf16 v[188:191], v[56:59], v[36:39], v[188:191]
    buffer_load_dwordx4 a[8:11], v2, s[40:43], s67 offen offset:2048 sc1
    v_mfma_f32_16x16x32_bf16 v[188:191], a[240:243], a[248:251], v[188:191]
    ds_read_b64_tr_b16 v[72:73], v9 offset:320
    v_mfma_f32_16x16x32_bf16 v[108:111], a[240:243], a[252:255], v[108:111]
    ds_read_b64_tr_b16 v[74:75], v9 offset:8000
    v_mfma_f32_16x16x32_bf16 v[108:111], v[56:59], v[40:43], v[108:111]
    s_waitcnt lgkmcnt(4)
    v_mfma_f32_16x16x32_bf16 v[112:115], v[60:63], v[40:43], v[112:115]
    ds_read_b64_tr_b16 a[240:241], v9 offset:328
    v_mfma_f32_16x16x32_bf16 v[112:115], v[64:67], a[252:255], v[112:115]
    ds_read_b64_tr_b16 a[242:243], v9 offset:8008
    v_mfma_f32_16x16x32_bf16 v[192:195], v[64:67], a[248:251], v[192:195]
    buffer_load_dwordx4 a[12:15], v2, s[40:43], s67 offen offset:3072 sc1
    s_add_u32 s67, s67, 4096
    v_mfma_f32_16x16x32_bf16 v[192:195], v[60:63], v[36:39], v[192:195]
    ds_read_b64_tr_b16 v[56:57], v8 offset:49480
    v_mfma_f32_16x16x32_bf16 v[92:95], v[60:63], v[32:35], v[92:95]
    ds_read_b64_tr_b16 v[58:59], v8 offset:57160
    v_mfma_f32_16x16x32_bf16 v[92:95], v[64:67], a[244:247], v[92:95]
    s_waitcnt lgkmcnt(4)
    v_mfma_f32_16x16x32_bf16 v[116:119], v[68:71], a[244:247], v[116:119]
    ds_read_b64_tr_b16 v[60:61], v8 offset:49488
    v_mfma_f32_16x16x32_bf16 v[116:119], v[72:75], v[32:35], v[116:119]
    ds_read_b64_tr_b16 v[62:63], v8 offset:57168
    v_mfma_f32_16x16x32_bf16 v[136:139], v[72:75], v[36:39], v[136:139]
    buffer_load_dwordx4 a[16:19], v2, s[40:43], s67 offen offset:0 sc1
    v_mfma_f32_16x16x32_bf16 v[136:139], v[68:71], a[248:251], v[136:139]
    ds_read_b64_tr_b16 v[64:65], v9 offset:336
    v_mfma_f32_16x16x32_bf16 v[156:159], v[68:71], a[252:255], v[156:159]
    ds_read_b64_tr_b16 v[66:67], v9 offset:8016
    v_mfma_f32_16x16x32_bf16 v[156:159], v[72:75], v[40:43], v[156:159]
    s_waitcnt lgkmcnt(4) vmcnt(13)
    s_barrier
    ds_read_b128 v[44:47], v7 offset:24832
    v_mfma_f32_16x16x32_bf16 v[160:163], a[240:243], v[40:43], v[160:163]
    s_add_u32 m0, s63, 32768
    ds_read_b64_tr_b16 v[68:69], v9 offset:344
    v_mfma_f32_16x16x32_bf16 v[160:163], v[56:59], a[252:255], v[160:163]
    ds_read_b64_tr_b16 v[70:71], v9 offset:8024
    v_mfma_f32_16x16x32_bf16 v[140:143], v[56:59], a[248:251], v[140:143]
    buffer_load_dwordx4 v16, s[28:31], s65 offen offset:0 lds
    v_mfma_f32_16x16x32_bf16 v[140:143], a[240:243], v[36:39], v[140:143]
    ds_read_b64_tr_b16 v[72:73], v8 offset:49496
    v_mfma_f32_16x16x32_bf16 v[120:123], a[240:243], v[32:35], v[120:123]
    ds_read_b64_tr_b16 v[74:75], v8 offset:57176
    v_mfma_f32_16x16x32_bf16 v[120:123], v[56:59], a[244:247], v[120:123]
    s_waitcnt lgkmcnt(5)
    buffer_load_dwordx4 v17, s[28:31], s65 offen offset:1024 lds
    v_mfma_f32_16x16x32_bf16 v[124:127], v[60:63], a[244:247], v[124:127]
    ds_read_b64_tr_b16 a[240:241], v8 offset:49504
    v_mfma_f32_16x16x32_bf16 v[124:127], v[64:67], v[32:35], v[124:127]
    ds_read_b64_tr_b16 a[242:243], v8 offset:57184
    v_mfma_f32_16x16x32_bf16 v[144:147], v[64:67], v[36:39], v[144:147]
    ds_read_b128 v[48:51], v5 offset:26880
    v_mfma_f32_16x16x32_bf16 v[144:147], v[60:63], a[248:251], v[144:147]
    ds_read_b64_tr_b16 v[56:57], v9 offset:352
    v_mfma_f32_16x16x32_bf16 v[164:167], v[60:63], a[252:255], v[164:167]
    ds_read_b64_tr_b16 v[58:59], v9 offset:8032
    v_mfma_f32_16x16x32_bf16 v[164:167], v[64:67], v[40:43], v[164:167]
    s_waitcnt lgkmcnt(5)
    buffer_load_dwordx4 v18, s[28:31], s65 offen offset:2048 lds
    v_mfma_f32_16x16x32_bf16 v[168:171], v[68:71], v[40:43], v[168:171]
    ds_read_b64_tr_b16 v[60:61], v9 offset:0
    v_mfma_f32_16x16x32_bf16 v[168:171], v[72:75], a[252:255], v[168:171]
    ds_read_b64_tr_b16 v[62:63], v9 offset:7680
    v_mfma_f32_16x16x32_bf16 v[148:151], v[72:75], a[248:251], v[148:151]
    buffer_load_dwordx4 v19, s[28:31], s65 offen offset:3072 lds
    s_bfe_u32 s64, s59, 0x40004
    v_mfma_f32_16x16x32_bf16 v[148:151], v[68:71], v[36:39], v[148:151]
    s_lshl_b32 s64, s64, 7
    ds_read_b64_tr_b16 v[64:65], v8 offset:0
    s_add_u32 m0, s62, 81920
    v_mfma_f32_16x16x32_bf16 v[128:131], v[68:71], v[32:35], v[128:131]
    ds_read_b64_tr_b16 v[66:67], v8 offset:7680
    v_mfma_f32_16x16x32_bf16 v[128:131], v[72:75], a[244:247], v[128:131]
    s_waitcnt lgkmcnt(4)
    ds_read_b128 v[52:55], v5 offset:28928
    v_mfma_f32_16x16x32_bf16 v[132:135], a[240:243], a[244:247], v[132:135]
    ds_read_b64_tr_b16 v[68:69], v8 offset:8
    v_mfma_f32_16x16x32_bf16 v[132:135], v[56:59], v[32:35], v[132:135]
    ds_read_b64_tr_b16 v[70:71], v8 offset:7688
    v_mfma_f32_16x16x32_bf16 v[152:155], v[56:59], v[36:39], v[152:155]
    buffer_load_dwordx4 v10, s[24:27], s64 offen offset:0 lds
    v_mfma_f32_16x16x32_bf16 v[152:155], a[240:243], a[248:251], v[152:155]
    ds_read_b64_tr_b16 v[72:73], v9 offset:8
    v_mfma_f32_16x16x32_bf16 v[172:175], a[240:243], a[252:255], v[172:175]
    ds_read_b64_tr_b16 v[74:75], v9 offset:7688
    v_mfma_f32_16x16x32_bf16 v[172:175], v[56:59], v[40:43], v[172:175]
    s_waitcnt lgkmcnt(4)
    v_mfma_f32_16x16x32_bf16 v[196:199], v[60:63], v[32:35], v[196:199]
    ds_read_b64_tr_b16 a[240:241], v9 offset:16
    v_mfma_f32_16x16x32_bf16 v[196:199], v[64:67], v[44:47], v[196:199]
    ds_read_b64_tr_b16 a[242:243], v9 offset:7696
    v_mfma_f32_16x16x32_bf16 v[216:219], v[64:67], v[48:51], v[216:219]
    v_mfma_f32_16x16x32_bf16 v[216:219], v[60:63], v[36:39], v[216:219]
    ds_read_b64_tr_b16 v[56:57], v8 offset:16
    v_mfma_f32_16x16x32_bf16 v[236:239], v[60:63], v[40:43], v[236:239]
    ds_read_b64_tr_b16 v[58:59], v8 offset:7696
    v_mfma_f32_16x16x32_bf16 v[236:239], v[64:67], v[52:55], v[236:239]
    s_waitcnt lgkmcnt(4)
    buffer_load_dwordx4 v11, s[24:27], s64 offen offset:1024 lds
    s_add_u32 m0, s62, 83968
    v_mfma_f32_16x16x32_bf16 v[240:243], v[68:71], v[52:55], v[240:243]
    ds_read_b64_tr_b16 v[60:61], v8 offset:24
    v_mfma_f32_16x16x32_bf16 v[240:243], v[72:75], v[40:43], v[240:243]
    ds_read_b64_tr_b16 v[62:63], v8 offset:7704
    v_mfma_f32_16x16x32_bf16 v[220:223], v[72:75], v[36:39], v[220:223]
    v_mfma_f32_16x16x32_bf16 v[220:223], v[68:71], v[48:51], v[220:223]
    ds_read_b64_tr_b16 v[64:65], v9 offset:24
    v_mfma_f32_16x16x32_bf16 v[200:203], v[68:71], v[44:47], v[200:203]
    ds_read_b64_tr_b16 v[66:67], v9 offset:7704
    v_mfma_f32_16x16x32_bf16 v[200:203], v[72:75], v[32:35], v[200:203]
    s_waitcnt lgkmcnt(4)
    buffer_load_dwordx4 v12, s[24:27], s64 offen offset:0 lds
    v_mfma_f32_16x16x32_bf16 v[204:207], a[240:243], v[32:35], v[204:207]
    ds_read_b64_tr_b16 v[68:69], v9 offset:32
    v_mfma_f32_16x16x32_bf16 v[204:207], v[56:59], v[44:47], v[204:207]
    ds_read_b64_tr_b16 v[70:71], v9 offset:7712
    v_mfma_f32_16x16x32_bf16 v[224:227], v[56:59], v[48:51], v[224:227]
    v_mfma_f32_16x16x32_bf16 v[224:227], a[240:243], v[36:39], v[224:227]
    ds_read_b64_tr_b16 v[72:73], v8 offset:32
    v_mfma_f32_16x16x32_bf16 v[244:247], a[240:243], v[40:43], v[244:247]
    ds_read_b64_tr_b16 v[74:75], v8 offset:7712
    v_mfma_f32_16x16x32_bf16 v[244:247], v[56:59], v[52:55], v[244:247]
    s_waitcnt lgkmcnt(4)
    buffer_load_dwordx4 v13, s[24:27], s64 offen offset:1024 lds
    v_mfma_f32_16x16x32_bf16 v[248:251], v[60:63], v[52:55], v[248:251]
    ds_read_b64_tr_b16 a[240:241], v8 offset:160
    v_mfma_f32_16x16x32_bf16 v[248:251], v[64:67], v[40:43], v[248:251]
    ds_read_b64_tr_b16 a[242:243], v8 offset:7840
    v_mfma_f32_16x16x32_bf16 v[228:231], v[64:67], v[36:39], v[228:231]
    s_waitcnt vmcnt(11)
    s_barrier
    ds_read_b128 a[244:247], v6 offset:49664
    v_mfma_f32_16x16x32_bf16 v[228:231], v[60:63], v[48:51], v[228:231]
    ds_read_b64_tr_b16 v[56:57], v9 offset:160
    v_mfma_f32_16x16x32_bf16 v[208:211], v[60:63], v[44:47], v[208:211]
    ds_read_b64_tr_b16 v[58:59], v9 offset:7840
    v_mfma_f32_16x16x32_bf16 v[208:211], v[64:67], v[32:35], v[208:211]
    s_waitcnt lgkmcnt(5)
    buffer_load_dwordx4 v14, s[24:27], s64 offen offset:2048 lds
    v_mfma_f32_16x16x32_bf16 v[212:215], v[68:71], v[32:35], v[212:215]
    ds_read_b64_tr_b16 v[60:61], v9 offset:168
    v_mfma_f32_16x16x32_bf16 v[212:215], v[72:75], v[44:47], v[212:215]
    ds_read_b64_tr_b16 v[62:63], v9 offset:7848
    v_mfma_f32_16x16x32_bf16 v[232:235], v[72:75], v[48:51], v[232:235]
    buffer_load_dwordx4 v15, s[24:27], s64 offen offset:3072 lds
    s_bfe_u32 s65, s59, 0x40004
    v_mfma_f32_16x16x32_bf16 v[232:235], v[68:71], v[36:39], v[232:235]
    s_lshl1_add_u32 s65, s65, s76
    ds_read_b64_tr_b16 v[64:65], v8 offset:168
    s_mul_i32 s65, s65, 122880
    v_mfma_f32_16x16x32_bf16 v[252:255], v[68:71], v[40:43], v[252:255]
    s_add_u32 m0, s63, 49152
    ds_read_b64_tr_b16 v[66:67], v8 offset:7848
    v_mfma_f32_16x16x32_bf16 v[252:255], v[72:75], v[52:55], v[252:255]
    s_waitcnt lgkmcnt(4)
    ds_read_b128 a[248:251], v4 offset:51712
    v_mfma_f32_16x16x32_bf16 v[96:99], a[240:243], v[52:55], v[96:99]
    ds_read_b64_tr_b16 v[68:69], v8 offset:176
    v_mfma_f32_16x16x32_bf16 v[96:99], v[56:59], v[40:43], v[96:99]
    ds_read_b64_tr_b16 v[70:71], v8 offset:7856
    v_mfma_f32_16x16x32_bf16 v[176:179], v[56:59], v[36:39], v[176:179]
    buffer_load_dword v20, v26, s[40:43], 0 offen sc1
    v_mfma_f32_16x16x32_bf16 v[176:179], a[240:243], v[48:51], v[176:179]
    ds_read_b64_tr_b16 v[72:73], v9 offset:176
    v_mfma_f32_16x16x32_bf16 v[76:79], a[240:243], v[44:47], v[76:79]
    ds_read_b64_tr_b16 v[74:75], v9 offset:7856
    v_mfma_f32_16x16x32_bf16 v[76:79], v[56:59], v[32:35], v[76:79]
    s_waitcnt lgkmcnt(5)
    buffer_load_dwordx4 v16, s[28:31], s65 offen offset:0 lds
    v_mfma_f32_16x16x32_bf16 v[80:83], v[60:63], v[32:35], v[80:83]
Q_PG3:
    s_cbranch_execz Q_TRET
    ds_read_b64_tr_b16 a[240:241], v8 offset:184
    v_mfma_f32_16x16x32_bf16 v[80:83], v[64:67], v[44:47], v[80:83]
    ds_read_b64_tr_b16 a[242:243], v8 offset:7864
    v_mfma_f32_16x16x32_bf16 v[180:183], v[64:67], v[48:51], v[180:183]
    ds_read_b128 a[252:255], v4 offset:53760
    v_mfma_f32_16x16x32_bf16 v[180:183], v[60:63], v[36:39], v[180:183]
    ds_read_b64_tr_b16 v[56:57], v8 offset:16568
    v_mfma_f32_16x16x32_bf16 v[100:103], v[60:63], v[40:43], v[100:103]
    ds_read_b64_tr_b16 v[58:59], v8 offset:24248
    v_mfma_f32_16x16x32_bf16 v[100:103], v[64:67], v[52:55], v[100:103]
    s_waitcnt lgkmcnt(5)
    buffer_load_dwordx4 v17, s[28:31], s65 offen offset:1024 lds
    v_mfma_f32_16x16x32_bf16 v[104:107], v[68:71], v[52:55], v[104:107]
    ds_read_b64_tr_b16 v[60:61], v8 offset:16576
    v_mfma_f32_16x16x32_bf16 v[104:107], v[72:75], v[40:43], v[104:107]
    ds_read_b64_tr_b16 v[62:63], v8 offset:24256
    v_mfma_f32_16x16x32_bf16 v[184:187], v[72:75], v[36:39], v[184:187]
    buffer_load_dwordx4 v18, s[28:31], s65 offen offset:2048 lds
    v_mfma_f32_16x16x32_bf16 v[184:187], v[68:71], v[48:51], v[184:187]
    ds_read_b64_tr_b16 v[64:65], v8 offset:192
    v_mfma_f32_16x16x32_bf16 v[84:87], v[68:71], v[44:47], v[84:87]
    ds_read_b64_tr_b16 v[66:67], v8 offset:7872
    v_mfma_f32_16x16x32_bf16 v[84:87], v[72:75], v[32:35], v[84:87]
    s_waitcnt lgkmcnt(4)
    buffer_load_dwordx4 v19, s[28:31], s65 offen offset:3072 lds
    s_add_u32 s65, s65, s101
    v_mfma_f32_16x16x32_bf16 v[88:91], a[240:243], v[44:47], v[88:91]
    ds_read_b64_tr_b16 v[68:69], v8 offset:320
    v_mfma_f32_16x16x32_bf16 v[88:91], v[56:59], a[244:247], v[88:91]
    ds_read_b64_tr_b16 v[70:71], v8 offset:8000
    v_mfma_f32_16x16x32_bf16 v[188:191], v[56:59], a[248:251], v[188:191]
    buffer_load_dwordx4 a[20:23], v2, s[40:43], s67 offen offset:1024 sc1
    v_mfma_f32_16x16x32_bf16 v[188:191], a[240:243], v[48:51], v[188:191]
    ds_read_b64_tr_b16 v[72:73], v8 offset:16704
    v_mfma_f32_16x16x32_bf16 v[108:111], a[240:243], v[52:55], v[108:111]
    ds_read_b64_tr_b16 v[74:75], v8 offset:24384
    v_mfma_f32_16x16x32_bf16 v[108:111], v[56:59], a[252:255], v[108:111]
    s_waitcnt lgkmcnt(4)
    v_mfma_f32_16x16x32_bf16 v[112:115], v[60:63], a[252:255], v[112:115]
    ds_read_b64_tr_b16 a[240:241], v8 offset:16712
    v_mfma_f32_16x16x32_bf16 v[112:115], v[64:67], v[52:55], v[112:115]
    ds_read_b64_tr_b16 a[242:243], v8 offset:24392
    v_mfma_f32_16x16x32_bf16 v[192:195], v[64:67], v[48:51], v[192:195]
    buffer_load_dwordx4 a[24:27], v2, s[40:43], s67 offen offset:2048 sc1
    v_mfma_f32_16x16x32_bf16 v[192:195], v[60:63], a[248:251], v[192:195]
    ds_read_b64_tr_b16 v[56:57], v8 offset:328
    v_mfma_f32_16x16x32_bf16 v[92:95], v[60:63], a[244:247], v[92:95]
    ds_read_b64_tr_b16 v[58:59], v8 offset:8008
    v_mfma_f32_16x16x32_bf16 v[92:95], v[64:67], v[44:47], v[92:95]
    s_waitcnt lgkmcnt(4)
    v_mfma_f32_16x16x32_bf16 v[116:119], v[68:71], v[44:47], v[116:119]
    ds_read_b64_tr_b16 v[60:61], v8 offset:336
    v_mfma_f32_16x16x32_bf16 v[116:119], v[72:75], a[244:247], v[116:119]
    ds_read_b64_tr_b16 v[62:63], v8 offset:8016
    v_mfma_f32_16x16x32_bf16 v[136:139], v[72:75], a[248:251], v[136:139]
    buffer_load_dwordx4 a[28:31], v2, s[40:43], s67 offen offset:3072 sc1
    s_add_u32 s67, s67, 4096
    v_mfma_f32_16x16x32_bf16 v[136:139], v[68:71], v[48:51], v[136:139]
    ds_read_b64_tr_b16 v[64:65], v8 offset:16720
    v_mfma_f32_16x16x32_bf16 v[156:159], v[68:71], v[52:55], v[156:159]
    ds_read_b64_tr_b16 v[66:67], v8 offset:24400
    v_mfma_f32_16x16x32_bf16 v[156:159], v[72:75], a[252:255], v[156:159]
    s_waitcnt lgkmcnt(4) vmcnt(14)
    s_barrier
    ds_read_b128 v[32:35], v7 offset:49664
    v_mfma_f32_16x16x32_bf16 v[160:163], a[240:243], a[252:255], v[160:163]
    s_add_u32 m0, s63, 65536
    ds_read_b64_tr_b16 v[68:69], v8 offset:16728
    v_mfma_f32_16x16x32_bf16 v[160:163], v[56:59], v[52:55], v[160:163]
    ds_read_b64_tr_b16 v[70:71], v8 offset:24408
    v_mfma_f32_16x16x32_bf16 v[140:143], v[56:59], v[48:51], v[140:143]
    s_waitcnt vmcnt(7)
    buffer_load_dwordx4 v16, s[28:31], s65 offen offset:0 lds
    v_mfma_f32_16x16x32_bf16 v[140:143], a[240:243], a[248:251], v[140:143]
    ds_read_b64_tr_b16 v[72:73], v8 offset:344
    v_cmp_eq_u32 vcc, 0, v20
    v_mfma_f32_16x16x32_bf16 v[120:123], a[240:243], a[244:247], v[120:123]
    s_cbranch_vccnz Q_SPIN_T
Q_BACK_T:
    ds_read_b64_tr_b16 v[74:75], v8 offset:8024
    v_add3_u32 v26, v29, s78, 0
    v_mfma_f32_16x16x32_bf16 v[120:123], v[56:59], v[44:47], v[120:123]
    s_waitcnt lgkmcnt(5)
    v_med3_i32 v26, v26, 0, s71
    v_lshlrev_b32 v26, 4, v26
    v_mfma_f32_16x16x32_bf16 v[124:127], v[60:63], v[44:47], v[124:127]
    ds_read_b64_tr_b16 a[240:241], v8 offset:352
    v_add_u32 v26, 3145728, v26
    v_mfma_f32_16x16x32_bf16 v[124:127], v[64:67], a[244:247], v[124:127]
    ds_read_b64_tr_b16 a[242:243], v8 offset:8032
    v_mfma_f32_16x16x32_bf16 v[144:147], v[64:67], a[248:251], v[144:147]
    ds_read_b128 v[36:39], v5 offset:51712
    v_mfma_f32_16x16x32_bf16 v[144:147], v[60:63], v[48:51], v[144:147]
    ds_read_b64_tr_b16 v[56:57], v8 offset:16736
    v_mfma_f32_16x16x32_bf16 v[164:167], v[60:63], v[52:55], v[164:167]
    ds_read_b64_tr_b16 v[58:59], v8 offset:24416
    v_mfma_f32_16x16x32_bf16 v[164:167], v[64:67], a[252:255], v[164:167]
    s_waitcnt lgkmcnt(5)
    buffer_load_dwordx2 v[20:21], v26, s[40:43], 0 offen sc1
    v_mfma_f32_16x16x32_bf16 v[168:171], v[68:71], a[252:255], v[168:171]
    ds_read_b64_tr_b16 v[60:61], v8 offset:16384
    v_add3_u32 v26, v29, s78, 16
    v_mfma_f32_16x16x32_bf16 v[168:171], v[72:75], v[52:55], v[168:171]
    ds_read_b64_tr_b16 v[62:63], v8 offset:24064
    v_med3_i32 v26, v26, 0, s71
    v_mfma_f32_16x16x32_bf16 v[148:151], v[72:75], v[48:51], v[148:151]
    buffer_load_dwordx4 v17, s[28:31], s65 offen offset:1024 lds
    v_mfma_f32_16x16x32_bf16 v[148:151], v[68:71], a[248:251], v[148:151]
    ds_read_b64_tr_b16 v[64:65], v8 offset:32768
    v_lshlrev_b32 v26, 4, v26
    v_mfma_f32_16x16x32_bf16 v[128:131], v[68:71], a[244:247], v[128:131]
    ds_read_b64_tr_b16 v[66:67], v8 offset:40448
    v_add_u32 v26, 3145728, v26
    v_mfma_f32_16x16x32_bf16 v[128:131], v[72:75], v[44:47], v[128:131]
    s_waitcnt lgkmcnt(4)
    ds_read_b128 v[40:43], v5 offset:53760
    v_mfma_f32_16x16x32_bf16 v[132:135], a[240:243], v[44:47], v[132:135]
    ds_read_b64_tr_b16 v[68:69], v8 offset:32776
    v_mfma_f32_16x16x32_bf16 v[132:135], v[56:59], a[244:247], v[132:135]
    ds_read_b64_tr_b16 v[70:71], v8 offset:40456
    v_mfma_f32_16x16x32_bf16 v[152:155], v[56:59], a[248:251], v[152:155]
    buffer_load_dwordx2 v[22:23], v26, s[40:43], 0 offen sc1
    v_mfma_f32_16x16x32_bf16 v[152:155], a[240:243], v[48:51], v[152:155]
    ds_read_b64_tr_b16 v[72:73], v8 offset:16392
    v_add3_u32 v26, v29, s78, 32
    v_mfma_f32_16x16x32_bf16 v[172:175], a[240:243], v[52:55], v[172:175]
    ds_read_b64_tr_b16 v[74:75], v8 offset:24072
    v_med3_i32 v26, v26, 0, s71
    v_mfma_f32_16x16x32_bf16 v[172:175], v[56:59], a[252:255], v[172:175]
    s_waitcnt lgkmcnt(4)
    buffer_load_dwordx4 v18, s[28:31], s65 offen offset:2048 lds
    v_mfma_f32_16x16x32_bf16 v[196:199], v[60:63], a[244:247], v[196:199]
    ds_read_b64_tr_b16 a[240:241], v8 offset:16400
    v_lshlrev_b32 v26, 4, v26
    v_mfma_f32_16x16x32_bf16 v[196:199], v[64:67], v[32:35], v[196:199]
    ds_read_b64_tr_b16 a[242:243], v8 offset:24080
    v_add_u32 v26, 3145728, v26
    v_mfma_f32_16x16x32_bf16 v[216:219], v[64:67], v[36:39], v[216:219]
    buffer_load_dwordx2 v[24:25], v26, s[40:43], 0 offen sc1
    v_mfma_f32_16x16x32_bf16 v[216:219], v[60:63], a[248:251], v[216:219]
    ds_read_b64_tr_b16 v[56:57], v8 offset:32784
    v_mul_u32_u24 v26, 15360, v28
    v_mfma_f32_16x16x32_bf16 v[236:239], v[60:63], a[252:255], v[236:239]
    s_mul_i32 s71, s56, 3840
    ds_read_b64_tr_b16 v[58:59], v8 offset:40464
    v_mfma_f32_16x16x32_bf16 v[236:239], v[64:67], v[40:43], v[236:239]
    s_waitcnt lgkmcnt(4)
    s_add_u32 s71, s71, 82688
    v_mfma_f32_16x16x32_bf16 v[240:243], v[68:71], v[40:43], v[240:243]
    ds_read_b64_tr_b16 v[60:61], v8 offset:32792
    v_add_u32 v26, s71, v26
    v_mfma_f32_16x16x32_bf16 v[240:243], v[72:75], a[252:255], v[240:243]
    s_lshl_b32 s71, s56, 10
    ds_read_b64_tr_b16 v[62:63], v8 offset:40472
    s_add_u32 s71, s71, 145408
    v_mfma_f32_16x16x32_bf16 v[220:223], v[72:75], a[248:251], v[220:223]
    buffer_load_dwordx4 v19, s[28:31], s65 offen offset:3072 lds
    v_mfma_f32_16x16x32_bf16 v[220:223], v[68:71], v[36:39], v[220:223]
    ds_read_b64_tr_b16 v[64:65], v8 offset:16408
    v_add_u32 v27, s71, v2
    v_mfma_f32_16x16x32_bf16 v[200:203], v[68:71], v[32:35], v[200:203]
    ds_read_b64_tr_b16 v[66:67], v8 offset:24088
    v_lshlrev_b32 v10, 8, v28
    v_mfma_f32_16x16x32_bf16 v[200:203], v[72:75], a[244:247], v[200:203]
    s_waitcnt lgkmcnt(4)
    buffer_load_dwordx4 a[32:35], v2, s[40:43], s67 offen offset:0 sc1
    v_mfma_f32_16x16x32_bf16 v[204:207], a[240:243], a[244:247], v[204:207]
    ds_read_b64_tr_b16 v[68:69], v8 offset:16416
    v_add_u32 v10, 145408, v10
    v_mfma_f32_16x16x32_bf16 v[204:207], v[56:59], v[32:35], v[204:207]
    ds_read_b64_tr_b16 v[70:71], v8 offset:24096
    v_and_b32 v11, 3, v1
    v_mfma_f32_16x16x32_bf16 v[224:227], v[56:59], v[36:39], v[224:227]
    v_bfe_u32 v28, v1, 2, 2
    v_lshl_add_u32 v11, v11, 2, v28
    v_mfma_f32_16x16x32_bf16 v[224:227], a[240:243], a[248:251], v[224:227]
    ds_read_b64_tr_b16 v[72:73], v8 offset:32800
    v_mul_u32_u24 v11, 80, v11
    v_mfma_f32_16x16x32_bf16 v[244:247], a[240:243], a[252:255], v[244:247]
    ds_read_b64_tr_b16 v[74:75], v8 offset:40480
    v_add_u32 v11, v11, v26
    v_mfma_f32_16x16x32_bf16 v[244:247], v[56:59], v[40:43], v[244:247]
    s_waitcnt lgkmcnt(4)
    buffer_load_dwordx4 a[36:39], v2, s[40:43], s67 offen offset:1024 sc1
    v_mfma_f32_16x16x32_bf16 v[248:251], v[60:63], v[40:43], v[248:251]
    ds_read_b64_tr_b16 a[240:241], v8 offset:32928
    v_mul_u32_u24 v29, 80, v29
    v_mfma_f32_16x16x32_bf16 v[248:251], v[64:67], a[252:255], v[248:251]
    ds_read_b64_tr_b16 a[242:243], v8 offset:40608
    v_add_u32 v26, v26, v29
    v_mfma_f32_16x16x32_bf16 v[228:231], v[64:67], a[248:251], v[228:231]
    buffer_load_dwordx4 a[40:43], v2, s[40:43], s67 offen offset:2048 sc1
    v_mfma_f32_16x16x32_bf16 v[228:231], v[60:63], v[36:39], v[228:231]
    ds_read_b64_tr_b16 v[56:57], v8 offset:16544
    v_mfma_f32_16x16x32_bf16 v[208:211], v[60:63], v[32:35], v[208:211]
    ds_read_b64_tr_b16 v[58:59], v8 offset:24224
    v_mfma_f32_16x16x32_bf16 v[208:211], v[64:67], a[244:247], v[208:211]
    s_waitcnt lgkmcnt(4)
    buffer_load_dwordx4 a[44:47], v2, s[40:43], s67 offen offset:3072 sc1
    s_add_u32 s67, s67, 4096
    v_mfma_f32_16x16x32_bf16 v[212:215], v[68:71], a[244:247], v[212:215]
    ds_read_b64_tr_b16 v[60:61], v8 offset:16552
    v_mfma_f32_16x16x32_bf16 v[212:215], v[72:75], v[32:35], v[212:215]
    ds_read_b64_tr_b16 v[62:63], v8 offset:24232
    v_mfma_f32_16x16x32_bf16 v[232:235], v[72:75], v[36:39], v[232:235]
    v_mfma_f32_16x16x32_bf16 v[232:235], v[68:71], a[248:251], v[232:235]
    ds_read_b64_tr_b16 v[64:65], v8 offset:32936
    v_mfma_f32_16x16x32_bf16 v[252:255], v[68:71], a[252:255], v[252:255]
    ds_read_b64_tr_b16 v[66:67], v8 offset:40616
    v_mfma_f32_16x16x32_bf16 v[252:255], v[72:75], v[40:43], v[252:255]
    s_waitcnt lgkmcnt(4)
    buffer_load_dwordx4 a[48:51], v2, s[40:43], s67 offen offset:0 sc1
    v_mfma_f32_16x16x32_bf16 v[96:99], a[240:243], v[40:43], v[96:99]
    ds_read_b64_tr_b16 v[68:69], v8 offset:32944
    v_mfma_f32_16x16x32_bf16 v[96:99], v[56:59], a[252:255], v[96:99]
    ds_read_b64_tr_b16 v[70:71], v8 offset:40624
    v_mfma_f32_16x16x32_bf16 v[176:179], v[56:59], a[248:251], v[176:179]
    v_mfma_f32_16x16x32_bf16 v[176:179], a[240:243], v[36:39], v[176:179]
    ds_read_b64_tr_b16 v[72:73], v8 offset:16560
    v_mfma_f32_16x16x32_bf16 v[76:79], a[240:243], v[32:35], v[76:79]
    ds_read_b64_tr_b16 v[74:75], v8 offset:24240
    v_mfma_f32_16x16x32_bf16 v[76:79], v[56:59], a[244:247], v[76:79]
    s_waitcnt lgkmcnt(4)
    buffer_load_dwordx4 a[52:55], v2, s[40:43], s67 offen offset:1024 sc1
    v_mfma_f32_16x16x32_bf16 v[80:83], v[60:63], a[244:247], v[80:83]
    ds_read_b64_tr_b16 a[240:241], v8 offset:32952
    v_mfma_f32_16x16x32_bf16 v[80:83], v[64:67], v[32:35], v[80:83]
    ds_read_b64_tr_b16 a[242:243], v8 offset:40632
    v_mfma_f32_16x16x32_bf16 v[180:183], v[64:67], v[36:39], v[180:183]
    v_mfma_f32_16x16x32_bf16 v[180:183], v[60:63], a[248:251], v[180:183]
    ds_read_b64_tr_b16 v[56:57], v8 offset:32960
    v_mfma_f32_16x16x32_bf16 v[100:103], v[60:63], a[252:255], v[100:103]
    ds_read_b64_tr_b16 v[58:59], v8 offset:40640
    v_mfma_f32_16x16x32_bf16 v[100:103], v[64:67], v[40:43], v[100:103]
    s_waitcnt lgkmcnt(4)
    buffer_load_dwordx4 a[56:59], v2, s[40:43], s67 offen offset:2048 sc1
    v_mfma_f32_16x16x32_bf16 v[104:107], v[68:71], v[40:43], v[104:107]
    ds_read_b64_tr_b16 v[60:61], v8 offset:33088
    v_mfma_f32_16x16x32_bf16 v[104:107], v[72:75], a[252:255], v[104:107]
    ds_read_b64_tr_b16 v[62:63], v8 offset:40768
    v_mfma_f32_16x16x32_bf16 v[184:187], v[72:75], a[248:251], v[184:187]
    s_waitcnt vmcnt(17)
    s_barrier
    ds_read_b128 v[44:47], v6 offset:0
    v_mfma_f32_16x16x32_bf16 v[184:187], v[68:71], v[36:39], v[184:187]
    ds_read_b64_tr_b16 v[64:65], v8 offset:33096
    v_mfma_f32_16x16x32_bf16 v[84:87], v[68:71], v[32:35], v[84:87]
    ds_read_b64_tr_b16 v[66:67], v8 offset:40776
    v_mfma_f32_16x16x32_bf16 v[84:87], v[72:75], a[244:247], v[84:87]
    s_waitcnt lgkmcnt(7)
    ds_read_b128 v[48:51], v4 offset:2048
    v_mfma_f32_16x16x32_bf16 v[88:91], a[240:243], v[32:35], v[88:91]
    ds_read_b64_tr_b16 v[68:69], v8 offset:33104
    v_mfma_f32_16x16x32_bf16 v[188:191], a[240:243], v[36:39], v[188:191]
    ds_read_b64_tr_b16 v[70:71], v8 offset:40784
    v_mfma_f32_16x16x32_bf16 v[108:111], a[240:243], v[40:43], v[108:111]
    s_waitcnt lgkmcnt(8)
    ds_read_b128 v[52:55], v4 offset:4096
    v_mfma_f32_16x16x32_bf16 v[112:115], v[56:59], v[40:43], v[112:115]
    ds_read_b64_tr_b16 v[72:73], v8 offset:33112
    v_mfma_f32_16x16x32_bf16 v[192:195], v[56:59], v[36:39], v[192:195]
    ds_read_b64_tr_b16 v[74:75], v8 offset:40792
    v_mfma_f32_16x16x32_bf16 v[92:95], v[56:59], v[32:35], v[92:95]
    s_waitcnt lgkmcnt(9)
    ds_read_b128 a[244:247], v7 offset:0
    v_mfma_f32_16x16x32_bf16 v[116:119], v[60:63], v[32:35], v[116:119]
    ds_read_b64_tr_b16 a[240:241], v8 offset:33120
    v_mfma_f32_16x16x32_bf16 v[136:139], v[60:63], v[36:39], v[136:139]
    ds_read_b64_tr_b16 a[242:243], v8 offset:40800
    v_mfma_f32_16x16x32_bf16 v[156:159], v[60:63], v[40:43], v[156:159]
    s_waitcnt lgkmcnt(9)
    ds_read_b128 a[248:251], v5 offset:2048
    v_mfma_f32_16x16x32_bf16 v[160:163], v[64:67], v[40:43], v[160:163]
    ds_read_b64_tr_b16 v[56:57], v8 offset:49152
    v_mfma_f32_16x16x32_bf16 v[140:143], v[64:67], v[36:39], v[140:143]
    ds_read_b64_tr_b16 v[58:59], v8 offset:56832
    v_mfma_f32_16x16x32_bf16 v[120:123], v[64:67], v[32:35], v[120:123]
    s_waitcnt lgkmcnt(9) vmcnt(7)
    s_barrier
    buffer_load_dwordx4 a[60:63], v2, s[40:43], s67 offen offset:3072 sc1
    v_mfma_f32_16x16x32_bf16 v[124:127], v[68:71], v[32:35], v[124:127]
    s_add_u32 s67, s67, 4096
    ds_read_b64_tr_b16 v[60:61], v9 offset:0
    v_mfma_f32_16x16x32_bf16 v[144:147], v[68:71], v[36:39], v[144:147]
    ds_read_b64_tr_b16 v[62:63], v9 offset:7680
    v_mfma_f32_16x16x32_bf16 v[164:167], v[68:71], v[40:43], v[164:167]
    s_waitcnt lgkmcnt(8)
    ds_read_b128 a[252:255], v5 offset:4096
    v_mfma_f32_16x16x32_bf16 v[168:171], v[72:75], v[40:43], v[168:171]
    ds_read_b64_tr_b16 v[64:65], v8 offset:49160
    v_mfma_f32_16x16x32_bf16 v[148:151], v[72:75], v[36:39], v[148:151]
    ds_read_b64_tr_b16 v[66:67], v8 offset:56840
    v_mfma_f32_16x16x32_bf16 v[128:131], v[72:75], v[32:35], v[128:131]
    s_waitcnt lgkmcnt(8)
    buffer_load_dwordx4 a[64:67], v2, s[40:43], s67 offen offset:0 sc1
    v_mfma_f32_16x16x32_bf16 v[132:135], a[240:243], v[32:35], v[132:135]
    ds_read_b64_tr_b16 v[68:69], v9 offset:8
    v_mfma_f32_16x16x32_bf16 v[152:155], a[240:243], v[36:39], v[152:155]
    ds_read_b64_tr_b16 v[70:71], v9 offset:7688
    v_mfma_f32_16x16x32_bf16 v[172:175], a[240:243], v[40:43], v[172:175]
    s_waitcnt lgkmcnt(4)
    buffer_load_dwordx4 a[68:71], v2, s[40:43], s67 offen offset:1024 sc1
    v_mfma_f32_16x16x32_bf16 v[196:199], v[56:59], v[44:47], v[196:199]
    ds_read_b64_tr_b16 v[72:73], v8 offset:49168
    v_mfma_f32_16x16x32_bf16 v[196:199], v[60:63], a[244:247], v[196:199]
    ds_read_b64_tr_b16 v[74:75], v8 offset:56848
    v_mfma_f32_16x16x32_bf16 v[216:219], v[60:63], a[248:251], v[216:219]
    buffer_load_dwordx4 a[72:75], v2, s[40:43], s67 offen offset:2048 sc1
    v_mfma_f32_16x16x32_bf16 v[216:219], v[56:59], v[48:51], v[216:219]
    ds_read_b64_tr_b16 a[240:241], v9 offset:16
    v_mfma_f32_16x16x32_bf16 v[236:239], v[56:59], v[52:55], v[236:239]
    ds_read_b64_tr_b16 a[242:243], v9 offset:7696
    v_mfma_f32_16x16x32_bf16 v[236:239], v[60:63], a[252:255], v[236:239]
    s_waitcnt lgkmcnt(4)
    buffer_load_dwordx4 a[76:79], v2, s[40:43], s67 offen offset:3072 sc1
    s_add_u32 s67, s67, 4096
    v_mfma_f32_16x16x32_bf16 v[200:203], v[64:67], v[44:47], v[200:203]
    ds_read_b64_tr_b16 v[56:57], v8 offset:49176
    v_mfma_f32_16x16x32_bf16 v[200:203], v[68:71], a[244:247], v[200:203]
    ds_read_b64_tr_b16 v[58:59], v8 offset:56856
    v_mov_b32 v28, v196
    v_mfma_f32_16x16x32_bf16 v[220:223], v[68:71], a[248:251], v[220:223]
    buffer_load_dwordx4 a[80:83], v2, s[40:43], s67 offen offset:0 sc1
    v_mfma_f32_16x16x32_bf16 v[220:223], v[64:67], v[48:51], v[220:223]
    ds_read_b64_tr_b16 v[60:61], v9 offset:24
    v_mov_b32 v29, v197
    v_mfma_f32_16x16x32_bf16 v[240:243], v[64:67], v[52:55], v[240:243]
    ds_read_b64_tr_b16 v[62:63], v9 offset:7704
    v_mov_b32 v30, v198
    v_mfma_f32_16x16x32_bf16 v[240:243], v[68:71], a[252:255], v[240:243]
    s_waitcnt lgkmcnt(4)
    buffer_load_dwordx4 a[84:87], v2, s[40:43], s67 offen offset:1024 sc1
    v_mfma_f32_16x16x32_bf16 v[204:207], v[72:75], v[44:47], v[204:207]
    ds_read_b64_tr_b16 v[64:65], v8 offset:49184
    v_mov_b32 v31, v199
    v_mfma_f32_16x16x32_bf16 v[204:207], a[240:243], a[244:247], v[204:207]
    ds_read_b64_tr_b16 v[66:67], v8 offset:56864
    v_mov_b32_dpp v28, v200 row_shr:1 row_mask:0xf bank_mask:0xf
    v_mfma_f32_16x16x32_bf16 v[224:227], a[240:243], a[248:251], v[224:227]
    buffer_load_dwordx4 a[88:91], v2, s[40:43], s67 offen offset:2048 sc1
    v_mfma_f32_16x16x32_bf16 v[224:227], v[72:75], v[48:51], v[224:227]
    ds_read_b64_tr_b16 v[68:69], v9 offset:32
    v_mov_b32_dpp v29, v201 row_shr:1 row_mask:0xf bank_mask:0xf
    v_mfma_f32_16x16x32_bf16 v[244:247], v[72:75], v[52:55], v[244:247]
    ds_read_b64_tr_b16 v[70:71], v9 offset:7712
    v_mov_b32_dpp v30, v202 row_shr:1 row_mask:0xf bank_mask:0xf
    v_mfma_f32_16x16x32_bf16 v[244:247], a[240:243], a[252:255], v[244:247]
    s_waitcnt lgkmcnt(4)
    buffer_load_dwordx4 a[92:95], v2, s[40:43], s67 offen offset:3072 sc1
    s_add_u32 s67, s67, 4096
    v_mfma_f32_16x16x32_bf16 v[208:211], v[56:59], v[44:47], v[208:211]
    ds_read_b64_tr_b16 v[72:73], v8 offset:49312
    v_mov_b32_dpp v31, v203 row_shr:1 row_mask:0xf bank_mask:0xf
    v_mfma_f32_16x16x32_bf16 v[208:211], v[60:63], a[244:247], v[208:211]
    ds_read_b64_tr_b16 v[74:75], v8 offset:56992
    v_mov_b32_dpp v28, v204 row_shr:2 row_mask:0xf bank_mask:0xf
    v_mfma_f32_16x16x32_bf16 v[228:231], v[60:63], a[248:251], v[228:231]
    buffer_load_dwordx4 a[96:99], v2, s[40:43], s67 offen offset:0 sc1
    s_xor_b32 s66, s82, 0
    v_mfma_f32_16x16x32_bf16 v[228:231], v[56:59], v[48:51], v[228:231]
    s_mul_i32 s66, s66, 15360
    ds_read_b64_tr_b16 a[240:241], v9 offset:160
    s_add_u32 s66, s66, s83
    v_mfma_f32_16x16x32_bf16 v[248:251], v[56:59], v[52:55], v[248:251]
    ds_read_b64_tr_b16 a[242:243], v9 offset:7840
    v_mov_b32_dpp v29, v205 row_shr:2 row_mask:0xf bank_mask:0xf
    v_mfma_f32_16x16x32_bf16 v[248:251], v[60:63], a[252:255], v[248:251]
    s_waitcnt lgkmcnt(4)
    buffer_load_dwordx4 a[100:103], v2, s[40:43], s66 offen offset:0 sc1
    v_mfma_f32_16x16x32_bf16 v[212:215], v[64:67], v[44:47], v[212:215]
    ds_read_b64_tr_b16 v[56:57], v8 offset:49320
    v_mov_b32_dpp v30, v206 row_shr:2 row_mask:0xf bank_mask:0xf
    v_mfma_f32_16x16x32_bf16 v[212:215], v[68:71], a[244:247], v[212:215]
    ds_read_b64_tr_b16 v[58:59], v8 offset:57000
    v_mov_b32_dpp v31, v207 row_shr:2 row_mask:0xf bank_mask:0xf
    v_mfma_f32_16x16x32_bf16 v[232:235], v[68:71], a[248:251], v[232:235]
    v_mov_b32_dpp v28, v208 row_shr:3 row_mask:0xf bank_mask:0xf
    v_mov_b32_dpp v29, v209 row_shr:3 row_mask:0xf bank_mask:0xf
    v_mfma_f32_16x16x32_bf16 v[232:235], v[64:67], v[48:51], v[232:235]
    ds_read_b64_tr_b16 v[60:61], v9 offset:168
    v_mov_b32_dpp v30, v210 row_shr:3 row_mask:0xf bank_mask:0xf
    v_mfma_f32_16x16x32_bf16 v[252:255], v[64:67], v[52:55], v[252:255]
    ds_read_b64_tr_b16 v[62:63], v9 offset:7848
    v_mov_b32_dpp v31, v211 row_shr:3 row_mask:0xf bank_mask:0xf
    v_mfma_f32_16x16x32_bf16 v[252:255], v[68:71], a[252:255], v[252:255]
    s_waitcnt lgkmcnt(4)
    buffer_load_dwordx4 a[104:107], v2, s[40:43], s66 offen offset:1024 sc1
    v_mfma_f32_16x16x32_bf16 v[76:79], v[72:75], v[44:47], v[76:79]
    ds_read_b64_tr_b16 v[64:65], v8 offset:49328
    v_mfma_f32_16x16x32_bf16 v[76:79], a[240:243], a[244:247], v[76:79]
    ds_read_b64_tr_b16 v[66:67], v8 offset:57008
    v_mov_b32_dpp v28, v212 row_shr:4 row_mask:0xf bank_mask:0xf
    v_mfma_f32_16x16x32_bf16 v[176:179], a[240:243], a[248:251], v[176:179]
    buffer_load_dwordx4 a[108:111], v2, s[40:43], s66 offen offset:2048 sc1
    v_mfma_f32_16x16x32_bf16 v[176:179], v[72:75], v[48:51], v[176:179]
    ds_read_b64_tr_b16 v[68:69], v9 offset:176
    v_mov_b32_dpp v29, v213 row_shr:4 row_mask:0xf bank_mask:0xf
    v_mfma_f32_16x16x32_bf16 v[96:99], v[72:75], v[52:55], v[96:99]
    ds_read_b64_tr_b16 v[70:71], v9 offset:7856
    v_mov_b32_dpp v30, v214 row_shr:4 row_mask:0xf bank_mask:0xf
    v_mfma_f32_16x16x32_bf16 v[96:99], a[240:243], a[252:255], v[96:99]
    s_waitcnt lgkmcnt(4)
    v_mov_b32_dpp v31, v215 row_shr:4 row_mask:0xf bank_mask:0xf
    v_mfma_f32_16x16x32_bf16 v[80:83], v[56:59], v[44:47], v[80:83]
    ds_read_b64_tr_b16 v[72:73], v8 offset:49336
    v_mfma_f32_16x16x32_bf16 v[80:83], v[60:63], a[244:247], v[80:83]
    ds_read_b64_tr_b16 v[74:75], v8 offset:57016
    v_mfma_f32_16x16x32_bf16 v[180:183], v[60:63], a[248:251], v[180:183]
    ds_write_b128 v27, v[28:31]
    v_mfma_f32_16x16x32_bf16 v[180:183], v[56:59], v[48:51], v[180:183]
    ds_read_b64_tr_b16 a[240:241], v9 offset:184
    v_mov_b32_dpp v28, v76 row_shr:5 row_mask:0xf bank_mask:0xf
    v_mfma_f32_16x16x32_bf16 v[100:103], v[56:59], v[52:55], v[100:103]
    ds_read_b64_tr_b16 a[242:243], v9 offset:7864
    v_mov_b32_dpp v29, v77 row_shr:5 row_mask:0xf bank_mask:0xf
    v_mfma_f32_16x16x32_bf16 v[100:103], v[60:63], a[252:255], v[100:103]
    s_waitcnt lgkmcnt(5)
    buffer_load_dwordx4 a[112:115], v2, s[40:43], s66 offen offset:3072 sc1
    s_add_u32 s66, s66, 4096
    v_mfma_f32_16x16x32_bf16 v[84:87], v[64:67], v[44:47], v[84:87]
    ds_read_b64_tr_b16 v[56:57], v8 offset:49344
    v_mov_b32_dpp v30, v78 row_shr:5 row_mask:0xf bank_mask:0xf
    v_mfma_f32_16x16x32_bf16 v[84:87], v[68:71], a[244:247], v[84:87]
    ds_read_b64_tr_b16 v[58:59], v8 offset:57024
    v_mov_b32_dpp v31, v79 row_shr:5 row_mask:0xf bank_mask:0xf
    v_mfma_f32_16x16x32_bf16 v[184:187], v[68:71], a[248:251], v[184:187]
    s_waitcnt lgkmcnt(4)
    s_barrier
    ds_read_b128 v[12:15], v10 offset:0
    v_mfma_f32_16x16x32_bf16 v[184:187], v[64:67], v[48:51], v[184:187]
    ds_read_b64_tr_b16 v[60:61], v9 offset:192
    v_mov_b32_dpp v28, v80 row_shr:6 row_mask:0xf bank_mask:0xf
    v_mfma_f32_16x16x32_bf16 v[104:107], v[64:67], v[52:55], v[104:107]
    ds_read_b64_tr_b16 v[62:63], v9 offset:7872
    v_mov_b32_dpp v29, v81 row_shr:6 row_mask:0xf bank_mask:0xf
    v_mfma_f32_16x16x32_bf16 v[104:107], v[68:71], a[252:255], v[104:107]
    s_waitcnt lgkmcnt(5)
    ds_read_b128 v[16:19], v10 offset:16
    v_mov_b32_dpp v30, v82 row_shr:6 row_mask:0xf bank_mask:0xf
    v_mfma_f32_16x16x32_bf16 v[88:91], v[72:75], v[44:47], v[88:91]
    ds_read_b64_tr_b16 v[64:65], v8 offset:49472
    v_mov_b32_dpp v31, v83 row_shr:6 row_mask:0xf bank_mask:0xf
    v_mfma_f32_16x16x32_bf16 v[88:91], a[240:243], a[244:247], v[88:91]
    ds_read_b64_tr_b16 v[66:67], v8 offset:57152
    v_mov_b32_dpp v28, v84 row_shr:7 row_mask:0xf bank_mask:0xf
    v_mfma_f32_16x16x32_bf16 v[188:191], a[240:243], a[248:251], v[188:191]
    ds_read_b128 v[32:35], v10 offset:32
    v_mov_b32_dpp v29, v85 row_shr:7 row_mask:0xf bank_mask:0xf
    v_mfma_f32_16x16x32_bf16 v[188:191], v[72:75], v[48:51], v[188:191]
    ds_read_b64_tr_b16 v[68:69], v9 offset:320
    v_mov_b32_dpp v30, v86 row_shr:7 row_mask:0xf bank_mask:0xf
    v_mfma_f32_16x16x32_bf16 v[108:111], v[72:75], v[52:55], v[108:111]
    ds_read_b64_tr_b16 v[70:71], v9 offset:8000
    v_mov_b32_dpp v31, v87 row_shr:7 row_mask:0xf bank_mask:0xf
    v_mfma_f32_16x16x32_bf16 v[108:111], a[240:243], a[252:255], v[108:111]
    s_waitcnt lgkmcnt(6)
    ds_read_b128 v[36:39], v10 offset:48
    v_mfma_f32_16x16x32_bf16 v[92:95], v[56:59], v[44:47], v[92:95]
    ds_read_b64_tr_b16 v[72:73], v8 offset:49480
    v_mfma_f32_16x16x32_bf16 v[92:95], v[60:63], a[244:247], v[92:95]
    ds_read_b64_tr_b16 v[74:75], v8 offset:57160
    v_mov_b32_dpp v28, v88 row_shr:8 row_mask:0xf bank_mask:0xf
    v_mfma_f32_16x16x32_bf16 v[192:195], v[60:63], a[248:251], v[192:195]
    ds_read_b128 v[40:43], v10 offset:64
    v_mov_b32_dpp v29, v89 row_shr:8 row_mask:0xf bank_mask:0xf
    v_mfma_f32_16x16x32_bf16 v[192:195], v[56:59], v[48:51], v[192:195]
    ds_read_b64_tr_b16 a[240:241], v9 offset:328
    v_mov_b32_dpp v30, v90 row_shr:8 row_mask:0xf bank_mask:0xf
    v_mfma_f32_16x16x32_bf16 v[112:115], v[56:59], v[52:55], v[112:115]
    ds_read_b64_tr_b16 a[242:243], v9 offset:8008
    v_mov_b32_dpp v31, v91 row_shr:8 row_mask:0xf bank_mask:0xf
    v_mfma_f32_16x16x32_bf16 v[112:115], v[60:63], a[252:255], v[112:115]
    s_waitcnt lgkmcnt(6)
    buffer_load_dwordx4 a[116:119], v2, s[40:43], s66 offen offset:0 sc1
    v_mfma_f32_16x16x32_bf16 v[116:119], v[64:67], v[44:47], v[116:119]
    ds_read_b64_tr_b16 v[56:57], v8 offset:49488
    v_mfma_f32_16x16x32_bf16 v[116:119], v[68:71], a[244:247], v[116:119]
    ds_read_b64_tr_b16 v[58:59], v8 offset:57168
    v_mov_b32_dpp v28, v92 row_shr:9 row_mask:0xf bank_mask:0xf
    v_mfma_f32_16x16x32_bf16 v[136:139], v[68:71], a[248:251], v[136:139]
    buffer_load_dwordx4 a[120:123], v2, s[40:43], s66 offen offset:1024 sc1
    v_mfma_f32_16x16x32_bf16 v[136:139], v[64:67], v[48:51], v[136:139]
    ds_read_b64_tr_b16 v[60:61], v9 offset:336
    v_mov_b32_dpp v29, v93 row_shr:9 row_mask:0xf bank_mask:0xf
    v_mfma_f32_16x16x32_bf16 v[156:159], v[64:67], v[52:55], v[156:159]
    ds_read_b64_tr_b16 v[62:63], v9 offset:8016
    v_mov_b32_dpp v30, v94 row_shr:9 row_mask:0xf bank_mask:0xf
    v_mfma_f32_16x16x32_bf16 v[156:159], v[68:71], a[252:255], v[156:159]
    s_waitcnt lgkmcnt(4)
    buffer_load_dwordx4 a[124:127], v2, s[40:43], s66 offen offset:2048 sc1
    v_mfma_f32_16x16x32_bf16 v[120:123], v[72:75], v[44:47], v[120:123]
    ds_read_b64_tr_b16 v[64:65], v8 offset:49496
    v_mov_b32_dpp v31, v95 row_shr:9 row_mask:0xf bank_mask:0xf
    v_mfma_f32_16x16x32_bf16 v[120:123], a[240:243], a[244:247], v[120:123]
    ds_read_b64_tr_b16 v[66:67], v8 offset:57176
    v_mov_b32_dpp v28, v116 row_shr:10 row_mask:0xf bank_mask:0xf
    v_mfma_f32_16x16x32_bf16 v[140:143], a[240:243], a[248:251], v[140:143]
    buffer_load_dwordx4 a[128:131], v2, s[40:43], s66 offen offset:3072 sc1
    s_add_u32 s66, s66, 4096
    v_mfma_f32_16x16x32_bf16 v[140:143], v[72:75], v[48:51], v[140:143]
    ds_read_b64_tr_b16 v[68:69], v9 offset:344
    v_mov_b32_dpp v29, v117 row_shr:10 row_mask:0xf bank_mask:0xf
    v_mfma_f32_16x16x32_bf16 v[160:163], v[72:75], v[52:55], v[160:163]
    ds_read_b64_tr_b16 v[70:71], v9 offset:8024
    v_mov_b32_dpp v30, v118 row_shr:10 row_mask:0xf bank_mask:0xf
    v_mfma_f32_16x16x32_bf16 v[160:163], a[240:243], a[252:255], v[160:163]
    s_waitcnt lgkmcnt(4)
    buffer_load_dwordx4 a[132:135], v2, s[40:43], s66 offen offset:0 sc1
    v_mfma_f32_16x16x32_bf16 v[124:127], v[56:59], v[44:47], v[124:127]
    ds_read_b64_tr_b16 v[72:73], v8 offset:49504
    v_mov_b32_dpp v31, v119 row_shr:10 row_mask:0xf bank_mask:0xf
    v_mfma_f32_16x16x32_bf16 v[124:127], v[60:63], a[244:247], v[124:127]
    ds_read_b64_tr_b16 v[74:75], v8 offset:57184
    v_mov_b32_dpp v28, v120 row_shr:11 row_mask:0xf bank_mask:0xf
    v_mfma_f32_16x16x32_bf16 v[144:147], v[60:63], a[248:251], v[144:147]
    buffer_load_dwordx4 a[136:139], v2, s[40:43], s66 offen offset:1024 sc1
    v_mfma_f32_16x16x32_bf16 v[144:147], v[56:59], v[48:51], v[144:147]
    ds_read_b64_tr_b16 a[240:241], v9 offset:352
    v_mov_b32_dpp v29, v121 row_shr:11 row_mask:0xf bank_mask:0xf
    v_mfma_f32_16x16x32_bf16 v[164:167], v[56:59], v[52:55], v[164:167]
    ds_read_b64_tr_b16 a[242:243], v9 offset:8032
    v_mov_b32_dpp v30, v122 row_shr:11 row_mask:0xf bank_mask:0xf
    v_mfma_f32_16x16x32_bf16 v[164:167], v[60:63], a[252:255], v[164:167]
    s_waitcnt lgkmcnt(4)
    buffer_load_dwordx4 a[140:143], v2, s[40:43], s66 offen offset:2048 sc1
    v_mfma_f32_16x16x32_bf16 v[128:131], v[64:67], v[44:47], v[128:131]
    buffer_load_dwordx4 a[144:147], v2, s[40:43], s66 offen offset:3072 sc1
    s_add_u32 s66, s66, 4096
    v_mfma_f32_16x16x32_bf16 v[128:131], v[68:71], a[244:247], v[128:131]
    buffer_load_dwordx4 a[148:151], v2, s[40:43], s66 offen offset:0 sc1
    v_mfma_f32_16x16x32_bf16 v[148:151], v[68:71], a[248:251], v[148:151]
    v_mov_b32_dpp v31, v123 row_shr:11 row_mask:0xf bank_mask:0xf
    v_mov_b32_dpp v28, v124 row_shr:12 row_mask:0xf bank_mask:0xf
    v_mfma_f32_16x16x32_bf16 v[148:151], v[64:67], v[48:51], v[148:151]
    v_mov_b32_dpp v29, v125 row_shr:12 row_mask:0xf bank_mask:0xf
    v_mov_b32_dpp v30, v126 row_shr:12 row_mask:0xf bank_mask:0xf
    v_mfma_f32_16x16x32_bf16 v[168:171], v[64:67], v[52:55], v[168:171]
    v_mov_b32_dpp v31, v127 row_shr:12 row_mask:0xf bank_mask:0xf
    v_mfma_f32_16x16x32_bf16 v[168:171], v[68:71], a[252:255], v[168:171]
    s_waitcnt lgkmcnt(0)
    buffer_load_dwordx4 a[152:155], v2, s[40:43], s66 offen offset:1024 sc1
    v_mfma_f32_16x16x32_bf16 v[132:135], v[72:75], v[44:47], v[132:135]
    v_mfma_f32_16x16x32_bf16 v[132:135], a[240:243], a[244:247], v[132:135]
    v_mov_b32_dpp v28, v128 row_shr:13 row_mask:0xf bank_mask:0xf
    v_mov_b32_dpp v29, v129 row_shr:13 row_mask:0xf bank_mask:0xf
Q_PG4:
    s_cbranch_execz Q_TRET
    v_mfma_f32_16x16x32_bf16 v[152:155], a[240:243], a[248:251], v[152:155]
    v_mov_b32_dpp v30, v130 row_shr:13 row_mask:0xf bank_mask:0xf
    v_mov_b32_dpp v31, v131 row_shr:13 row_mask:0xf bank_mask:0xf
    v_mfma_f32_16x16x32_bf16 v[152:155], v[72:75], v[48:51], v[152:155]
    buffer_load_dwordx4 a[156:159], v2, s[40:43], s66 offen offset:2048 sc1
    s_xor_b32 s66, s82, 1
    v_mfma_f32_16x16x32_bf16 v[172:175], v[72:75], v[52:55], v[172:175]
    s_mul_i32 s66, s66, 15360
    s_add_u32 s66, s66, s83
    v_mfma_f32_16x16x32_bf16 v[172:175], a[240:243], a[252:255], v[172:175]
    v_pk_fma_f32 v[216:217], v[12:13], v[22:23], v[216:217] op_sel:[0,1,0]
    buffer_load_dwordx4 a[160:163], v2, s[40:43], s66 offen offset:0 sc1
    buffer_load_dwordx4 a[164:167], v2, s[40:43], s66 offen offset:1024 sc1
    buffer_load_dwordx4 a[168:171], v2, s[40:43], s66 offen offset:2048 sc1
    v_pk_fma_f32 v[218:219], v[14:15], v[22:23], v[218:219] op_sel:[0,1,0]
    v_pk_fma_f32 v[220:221], v[16:17], v[22:23], v[220:221] op_sel:[0,1,0]
    v_pk_fma_f32 v[222:223], v[18:19], v[22:23], v[222:223] op_sel:[0,1,0]
    v_pk_fma_f32 v[224:225], v[32:33], v[22:23], v[224:225] op_sel:[0,1,0]
    v_pk_fma_f32 v[226:227], v[34:35], v[22:23], v[226:227] op_sel:[0,1,0]
    v_pk_fma_f32 v[228:229], v[36:37], v[22:23], v[228:229] op_sel:[0,1,0]
    v_pk_fma_f32 v[230:231], v[38:39], v[22:23], v[230:231] op_sel:[0,1,0]
    v_pk_fma_f32 v[232:233], v[40:41], v[22:23], v[232:233] op_sel:[0,1,0]
    v_pk_fma_f32 v[234:235], v[42:43], v[22:23], v[234:235] op_sel:[0,1,0]
    v_mov_b32_dpp v28, v132 row_shr:14 row_mask:0xf bank_mask:0xf
    v_mov_b32_dpp v29, v133 row_shr:14 row_mask:0xf bank_mask:0xf
    v_mov_b32_dpp v30, v134 row_shr:14 row_mask:0xf bank_mask:0xf
    v_mov_b32_dpp v31, v135 row_shr:14 row_mask:0xf bank_mask:0xf
    ds_write_b128 v27, v[28:31]
    v_cvt_pk_bf16_f32 v216, v216, v217
    v_cvt_pk_bf16_f32 v217, v218, v219
    v_cvt_pk_bf16_f32 v218, v220, v221
    v_cvt_pk_bf16_f32 v219, v222, v223
    v_cvt_pk_bf16_f32 v220, v224, v225
    v_cvt_pk_bf16_f32 v221, v226, v227
    v_cvt_pk_bf16_f32 v222, v228, v229
    v_cvt_pk_bf16_f32 v223, v230, v231
    v_cvt_pk_bf16_f32 v224, v232, v233
    v_cvt_pk_bf16_f32 v225, v234, v235
    v_pk_fma_f32 v[196:197], v[12:13], v[20:21], v[196:197] op_sel:[0,1,0]
    v_pk_fma_f32 v[198:199], v[14:15], v[20:21], v[198:199] op_sel:[0,1,0]
    v_pk_fma_f32 v[200:201], v[16:17], v[20:21], v[200:201] op_sel:[0,1,0]
    v_pk_fma_f32 v[202:203], v[18:19], v[20:21], v[202:203] op_sel:[0,1,0]
    v_pk_fma_f32 v[204:205], v[32:33], v[20:21], v[204:205] op_sel:[0,1,0]
    buffer_load_dwordx4 a[172:175], v2, s[40:43], s66 offen offset:3072 sc1
    s_add_u32 s66, s66, 4096
    buffer_load_dwordx4 a[176:179], v2, s[40:43], s66 offen offset:0 sc1
    buffer_load_dwordx4 a[180:183], v2, s[40:43], s66 offen offset:1024 sc1
    v_pk_fma_f32 v[206:207], v[34:35], v[20:21], v[206:207] op_sel:[0,1,0]
    v_pk_fma_f32 v[208:209], v[36:37], v[20:21], v[208:209] op_sel:[0,1,0]
    v_pk_fma_f32 v[210:211], v[38:39], v[20:21], v[210:211] op_sel:[0,1,0]
    v_pk_fma_f32 v[212:213], v[40:41], v[20:21], v[212:213] op_sel:[0,1,0]
    v_pk_fma_f32 v[214:215], v[42:43], v[20:21], v[214:215] op_sel:[0,1,0]
    v_cvt_pk_bf16_f32 v196, v196, v197
    v_cvt_pk_bf16_f32 v197, v198, v199
    v_cvt_pk_bf16_f32 v198, v200, v201
    v_cvt_pk_bf16_f32 v199, v202, v203
    v_cvt_pk_bf16_f32 v200, v204, v205
    v_cvt_pk_bf16_f32 v201, v206, v207
    v_cvt_pk_bf16_f32 v202, v208, v209
    v_cvt_pk_bf16_f32 v203, v210, v211
    v_cvt_pk_bf16_f32 v204, v212, v213
    v_cvt_pk_bf16_f32 v205, v214, v215
    s_waitcnt lgkmcnt(0)
    s_barrier
    ds_read_b128 v[44:47], v10 offset:80
    ds_read_b128 v[48:51], v10 offset:96
    ds_read_b128 v[52:55], v10 offset:112
    ds_read_b128 v[56:59], v10 offset:128
    ds_read_b128 v[60:63], v10 offset:144
    v_pk_fma_f32 v[236:237], v[12:13], v[24:25], v[236:237] op_sel:[0,1,0]
    v_pk_fma_f32 v[238:239], v[14:15], v[24:25], v[238:239] op_sel:[0,1,0]
    v_pk_fma_f32 v[240:241], v[16:17], v[24:25], v[240:241] op_sel:[0,1,0]
    v_pk_fma_f32 v[242:243], v[18:19], v[24:25], v[242:243] op_sel:[0,1,0]
    v_pk_fma_f32 v[244:245], v[32:33], v[24:25], v[244:245] op_sel:[0,1,0]
    v_pk_fma_f32 v[246:247], v[34:35], v[24:25], v[246:247] op_sel:[0,1,0]
    v_pk_fma_f32 v[248:249], v[36:37], v[24:25], v[248:249] op_sel:[0,1,0]
    v_pk_fma_f32 v[250:251], v[38:39], v[24:25], v[250:251] op_sel:[0,1,0]
    v_pk_fma_f32 v[252:253], v[40:41], v[24:25], v[252:253] op_sel:[0,1,0]
    buffer_load_dwordx4 a[184:187], v2, s[40:43], s66 offen offset:2048 sc1
    buffer_load_dwordx4 a[188:191], v2, s[40:43], s66 offen offset:3072 sc1
    s_add_u32 s66, s66, 4096
    buffer_load_dwordx4 a[192:195], v2, s[40:43], s66 offen offset:0 sc1
    v_pk_fma_f32 v[254:255], v[42:43], v[24:25], v[254:255] op_sel:[0,1,0]
    v_cvt_pk_bf16_f32 v236, v236, v237
    ds_read_b128 v[12:15], v10 offset:160
    v_cvt_pk_bf16_f32 v237, v238, v239
    v_cvt_pk_bf16_f32 v238, v240, v241
    v_cvt_pk_bf16_f32 v239, v242, v243
    ds_read_b128 v[16:19], v10 offset:176
    v_cvt_pk_bf16_f32 v240, v244, v245
    v_cvt_pk_bf16_f32 v241, v246, v247
    v_cvt_pk_bf16_f32 v242, v248, v249
    ds_read_b128 v[32:35], v10 offset:192
    v_cvt_pk_bf16_f32 v243, v250, v251
    v_cvt_pk_bf16_f32 v244, v252, v253
    v_cvt_pk_bf16_f32 v245, v254, v255
    ds_read_b128 v[36:39], v10 offset:208
    v_and_b32 v72, 15, v1
    v_add3_u32 v73, v72, s78, 16
    v_mov_b32 v74, 0xf149f2ca
    ds_read_b128 v[40:43], v10 offset:224
    v_cmp_gt_u32 vcc, 8, v73
    v_cmp_gt_u32 s[12:13], 16, v73
    v_mov_b32 v72, 0xffff
    v_cndmask_b32 v64, 0, v74, vcc
    v_cndmask_b32 v65, 0, v74, vcc
    v_cndmask_b32 v66, 0, v74, vcc
    v_cndmask_b32 v67, 0, v74, vcc
    v_cndmask_b32_e64 v68, 0, v74, s[12:13]
    v_cndmask_b32_e64 v69, 0, v74, s[12:13]
    v_cndmask_b32_e64 v70, 0, v74, s[12:13]
    v_cndmask_b32_e64 v71, 0, v74, s[12:13]
    buffer_load_dwordx4 a[196:199], v2, s[40:43], s66 offen offset:1024 sc1
    buffer_load_dwordx4 a[200:203], v2, s[40:43], s66 offen offset:2048 sc1
    buffer_load_dwordx4 a[204:207], v2, s[40:43], s66 offen offset:3072 sc1
    s_waitcnt lgkmcnt(5)
    v_pk_fma_f32 v[76:77], v[44:45], v[20:21], v[76:77] op_sel:[0,1,0]
    v_pk_fma_f32 v[78:79], v[46:47], v[20:21], v[78:79] op_sel:[0,1,0]
    v_pk_fma_f32 v[80:81], v[48:49], v[20:21], v[80:81] op_sel:[0,1,0]
    v_pk_fma_f32 v[82:83], v[50:51], v[20:21], v[82:83] op_sel:[0,1,0]
    v_pk_fma_f32 v[84:85], v[52:53], v[20:21], v[84:85] op_sel:[0,1,0]
    v_pk_fma_f32 v[86:87], v[54:55], v[20:21], v[86:87] op_sel:[0,1,0]
    v_pk_fma_f32 v[88:89], v[56:57], v[20:21], v[88:89] op_sel:[0,1,0]
    v_pk_fma_f32 v[90:91], v[58:59], v[20:21], v[90:91] op_sel:[0,1,0]
    v_pk_fma_f32 v[92:93], v[60:61], v[20:21], v[92:93] op_sel:[0,1,0]
    v_pk_fma_f32 v[94:95], v[62:63], v[20:21], v[94:95] op_sel:[0,1,0]
    v_pk_mul_f32 v[76:77], v[76:77], v[20:21] op_sel_hi:[1,0]
    v_pk_mul_f32 v[78:79], v[78:79], v[20:21] op_sel_hi:[1,0]
    v_pk_mul_f32 v[80:81], v[80:81], v[20:21] op_sel_hi:[1,0]
    v_pk_mul_f32 v[82:83], v[82:83], v[20:21] op_sel_hi:[1,0]
    v_pk_mul_f32 v[84:85], v[84:85], v[20:21] op_sel_hi:[1,0]
    v_pk_mul_f32 v[86:87], v[86:87], v[20:21] op_sel_hi:[1,0]
    v_pk_mul_f32 v[88:89], v[88:89], v[20:21] op_sel_hi:[1,0]
    v_pk_mul_f32 v[90:91], v[90:91], v[20:21] op_sel_hi:[1,0]
    v_pk_mul_f32 v[92:93], v[92:93], v[20:21] op_sel_hi:[1,0]
    v_pk_mul_f32 v[94:95], v[94:95], v[20:21] op_sel_hi:[1,0]
    v_cvt_pk_bf16_f32 v206, v76, v77
    v_cvt_pk_bf16_f32 v207, v78, v79
    v_cvt_pk_bf16_f32 v208, v80, v81
    v_cvt_pk_bf16_f32 v209, v82, v83
    v_cvt_pk_bf16_f32 v210, v84, v85
    v_cvt_pk_bf16_f32 v211, v86, v87
    v_cvt_pk_bf16_f32 v212, v88, v89
    v_cvt_pk_bf16_f32 v213, v90, v91
    v_cvt_pk_bf16_f32 v214, v92, v93
    v_cvt_pk_bf16_f32 v215, v94, v95
    v_pk_fma_f32 v[176:177], v[44:45], v[22:23], v[176:177] op_sel:[0,1,0]
    ds_write_b128 v26, v[206:209] offset:1280
    v_pk_fma_f32 v[178:179], v[46:47], v[22:23], v[178:179] op_sel:[0,1,0]
    s_add_u32 s66, s66, 4096
    buffer_load_dwordx4 a[208:211], v2, s[40:43], s66 offen offset:0 sc1
    buffer_load_dwordx4 a[212:215], v2, s[40:43], s66 offen offset:1024 sc1
    buffer_load_dwordx4 a[216:219], v2, s[40:43], s66 offen offset:2048 sc1
    v_pk_fma_f32 v[180:181], v[48:49], v[22:23], v[180:181] op_sel:[0,1,0]
    ds_write_b128 v26, v[210:213] offset:1296
    v_pk_fma_f32 v[182:183], v[50:51], v[22:23], v[182:183] op_sel:[0,1,0]
    v_pk_fma_f32 v[184:185], v[52:53], v[22:23], v[184:185] op_sel:[0,1,0]
    v_pk_fma_f32 v[186:187], v[54:55], v[22:23], v[186:187] op_sel:[0,1,0]
    v_pk_fma_f32 v[188:189], v[56:57], v[22:23], v[188:189] op_sel:[0,1,0]
    v_pk_fma_f32 v[190:191], v[58:59], v[22:23], v[190:191] op_sel:[0,1,0]
    ds_write_b64 v26, v[214:215] offset:1312
    v_pk_fma_f32 v[192:193], v[60:61], v[22:23], v[192:193] op_sel:[0,1,0]
    v_pk_fma_f32 v[194:195], v[62:63], v[22:23], v[194:195] op_sel:[0,1,0]
    v_pk_mul_f32 v[176:177], v[176:177], v[22:23] op_sel_hi:[1,0]
    v_pk_mul_f32 v[178:179], v[178:179], v[22:23] op_sel_hi:[1,0]
    v_pk_mul_f32 v[180:181], v[180:181], v[22:23] op_sel_hi:[1,0]
    v_pk_mul_f32 v[182:183], v[182:183], v[22:23] op_sel_hi:[1,0]
    v_pk_mul_f32 v[184:185], v[184:185], v[22:23] op_sel_hi:[1,0]
    v_pk_mul_f32 v[186:187], v[186:187], v[22:23] op_sel_hi:[1,0]
    v_pk_mul_f32 v[188:189], v[188:189], v[22:23] op_sel_hi:[1,0]
    v_pk_mul_f32 v[190:191], v[190:191], v[22:23] op_sel_hi:[1,0]
    v_pk_mul_f32 v[192:193], v[192:193], v[22:23] op_sel_hi:[1,0]
    v_pk_mul_f32 v[194:195], v[194:195], v[22:23] op_sel_hi:[1,0]
    v_cvt_pk_bf16_f32 v226, v176, v177
    v_cvt_pk_bf16_f32 v227, v178, v179
    s_xor_b32 s66, s82, 2
    s_mul_i32 s66, s66, 15360
    s_add_u32 s66, s66, s83
    buffer_load_dwordx4 a[220:223], v2, s[40:43], s66 offen offset:0 sc1
    buffer_load_dwordx4 a[224:227], v2, s[40:43], s66 offen offset:1024 sc1
    buffer_load_dwordx4 a[228:231], v2, s[40:43], s66 offen offset:2048 sc1
    v_cvt_pk_bf16_f32 v228, v180, v181
    v_cvt_pk_bf16_f32 v229, v182, v183
    v_cvt_pk_bf16_f32 v230, v184, v185
    v_cvt_pk_bf16_f32 v231, v186, v187
    v_cvt_pk_bf16_f32 v232, v188, v189
    v_cvt_pk_bf16_f32 v233, v190, v191
    v_cvt_pk_bf16_f32 v234, v192, v193
    v_cvt_pk_bf16_f32 v235, v194, v195
    v_pk_fma_f32 v[96:97], v[44:45], v[24:25], v[96:97] op_sel:[0,1,0]
    ds_write_b128 v26, v[226:229] offset:2560
    v_pk_fma_f32 v[98:99], v[46:47], v[24:25], v[98:99] op_sel:[0,1,0]
    v_pk_fma_f32 v[100:101], v[48:49], v[24:25], v[100:101] op_sel:[0,1,0]
    v_pk_fma_f32 v[102:103], v[50:51], v[24:25], v[102:103] op_sel:[0,1,0]
    v_pk_fma_f32 v[104:105], v[52:53], v[24:25], v[104:105] op_sel:[0,1,0]
    v_pk_fma_f32 v[106:107], v[54:55], v[24:25], v[106:107] op_sel:[0,1,0]
    ds_write_b128 v26, v[230:233] offset:2576
    v_pk_fma_f32 v[108:109], v[56:57], v[24:25], v[108:109] op_sel:[0,1,0]
    v_pk_fma_f32 v[110:111], v[58:59], v[24:25], v[110:111] op_sel:[0,1,0]
    v_pk_fma_f32 v[112:113], v[60:61], v[24:25], v[112:113] op_sel:[0,1,0]
    v_pk_fma_f32 v[114:115], v[62:63], v[24:25], v[114:115] op_sel:[0,1,0]
    buffer_load_dwordx4 a[232:235], v2, s[40:43], s66 offen offset:3072 sc1
    s_add_u32 s66, s66, 4096
    buffer_load_dwordx4 a[236:239], v2, s[40:43], s66 offen offset:0 sc1
    buffer_load_dwordx4 a[240:243], v2, s[40:43], s66 offen offset:1024 sc1
    v_pk_mul_f32 v[96:97], v[96:97], v[24:25] op_sel_hi:[1,0]
    ds_write_b64 v26, v[234:235] offset:2592
    v_pk_mul_f32 v[98:99], v[98:99], v[24:25] op_sel_hi:[1,0]
    v_pk_mul_f32 v[100:101], v[100:101], v[24:25] op_sel_hi:[1,0]
    v_pk_mul_f32 v[102:103], v[102:103], v[24:25] op_sel_hi:[1,0]
    v_pk_mul_f32 v[104:105], v[104:105], v[24:25] op_sel_hi:[1,0]
    v_pk_mul_f32 v[106:107], v[106:107], v[24:25] op_sel_hi:[1,0]
    v_pk_mul_f32 v[108:109], v[108:109], v[24:25] op_sel_hi:[1,0]
    v_pk_mul_f32 v[110:111], v[110:111], v[24:25] op_sel_hi:[1,0]
    v_pk_mul_f32 v[112:113], v[112:113], v[24:25] op_sel_hi:[1,0]
    v_pk_mul_f32 v[114:115], v[114:115], v[24:25] op_sel_hi:[1,0]
    v_cvt_pk_bf16_f32 v246, v96, v97
    v_cvt_pk_bf16_f32 v247, v98, v99
    v_cvt_pk_bf16_f32 v248, v100, v101
    v_cvt_pk_bf16_f32 v249, v102, v103
    v_cvt_pk_bf16_f32 v250, v104, v105
    v_cvt_pk_bf16_f32 v251, v106, v107
    v_cvt_pk_bf16_f32 v252, v108, v109
    v_cvt_pk_bf16_f32 v253, v110, v111
    v_cvt_pk_bf16_f32 v254, v112, v113
    v_cvt_pk_bf16_f32 v255, v114, v115
    s_waitcnt lgkmcnt(6)
    v_pk_fma_f32 v[116:117], v[12:13], v[20:21], v[116:117] op_sel:[0,1,0]
    ds_write_b128 v26, v[246:249] offset:3840
    v_pk_fma_f32 v[118:119], v[14:15], v[20:21], v[118:119] op_sel:[0,1,0]
    v_pk_fma_f32 v[120:121], v[16:17], v[20:21], v[120:121] op_sel:[0,1,0]
    buffer_load_dwordx4 a[244:247], v2, s[40:43], s66 offen offset:2048 sc1
    buffer_load_dwordx4 a[248:251], v2, s[40:43], s66 offen offset:3072 sc1
    s_add_u32 s66, s66, 4096
    buffer_load_dwordx4 a[252:255], v2, s[40:43], s66 offen offset:0 sc1
    v_pk_fma_f32 v[122:123], v[18:19], v[20:21], v[122:123] op_sel:[0,1,0]
    ds_write_b128 v26, v[250:253] offset:3856
    v_pk_fma_f32 v[124:125], v[32:33], v[20:21], v[124:125] op_sel:[0,1,0]
    v_pk_fma_f32 v[126:127], v[34:35], v[20:21], v[126:127] op_sel:[0,1,0]
    v_pk_fma_f32 v[128:129], v[36:37], v[20:21], v[128:129] op_sel:[0,1,0]
    v_pk_fma_f32 v[130:131], v[38:39], v[20:21], v[130:131] op_sel:[0,1,0]
    v_pk_fma_f32 v[132:133], v[40:41], v[20:21], v[132:133] op_sel:[0,1,0]
    ds_write_b64 v26, v[254:255] offset:3872
    v_pk_fma_f32 v[134:135], v[42:43], v[20:21], v[134:135] op_sel:[0,1,0]
    v_pk_mul_f32 v[116:117], v[116:117], v[20:21] op_sel_hi:[1,0]
    v_pk_mul_f32 v[118:119], v[118:119], v[20:21] op_sel_hi:[1,0]
    v_pk_mul_f32 v[120:121], v[120:121], v[20:21] op_sel_hi:[1,0]
    ds_read_b128 v[74:77], v26 offset:1920
    v_pk_mul_f32 v[122:123], v[122:123], v[20:21] op_sel_hi:[1,0]
    v_pk_mul_f32 v[124:125], v[124:125], v[20:21] op_sel_hi:[1,0]
    ds_read_b128 v[78:81], v26 offset:1936
    v_pk_mul_f32 v[126:127], v[126:127], v[20:21] op_sel_hi:[1,0]
    v_pk_mul_f32 v[128:129], v[128:129], v[20:21] op_sel_hi:[1,0]
    ds_read_b64 v[82:83], v26 offset:1952
    v_pk_mul_f32 v[130:131], v[130:131], v[20:21] op_sel_hi:[1,0]
    v_pk_mul_f32 v[132:133], v[132:133], v[20:21] op_sel_hi:[1,0]
    v_pk_mul_f32 v[134:135], v[134:135], v[20:21] op_sel_hi:[1,0]
    v_mul_f32 v20, 0x3ea52b5c, v20
    buffer_load_dwordx4 v[96:99], v2, s[40:43], s66 offen offset:1024 sc1
    buffer_load_dwordx4 v[100:103], v2, s[40:43], s66 offen offset:2048 sc1
    buffer_load_dwordx4 v[104:107], v2, s[40:43], s66 offen offset:3072 sc1
    v_cvt_pk_bf16_f32 v116, v116, v117
    v_cvt_pk_bf16_f32 v117, v118, v119
    v_cvt_pk_bf16_f32 v118, v120, v121
    v_cvt_pk_bf16_f32 v119, v122, v123
    v_cvt_pk_bf16_f32 v120, v124, v125
    v_cvt_pk_bf16_f32 v121, v126, v127
    v_cvt_pk_bf16_f32 v122, v128, v129
    v_cvt_pk_bf16_f32 v123, v130, v131
    v_cvt_pk_bf16_f32 v124, v132, v133
    v_cvt_pk_bf16_f32 v125, v134, v135
    v_pk_fma_f32 v[136:137], v[12:13], v[22:23], v[136:137] op_sel:[0,1,0]
    ds_write_b64 v26, v[116:117] offset:1320
    v_pk_fma_f32 v[138:139], v[14:15], v[22:23], v[138:139] op_sel:[0,1,0]
    v_pk_fma_f32 v[140:141], v[16:17], v[22:23], v[140:141] op_sel:[0,1,0]
    v_pk_fma_f32 v[142:143], v[18:19], v[22:23], v[142:143] op_sel:[0,1,0]
    v_pk_fma_f32 v[144:145], v[32:33], v[22:23], v[144:145] op_sel:[0,1,0]
    ds_write_b128 v26, v[118:121] offset:1328
    v_pk_fma_f32 v[146:147], v[34:35], v[22:23], v[146:147] op_sel:[0,1,0]
    v_pk_fma_f32 v[148:149], v[36:37], v[22:23], v[148:149] op_sel:[0,1,0]
    v_pk_fma_f32 v[150:151], v[38:39], v[22:23], v[150:151] op_sel:[0,1,0]
    v_pk_fma_f32 v[152:153], v[40:41], v[22:23], v[152:153] op_sel:[0,1,0]
    v_pk_fma_f32 v[154:155], v[42:43], v[22:23], v[154:155] op_sel:[0,1,0]
    ds_write_b128 v26, v[122:125] offset:1344
    v_pk_mul_f32 v[136:137], v[136:137], v[22:23] op_sel_hi:[1,0]
    s_add_u32 s66, s66, 4096
    buffer_load_dwordx4 v[108:111], v2, s[40:43], s66 offen offset:0 sc1
    buffer_load_dwordx4 v[112:115], v2, s[40:43], s66 offen offset:1024 sc1
    buffer_load_dwordx4 v[116:119], v2, s[40:43], s66 offen offset:2048 sc1
    v_pk_mul_f32 v[138:139], v[138:139], v[22:23] op_sel_hi:[1,0]
    v_pk_mul_f32 v[140:141], v[140:141], v[22:23] op_sel_hi:[1,0]
    v_pk_mul_f32 v[142:143], v[142:143], v[22:23] op_sel_hi:[1,0]
    v_pk_mul_f32 v[144:145], v[144:145], v[22:23] op_sel_hi:[1,0]
    v_pk_mul_f32 v[146:147], v[146:147], v[22:23] op_sel_hi:[1,0]
    v_pk_mul_f32 v[148:149], v[148:149], v[22:23] op_sel_hi:[1,0]
    v_pk_mul_f32 v[150:151], v[150:151], v[22:23] op_sel_hi:[1,0]
    v_pk_mul_f32 v[152:153], v[152:153], v[22:23] op_sel_hi:[1,0]
    v_pk_mul_f32 v[154:155], v[154:155], v[22:23] op_sel_hi:[1,0]
    v_mul_f32 v22, 0x3ea52b5c, v22
    v_cvt_pk_bf16_f32 v136, v136, v137
    v_cvt_pk_bf16_f32 v137, v138, v139
    v_cvt_pk_bf16_f32 v138, v140, v141
    v_cvt_pk_bf16_f32 v139, v142, v143
    v_cvt_pk_bf16_f32 v140, v144, v145
    v_cvt_pk_bf16_f32 v141, v146, v147
    v_cvt_pk_bf16_f32 v142, v148, v149
    v_cvt_pk_bf16_f32 v143, v150, v151
    v_cvt_pk_bf16_f32 v144, v152, v153
    v_cvt_pk_bf16_f32 v145, v154, v155
    s_waitcnt lgkmcnt(3)
    v_mfma_f32_4x4x4_16b_bf16 v[84:87], v[226:227], v[216:217], 0
    ds_write_b64 v26, v[136:137] offset:2600
    v_mfma_f32_4x4x4_16b_bf16 v[88:91], v[74:75], v[216:217], v[64:67]
    s_xor_b32 s66, s82, 3
    s_mul_i32 s66, s66, 15360
    s_add_u32 s66, s66, s83
    buffer_load_dwordx4 v[120:123], v2, s[40:43], s66 offen offset:0 sc1
    v_mfma_f32_4x4x4_16b_bf16 v[92:95], v[206:207], v[216:217], v[68:71]
    ds_write_b128 v26, v[138:141] offset:2608
    v_mfma_f32_4x4x4_16b_bf16 v[84:87], v[228:229], v[218:219], v[84:87]
    buffer_load_dwordx4 v[124:127], v2, s[40:43], s66 offen offset:1024 sc1
    v_mfma_f32_4x4x4_16b_bf16 v[88:91], v[76:77], v[218:219], v[88:91]
    buffer_load_dwordx4 v[128:131], v2, s[40:43], s66 offen offset:2048 sc1
    v_mfma_f32_4x4x4_16b_bf16 v[92:95], v[208:209], v[218:219], v[92:95]
    ds_write_b128 v26, v[142:145] offset:2624
    v_mfma_f32_4x4x4_16b_bf16 v[84:87], v[230:231], v[220:221], v[84:87]
    v_cndmask_b32_e64 v30, v72, -1, s[14:15]
    v_mfma_f32_4x4x4_16b_bf16 v[88:91], v[78:79], v[220:221], v[88:91]
    v_cndmask_b32_e64 v31, 0, v72, s[16:17]
    v_mfma_f32_4x4x4_16b_bf16 v[92:95], v[210:211], v[220:221], v[92:95]
    buffer_load_dwordx4 v[132:135], v2, s[40:43], s66 offen offset:3072 sc1
    v_mfma_f32_4x4x4_16b_bf16 v[84:87], v[232:233], v[222:223], v[84:87]
    v_cndmask_b32_e64 v31, v31, -1, s[18:19]
    v_mfma_f32_4x4x4_16b_bf16 v[88:91], v[80:81], v[222:223], v[88:91]
    v_bfe_u32 v9, v1, 3, 1
    v_mfma_f32_4x4x4_16b_bf16 v[92:95], v[212:213], v[222:223], v[92:95]
    v_mul_u32_u24 v7, 34816, v9
    v_mfma_f32_4x4x4_16b_bf16 v[84:87], v[234:235], v[224:225], v[84:87]
    v_lshrrev_b32 v9, 4, v1
    v_mfma_f32_4x4x4_16b_bf16 v[88:91], v[82:83], v[224:225], v[88:91]
    v_lshl_add_u32 v7, v9, 7, v7
    v_mfma_f32_4x4x4_16b_bf16 v[92:95], v[214:215], v[224:225], v[92:95]
    v_and_b32 v9, 7, v1
    v_pk_fma_f32 v[156:157], v[12:13], v[24:25], v[156:157] op_sel:[0,1,0]
    ds_read_b64_tr_b16 v[62:63], v11 offset:1992
    v_pk_fma_f32 v[158:159], v[14:15], v[24:25], v[158:159] op_sel:[0,1,0]
    ds_read_b64_tr_b16 v[54:55], v11 offset:1960
    v_pk_fma_f32 v[160:161], v[16:17], v[24:25], v[160:161] op_sel:[0,1,0]
    ds_read_b64_tr_b16 v[56:57], v11 offset:1968
    v_pk_fma_f32 v[162:163], v[18:19], v[24:25], v[162:163] op_sel:[0,1,0]
    ds_read_b64_tr_b16 v[58:59], v11 offset:1976
    v_pk_fma_f32 v[164:165], v[32:33], v[24:25], v[164:165] op_sel:[0,1,0]
    ds_read_b64_tr_b16 v[60:61], v11 offset:1984
    v_pk_fma_f32 v[166:167], v[34:35], v[24:25], v[166:167] op_sel:[0,1,0]
    ds_read_b64_tr_b16 v[52:53], v11 offset:2632
    v_pk_fma_f32 v[168:169], v[36:37], v[24:25], v[168:169] op_sel:[0,1,0]
    ds_read_b64_tr_b16 v[44:45], v11 offset:2600
    v_pk_fma_f32 v[170:171], v[38:39], v[24:25], v[170:171] op_sel:[0,1,0]
    ds_read_b64_tr_b16 v[46:47], v11 offset:2608
    v_pk_fma_f32 v[172:173], v[40:41], v[24:25], v[172:173] op_sel:[0,1,0]
    ds_read_b64_tr_b16 v[48:49], v11 offset:2616
    v_pk_fma_f32 v[174:175], v[42:43], v[24:25], v[174:175] op_sel:[0,1,0]
    ds_read_b64_tr_b16 v[50:51], v11 offset:2624
    v_pk_mul_f32 v[156:157], v[156:157], v[24:25] op_sel_hi:[1,0]
    ds_read_b64_tr_b16 v[72:73], v11 offset:1352
    v_pk_mul_f32 v[158:159], v[158:159], v[24:25] op_sel_hi:[1,0]
    ds_read_b64_tr_b16 v[64:65], v11 offset:1320
    v_pk_mul_f32 v[160:161], v[160:161], v[24:25] op_sel_hi:[1,0]
    ds_read_b64_tr_b16 v[66:67], v11 offset:1328
    v_pk_mul_f32 v[162:163], v[162:163], v[24:25] op_sel_hi:[1,0]
    ds_read_b64_tr_b16 v[68:69], v11 offset:1336
    v_pk_mul_f32 v[164:165], v[164:165], v[24:25] op_sel_hi:[1,0]
    ds_read_b64_tr_b16 v[70:71], v11 offset:1344
    v_pk_mul_f32 v[166:167], v[166:167], v[24:25] op_sel_hi:[1,0]
    s_add_u32 s66, s66, 4096
    buffer_load_dwordx4 v[136:139], v2, s[40:43], s66 offen offset:0 sc1
    buffer_load_dwordx4 v[140:143], v2, s[40:43], s66 offen offset:1024 sc1
    buffer_load_dwordx4 v[144:147], v2, s[40:43], s66 offen offset:2048 sc1
    v_pk_mul_f32 v[168:169], v[168:169], v[24:25] op_sel_hi:[1,0]
    v_pk_mul_f32 v[170:171], v[170:171], v[24:25] op_sel_hi:[1,0]
    v_pk_mul_f32 v[172:173], v[172:173], v[24:25] op_sel_hi:[1,0]
    v_pk_mul_f32 v[174:175], v[174:175], v[24:25] op_sel_hi:[1,0]
    v_mul_f32 v24, 0x3ea52b5c, v24
    v_cvt_pk_bf16_f32 v156, v156, v157
    v_cvt_pk_bf16_f32 v157, v158, v159
    v_cvt_pk_bf16_f32 v158, v160, v161
    v_cvt_pk_bf16_f32 v159, v162, v163
    v_cvt_pk_bf16_f32 v160, v164, v165
    v_cvt_pk_bf16_f32 v161, v166, v167
    v_cvt_pk_bf16_f32 v162, v168, v169
    v_cvt_pk_bf16_f32 v163, v170, v171
    v_cvt_pk_bf16_f32 v164, v172, v173
    v_cvt_pk_bf16_f32 v165, v174, v175
    v_cndmask_b32_e64 v85, v93, v85, s[14:15]
    ds_write_b64 v26, v[156:157] offset:3880
    v_cndmask_b32_e64 v86, v94, v86, s[16:17]
    v_cndmask_b32_e64 v87, v95, v87, s[18:19]
    v_max3_f32 v28, v84, v88, v89
    v_max3_f32 v28, v28, v90, v91
    ds_write_b128 v26, v[158:161] offset:3888
    v_max3_f32 v28, v28, v85, v86
    buffer_load_dwordx4 v[148:151], v2, s[40:43], s66 offen offset:3072 sc1
    s_add_u32 s66, s66, 4096
    buffer_load_dwordx4 v[152:155], v2, s[40:43], s66 offen offset:0 sc1
    v_max_f32 v28, v28, v87
    ds_write_b128 v26, v[162:165] offset:3904
    v_mul_f32_e64 v28, -v28, v22
    v_pk_fma_f32 v[84:85], v[84:85], v[22:23], v[28:29] op_sel_hi:[1,0,0]
    v_pk_fma_f32 v[86:87], v[86:87], v[22:23], v[28:29] op_sel_hi:[1,0,0]
    v_pk_fma_f32 v[88:89], v[88:89], v[22:23], v[28:29] op_sel_hi:[1,0,0]
    v_pk_fma_f32 v[90:91], v[90:91], v[22:23], v[28:29] op_sel_hi:[1,0,0]
    ds_read_b128 v[74:77], v26 offset:3200
    v_exp_f32 v84, v84
    ds_read_b128 v[78:81], v26 offset:3216
    v_exp_f32 v85, v85
    ds_read_b64 v[82:83], v26 offset:3232
    v_exp_f32 v86, v86
    buffer_load_dwordx4 v[156:159], v2, s[40:43], s66 offen offset:1024 sc1
    buffer_load_dwordx4 v[160:163], v2, s[40:43], s66 offen offset:2048 sc1
    buffer_load_dwordx4 v[164:167], v2, s[40:43], s66 offen offset:3072 sc1
    v_exp_f32 v87, v87
    v_exp_f32 v88, v88
    v_exp_f32 v89, v89
    v_exp_f32 v90, v90
    v_exp_f32 v91, v91
    v_pk_add_f32 v[28:29], v[84:85], v[86:87]
    v_pk_add_f32 v[28:29], v[28:29], v[88:89]
    v_pk_add_f32 v[28:29], v[28:29], v[90:91]
    v_add_f32 v28, v28, v29
    v_rcp_f32 v28, v28
    v_lshl_add_u32 v7, v9, 4, v7
    v_pk_mul_f32 v[84:85], v[84:85], v[28:29] op_sel_hi:[1,0]
    v_pk_mul_f32 v[86:87], v[86:87], v[28:29] op_sel_hi:[1,0]
    v_pk_mul_f32 v[88:89], v[88:89], v[28:29] op_sel_hi:[1,0]
    v_pk_mul_f32 v[90:91], v[90:91], v[28:29] op_sel_hi:[1,0]
    v_cvt_pk_bf16_f32 v34, v88, v89
    v_cvt_pk_bf16_f32 v35, v90, v91
    v_cvt_pk_bf16_f32 v36, v84, v85
    v_cvt_pk_bf16_f32 v37, v86, v87
    s_waitcnt lgkmcnt(6)
    v_mfma_f32_4x4x4_16b_bf16 v[12:15], v[62:63], v[34:35], 0
    v_and_b32 v32, v30, v36
    v_mfma_f32_4x4x4_16b_bf16 v[180:183], v[54:55], v[34:35], 0
    v_and_b32 v33, v31, v37
    v_mfma_f32_4x4x4_16b_bf16 v[184:187], v[56:57], v[34:35], 0
    v_xor_b32 v36, v32, v36
    v_mfma_f32_4x4x4_16b_bf16 v[188:191], v[58:59], v[34:35], 0
    v_xor_b32 v37, v33, v37
    v_mfma_f32_4x4x4_16b_bf16 v[192:195], v[60:61], v[34:35], 0
    s_add_u32 s66, s66, 4096
    buffer_load_dwordx4 v[168:171], v2, s[40:43], s66 offen offset:0 sc1
    v_mfma_f32_4x4x4_16b_bf16 v[12:15], v[52:53], v[32:33], v[12:15]
    buffer_load_dwordx4 v[172:175], v2, s[40:43], s66 offen offset:1024 sc1
    v_mfma_f32_4x4x4_16b_bf16 v[180:183], v[44:45], v[32:33], v[180:183]
    buffer_load_dwordx4 v[176:179], v2, s[40:43], s66 offen offset:2048 sc1
    v_mfma_f32_4x4x4_16b_bf16 v[184:187], v[46:47], v[32:33], v[184:187]
    v_add_u32 v4, s48, v7
    v_mfma_f32_4x4x4_16b_bf16 v[188:191], v[48:49], v[32:33], v[188:191]
    v_lshrrev_b32 v9, 5, v1
    v_mfma_f32_4x4x4_16b_bf16 v[192:195], v[50:51], v[32:33], v[192:195]
    v_lshl_add_u32 v27, v9, 30, v4
    v_mfma_f32_4x4x4_16b_bf16 v[12:15], v[72:73], v[36:37], v[12:15]
    v_add_u32 v27, s79, v27
    v_mfma_f32_4x4x4_16b_bf16 v[180:183], v[64:65], v[36:37], v[180:183]
    v_lshrrev_b32 v9, 5, v1
    v_mfma_f32_4x4x4_16b_bf16 v[184:187], v[66:67], v[36:37], v[184:187]
    v_mul_u32_u24 v9, 63, v9
    v_mfma_f32_4x4x4_16b_bf16 v[188:191], v[68:69], v[36:37], v[188:191]
    v_lshl_add_u32 v9, s60, 6, v9
    v_mfma_f32_4x4x4_16b_bf16 v[192:195], v[70:71], v[36:37], v[192:195]
    v_mul_u32_u24 v9, 6637, v9
    s_waitcnt lgkmcnt(0)
    s_barrier
    v_mfma_f32_4x4x4_16b_bf16 v[84:87], v[246:247], v[236:237], 0
    ds_read_b64_tr_b16 v[62:63], v11 offset:3272
    v_mfma_f32_4x4x4_16b_bf16 v[88:91], v[74:75], v[236:237], 0
    ds_read_b64_tr_b16 v[54:55], v11 offset:3240
    v_mfma_f32_4x4x4_16b_bf16 v[92:95], v[226:227], v[236:237], 0
    ds_read_b64_tr_b16 v[56:57], v11 offset:3248
    v_mfma_f32_4x4x4_16b_bf16 v[84:87], v[248:249], v[238:239], v[84:87]
    ds_read_b64_tr_b16 v[58:59], v11 offset:3256
    v_mfma_f32_4x4x4_16b_bf16 v[88:91], v[76:77], v[238:239], v[88:91]
    ds_read_b64_tr_b16 v[60:61], v11 offset:3264
    v_mfma_f32_4x4x4_16b_bf16 v[92:95], v[228:229], v[238:239], v[92:95]
    ds_read_b64_tr_b16 v[52:53], v11 offset:3912
    v_mfma_f32_4x4x4_16b_bf16 v[84:87], v[250:251], v[240:241], v[84:87]
    ds_read_b64_tr_b16 v[44:45], v11 offset:3880
    v_mfma_f32_4x4x4_16b_bf16 v[88:91], v[78:79], v[240:241], v[88:91]
    ds_read_b64_tr_b16 v[46:47], v11 offset:3888
    v_mfma_f32_4x4x4_16b_bf16 v[92:95], v[230:231], v[240:241], v[92:95]
    ds_read_b64_tr_b16 v[48:49], v11 offset:3896
    v_mfma_f32_4x4x4_16b_bf16 v[84:87], v[252:253], v[242:243], v[84:87]
    ds_read_b64_tr_b16 v[50:51], v11 offset:3904
    v_mfma_f32_4x4x4_16b_bf16 v[88:91], v[80:81], v[242:243], v[88:91]
    ds_read_b64_tr_b16 v[72:73], v11 offset:2632
    v_mfma_f32_4x4x4_16b_bf16 v[92:95], v[232:233], v[242:243], v[92:95]
    ds_read_b64_tr_b16 v[64:65], v11 offset:2600
    v_mfma_f32_4x4x4_16b_bf16 v[84:87], v[254:255], v[244:245], v[84:87]
    ds_read_b64_tr_b16 v[66:67], v11 offset:2608
    v_mfma_f32_4x4x4_16b_bf16 v[88:91], v[82:83], v[244:245], v[88:91]
    ds_read_b64_tr_b16 v[68:69], v11 offset:2616
    v_mfma_f32_4x4x4_16b_bf16 v[92:95], v[234:235], v[244:245], v[92:95]
    ds_read_b64_tr_b16 v[70:71], v11 offset:2624
    v_lshrrev_b32 v9, 20, v9
    v_and_b32 v8, 15, v1
    v_min_u32 v8, 2, v8
    v_mad_u32_u24 v9, v9, 12, v8
    v_lshl_add_u32 v8, v9, 7, s23
    buffer_load_dword v9, v8, s[40:43], 0 offen sc1
    v_cvt_pk_bf16_f32 v40, v12, v13
    v_cvt_pk_bf16_f32 v41, v14, v15
    v_cvt_pk_bf16_f32 v32, v180, v181
    v_cvt_pk_bf16_f32 v33, v182, v183
    v_cvt_pk_bf16_f32 v34, v184, v185
    v_cvt_pk_bf16_f32 v35, v186, v187
    buffer_store_dwordx4 v[32:35], v4, s[36:39], s21 offen sc1
    v_permlane32_swap_b32 v40, v42
    v_permlane32_swap_b32 v41, v43
    v_cvt_pk_bf16_f32 v36, v188, v189
    v_cvt_pk_bf16_f32 v37, v190, v191
    v_cvt_pk_bf16_f32 v38, v192, v193
    v_cvt_pk_bf16_f32 v39, v194, v195
    buffer_store_dwordx4 v[40:43], v27, s[36:39], s21 offen sc1
    buffer_store_dwordx4 v[36:39], v4, s[36:39], s21 offen offset:512 sc1
    v_cndmask_b32_e64 v85, v93, v85, s[14:15]
    ds_read_b128 v[74:77], v26 offset:640
    v_cndmask_b32_e64 v86, v94, v86, s[16:17]
    v_cndmask_b32_e64 v87, v95, v87, s[18:19]
    ds_read_b128 v[78:81], v26 offset:656
    v_max3_f32 v28, v84, v88, v89
    v_max3_f32 v28, v28, v90, v91
    ds_read_b64 v[82:83], v26 offset:672
    v_max3_f32 v28, v28, v85, v86
    v_max_f32 v28, v28, v87
    ds_read_b128 v[216:219], v26 offset:0
Q_PG5:
    s_cbranch_execz Q_TRET
    v_mul_f32_e64 v28, -v28, v24
    v_pk_fma_f32 v[84:85], v[84:85], v[24:25], v[28:29] op_sel_hi:[1,0,0]
    ds_read_b128 v[220:223], v26 offset:16
    v_pk_fma_f32 v[86:87], v[86:87], v[24:25], v[28:29] op_sel_hi:[1,0,0]
    v_pk_fma_f32 v[88:89], v[88:89], v[24:25], v[28:29] op_sel_hi:[1,0,0]
    ds_read_b64 v[224:225], v26 offset:32
    v_pk_fma_f32 v[90:91], v[90:91], v[24:25], v[28:29] op_sel_hi:[1,0,0]
    v_exp_f32 v84, v84
    v_exp_f32 v85, v85
    v_exp_f32 v86, v86
    v_exp_f32 v87, v87
    v_exp_f32 v88, v88
    v_exp_f32 v89, v89
    v_exp_f32 v90, v90
    v_exp_f32 v91, v91
    v_pk_add_f32 v[28:29], v[84:85], v[86:87]
    v_pk_add_f32 v[28:29], v[28:29], v[88:89]
    v_pk_add_f32 v[28:29], v[28:29], v[90:91]
    v_add_f32 v28, v28, v29
    v_rcp_f32 v28, v28
    v_add_u32 v5, s49, v7
    v_pk_mul_f32 v[84:85], v[84:85], v[28:29] op_sel_hi:[1,0]
    v_pk_mul_f32 v[86:87], v[86:87], v[28:29] op_sel_hi:[1,0]
    v_pk_mul_f32 v[88:89], v[88:89], v[28:29] op_sel_hi:[1,0]
    v_pk_mul_f32 v[90:91], v[90:91], v[28:29] op_sel_hi:[1,0]
    v_cvt_pk_bf16_f32 v34, v88, v89
    v_cvt_pk_bf16_f32 v35, v90, v91
    v_cvt_pk_bf16_f32 v36, v84, v85
    v_cvt_pk_bf16_f32 v37, v86, v87
    s_waitcnt lgkmcnt(6)
    v_mfma_f32_4x4x4_16b_bf16 v[12:15], v[62:63], v[34:35], 0
    v_and_b32 v32, v30, v36
    v_mfma_f32_4x4x4_16b_bf16 v[180:183], v[54:55], v[34:35], 0
    v_and_b32 v33, v31, v37
    v_mfma_f32_4x4x4_16b_bf16 v[184:187], v[56:57], v[34:35], 0
    v_xor_b32 v36, v32, v36
    v_mfma_f32_4x4x4_16b_bf16 v[188:191], v[58:59], v[34:35], 0
    v_xor_b32 v37, v33, v37
    v_mfma_f32_4x4x4_16b_bf16 v[192:195], v[60:61], v[34:35], 0
    v_add_u32 v6, s50, v7
    v_mfma_f32_4x4x4_16b_bf16 v[12:15], v[52:53], v[32:33], v[12:15]
    v_add_u32 v7, s51, v7
    v_mfma_f32_4x4x4_16b_bf16 v[180:183], v[44:45], v[32:33], v[180:183]
    v_mfma_f32_4x4x4_16b_bf16 v[184:187], v[46:47], v[32:33], v[184:187]
    v_mfma_f32_4x4x4_16b_bf16 v[188:191], v[48:49], v[32:33], v[188:191]
    v_mfma_f32_4x4x4_16b_bf16 v[192:195], v[50:51], v[32:33], v[192:195]
    v_mfma_f32_4x4x4_16b_bf16 v[12:15], v[72:73], v[36:37], v[12:15]
    v_mfma_f32_4x4x4_16b_bf16 v[180:183], v[64:65], v[36:37], v[180:183]
    v_mfma_f32_4x4x4_16b_bf16 v[184:187], v[66:67], v[36:37], v[184:187]
    v_mfma_f32_4x4x4_16b_bf16 v[188:191], v[68:69], v[36:37], v[188:191]
    v_mfma_f32_4x4x4_16b_bf16 v[192:195], v[70:71], v[36:37], v[192:195]
    s_waitcnt lgkmcnt(0)
    v_mfma_f32_4x4x4_16b_bf16 v[84:87], v[206:207], v[196:197], 0
    ds_read_b64_tr_b16 v[62:63], v11 offset:712
    v_mfma_f32_4x4x4_16b_bf16 v[88:91], v[74:75], v[196:197], 0
    ds_read_b64_tr_b16 v[54:55], v11 offset:680
    v_mfma_f32_4x4x4_16b_bf16 v[92:95], v[216:217], v[196:197], 0
    ds_read_b64_tr_b16 v[56:57], v11 offset:688
    v_mfma_f32_4x4x4_16b_bf16 v[84:87], v[208:209], v[198:199], v[84:87]
    ds_read_b64_tr_b16 v[58:59], v11 offset:696
    v_mfma_f32_4x4x4_16b_bf16 v[88:91], v[76:77], v[198:199], v[88:91]
    ds_read_b64_tr_b16 v[60:61], v11 offset:704
    v_mfma_f32_4x4x4_16b_bf16 v[92:95], v[218:219], v[198:199], v[92:95]
    ds_read_b64_tr_b16 v[52:53], v11 offset:1352
    v_mfma_f32_4x4x4_16b_bf16 v[84:87], v[210:211], v[200:201], v[84:87]
    ds_read_b64_tr_b16 v[44:45], v11 offset:1320
    v_mfma_f32_4x4x4_16b_bf16 v[88:91], v[78:79], v[200:201], v[88:91]
    ds_read_b64_tr_b16 v[46:47], v11 offset:1328
    v_mfma_f32_4x4x4_16b_bf16 v[92:95], v[220:221], v[200:201], v[92:95]
    ds_read_b64_tr_b16 v[48:49], v11 offset:1336
    v_mfma_f32_4x4x4_16b_bf16 v[84:87], v[212:213], v[202:203], v[84:87]
    ds_read_b64_tr_b16 v[50:51], v11 offset:1344
    v_mfma_f32_4x4x4_16b_bf16 v[88:91], v[80:81], v[202:203], v[88:91]
    ds_read_b64_tr_b16 v[72:73], v11 offset:72
    v_mfma_f32_4x4x4_16b_bf16 v[92:95], v[222:223], v[202:203], v[92:95]
    ds_read_b64_tr_b16 v[64:65], v11 offset:40
    v_mfma_f32_4x4x4_16b_bf16 v[84:87], v[214:215], v[204:205], v[84:87]
    ds_read_b64_tr_b16 v[66:67], v11 offset:48
    v_mfma_f32_4x4x4_16b_bf16 v[88:91], v[82:83], v[204:205], v[88:91]
    ds_read_b64_tr_b16 v[68:69], v11 offset:56
    v_mfma_f32_4x4x4_16b_bf16 v[92:95], v[224:225], v[204:205], v[92:95]
    ds_read_b64_tr_b16 v[70:71], v11 offset:64
    s_waitcnt vmcnt(3)
    v_cmp_eq_u32 vcc, 0, v9
    s_cbranch_vccnz Q_A1
    buffer_load_dwordx4 v[208:211], v4, s[36:39], s4 offen offset:0 sc1
    buffer_load_dwordx4 v[212:215], v4, s[36:39], s4 offen offset:512 sc1
    buffer_load_dwordx4 v[216:219], v4, s[36:39], s4 offen offset:1024 sc1
    buffer_load_dwordx4 v[220:223], v5, s[36:39], s4 offen offset:0 sc1
    buffer_load_dwordx4 v[224:227], v5, s[36:39], s4 offen offset:512 sc1
    buffer_load_dwordx4 v[228:231], v5, s[36:39], s4 offen offset:1024 sc1
    buffer_load_dwordx4 v[232:235], v6, s[36:39], s4 offen offset:0 sc1
    buffer_load_dwordx4 v[236:239], v6, s[36:39], s4 offen offset:512 sc1
Q_A1:
    buffer_load_dword v75, v8, s[40:43], 0 offen sc1
    v_mov_b32 v43, v27
    v_cvt_pk_bf16_f32 v204, v12, v13
    v_cvt_pk_bf16_f32 v205, v14, v15
    v_cvt_pk_bf16_f32 v196, v180, v181
    v_cvt_pk_bf16_f32 v197, v182, v183
    v_cvt_pk_bf16_f32 v198, v184, v185
    v_cvt_pk_bf16_f32 v199, v186, v187
    v_permlane32_swap_b32 v204, v206
    v_permlane32_swap_b32 v205, v207
    v_cvt_pk_bf16_f32 v200, v188, v189
    v_cvt_pk_bf16_f32 v201, v190, v191
    v_cvt_pk_bf16_f32 v202, v192, v193
    v_cvt_pk_bf16_f32 v203, v194, v195
    v_cndmask_b32_e64 v85, v93, v85, s[14:15]
    v_cndmask_b32_e64 v86, v94, v86, s[16:17]
    v_cndmask_b32_e64 v87, v95, v87, s[18:19]
    v_max3_f32 v28, v84, v88, v89
    v_max3_f32 v28, v28, v90, v91
    v_max3_f32 v28, v28, v85, v86
    v_max_f32 v28, v28, v87
    v_mul_f32_e64 v28, -v28, v20
    v_pk_fma_f32 v[84:85], v[84:85], v[20:21], v[28:29] op_sel_hi:[1,0,0]
    v_pk_fma_f32 v[86:87], v[86:87], v[20:21], v[28:29] op_sel_hi:[1,0,0]
    v_pk_fma_f32 v[88:89], v[88:89], v[20:21], v[28:29] op_sel_hi:[1,0,0]
    v_pk_fma_f32 v[90:91], v[90:91], v[20:21], v[28:29] op_sel_hi:[1,0,0]
    v_exp_f32 v84, v84
    v_exp_f32 v85, v85
    v_exp_f32 v86, v86
    v_exp_f32 v87, v87
    v_exp_f32 v88, v88
    v_exp_f32 v89, v89
    v_exp_f32 v90, v90
    v_exp_f32 v91, v91
    v_pk_add_f32 v[28:29], v[84:85], v[86:87]
    v_pk_add_f32 v[28:29], v[28:29], v[88:89]
    v_pk_add_f32 v[28:29], v[28:29], v[90:91]
    v_add_f32 v28, v28, v29
    v_rcp_f32 v28, v28
    s_nop 0
    v_pk_mul_f32 v[84:85], v[84:85], v[28:29] op_sel_hi:[1,0]
    v_pk_mul_f32 v[86:87], v[86:87], v[28:29] op_sel_hi:[1,0]
    v_pk_mul_f32 v[88:89], v[88:89], v[28:29] op_sel_hi:[1,0]
    v_pk_mul_f32 v[90:91], v[90:91], v[28:29] op_sel_hi:[1,0]
    v_cvt_pk_bf16_f32 v34, v88, v89
    v_cvt_pk_bf16_f32 v35, v90, v91
    v_cvt_pk_bf16_f32 v36, v84, v85
    v_cvt_pk_bf16_f32 v37, v86, v87
    s_cbranch_vccz Q_A2
    s_waitcnt vmcnt(0)
    v_cmp_eq_u32 vcc, 0, v75
    s_cbranch_vccnz Q_A2
    buffer_load_dwordx4 v[208:211], v4, s[36:39], s4 offen offset:0 sc1
    buffer_load_dwordx4 v[212:215], v4, s[36:39], s4 offen offset:512 sc1
    buffer_load_dwordx4 v[216:219], v4, s[36:39], s4 offen offset:1024 sc1
    buffer_load_dwordx4 v[220:223], v5, s[36:39], s4 offen offset:0 sc1
    buffer_load_dwordx4 v[224:227], v5, s[36:39], s4 offen offset:512 sc1
    buffer_load_dwordx4 v[228:231], v5, s[36:39], s4 offen offset:1024 sc1
    buffer_load_dwordx4 v[232:235], v6, s[36:39], s4 offen offset:0 sc1
    buffer_load_dwordx4 v[236:239], v6, s[36:39], s4 offen offset:512 sc1
Q_A2:
    s_cmp_eq_u64 vcc, 0
    s_cselect_b32 s34, s38, 0
    s_waitcnt lgkmcnt(0)
    v_mfma_f32_4x4x4_16b_bf16 v[12:15], v[62:63], v[34:35], 0
    v_and_b32 v32, v30, v36
    v_mfma_f32_4x4x4_16b_bf16 v[180:183], v[54:55], v[34:35], 0
    v_and_b32 v33, v31, v37
    v_mfma_f32_4x4x4_16b_bf16 v[184:187], v[56:57], v[34:35], 0
    v_xor_b32 v36, v32, v36
    v_mfma_f32_4x4x4_16b_bf16 v[188:191], v[58:59], v[34:35], 0
    v_xor_b32 v37, v33, v37
    v_mfma_f32_4x4x4_16b_bf16 v[192:195], v[60:61], v[34:35], 0
    v_mfma_f32_4x4x4_16b_bf16 v[12:15], v[52:53], v[32:33], v[12:15]
    v_mfma_f32_4x4x4_16b_bf16 v[180:183], v[44:45], v[32:33], v[180:183]
    buffer_load_dwordx4 v[240:243], v6, s[32:35], s4 offen offset:1024 sc1
    v_mfma_f32_4x4x4_16b_bf16 v[184:187], v[46:47], v[32:33], v[184:187]
    v_mfma_f32_4x4x4_16b_bf16 v[188:191], v[48:49], v[32:33], v[188:191]
    v_mfma_f32_4x4x4_16b_bf16 v[192:195], v[50:51], v[32:33], v[192:195]
    buffer_load_dwordx4 v[244:247], v7, s[32:35], s4 offen offset:0 sc1
    v_mfma_f32_4x4x4_16b_bf16 v[12:15], v[72:73], v[36:37], v[12:15]
    v_mfma_f32_4x4x4_16b_bf16 v[180:183], v[64:65], v[36:37], v[180:183]
    v_mfma_f32_4x4x4_16b_bf16 v[184:187], v[66:67], v[36:37], v[184:187]
    buffer_load_dwordx4 v[248:251], v7, s[32:35], s4 offen offset:512 sc1
    v_mfma_f32_4x4x4_16b_bf16 v[188:191], v[68:69], v[36:37], v[188:191]
    v_mfma_f32_4x4x4_16b_bf16 v[192:195], v[70:71], v[36:37], v[192:195]
    buffer_load_dwordx4 v[252:255], v7, s[32:35], s4 offen offset:1024 sc1
    v_cvt_pk_bf16_f32 v52, v12, v13
    v_cvt_pk_bf16_f32 v53, v14, v15
    v_cvt_pk_bf16_f32 v44, v180, v181
    v_cvt_pk_bf16_f32 v45, v182, v183
    v_cvt_pk_bf16_f32 v46, v184, v185
    v_cvt_pk_bf16_f32 v47, v186, v187
    buffer_load_dword v74, v8, s[40:43], 0 offen sc1
    v_permlane32_swap_b32 v52, v54
    v_permlane32_swap_b32 v53, v55
    v_cvt_pk_bf16_f32 v48, v188, v189
    v_cvt_pk_bf16_f32 v49, v190, v191
    v_cvt_pk_bf16_f32 v50, v192, v193
    v_cvt_pk_bf16_f32 v51, v194, v195
    buffer_store_dwordx4 v[196:199], v4, s[36:39], s22 offen sc1
    buffer_store_dwordx4 v[204:207], v43, s[36:39], s22 offen sc1
    buffer_store_dwordx4 v[200:203], v4, s[36:39], s22 offen offset:512 sc1
    buffer_store_dwordx4 v[44:47], v4, s[36:39], s20 offen sc1
    buffer_store_dwordx4 v[52:55], v43, s[36:39], s20 offen sc1
    buffer_store_dwordx4 v[48:51], v4, s[36:39], s20 offen offset:512 sc1
Q_P2:
    v_mov_b32 v15, 1
    s_cbranch_vccnz Q_SLOW
Q_FAST:
    s_waitcnt vmcnt(18)
    v_mfma_f32_16x16x32_bf16 v[16:19], a[100:103], v[208:211], 0
    v_lshlrev_b32 v36, 2, v1
    s_add_u32 s71, s3, 1
    v_mfma_f32_16x16x32_bf16 v[20:23], a[104:107], v[208:211], 0
    s_and_b32 s71, s71, 3
    s_mul_i32 s72, s71, 15360
    v_mfma_f32_16x16x32_bf16 v[24:27], a[108:111], v[208:211], 0
    v_add_u32 v8, s72, v36
    s_add_u32 s71, s3, 2
    v_mfma_f32_16x16x32_bf16 v[28:31], a[112:115], v[208:211], 0
    s_and_b32 s71, s71, 3
    s_mul_i32 s72, s71, 15360
    v_mfma_f32_16x16x32_bf16 v[32:35], a[116:119], v[208:211], 0
    s_waitcnt vmcnt(17)
    v_add_u32 v9, s72, v36
    s_add_u32 s71, s3, 3
    v_mfma_f32_16x16x32_bf16 v[16:19], a[120:123], v[212:215], v[16:19]
    s_and_b32 s71, s71, 3
    s_mul_i32 s72, s71, 15360
    v_mfma_f32_16x16x32_bf16 v[20:23], a[124:127], v[212:215], v[20:23]
    v_add_u32 v10, s72, v36
    s_add_u32 s71, s3, 4
    v_mfma_f32_16x16x32_bf16 v[24:27], a[128:131], v[212:215], v[24:27]
    s_and_b32 s71, s71, 3
    s_mul_i32 s72, s71, 15360
    v_mfma_f32_16x16x32_bf16 v[28:31], a[132:135], v[212:215], v[28:31]
    v_add_u32 v11, s72, v36
    s_lshl2_add_u32 s71, s60, s71
    v_mfma_f32_16x16x32_bf16 v[32:35], a[136:139], v[212:215], v[32:35]
    s_waitcnt vmcnt(15)
    v_and_b32 v36, 15, v1
    v_lshl_add_u32 v36, s71, 4, v36
    v_mfma_f32_16x16x32_bf16 v[16:19], a[140:143], v[216:219], v[16:19]
    v_bfe_u32 v37, v36, 2, 1
    v_and_or_b32 v37, v36, -8, v37
    v_mfma_f32_16x16x32_bf16 v[16:19], a[160:163], v[220:223], v[16:19]
    v_and_b32 v13, 3, v36
    v_lshl_add_u32 v13, v13, 1, v37
    v_mfma_f32_16x16x32_bf16 v[20:23], a[164:167], v[220:223], v[20:23]
    v_mul_u32_u24 v13, 1280, v13
    s_mul_i32 s72, s61, 160
    v_mfma_f32_16x16x32_bf16 v[20:23], a[144:147], v[216:219], v[20:23]
    v_lshrrev_b32 v36, 4, v1
    v_add_u32 v13, s72, v13
    v_mfma_f32_16x16x32_bf16 v[24:27], a[148:151], v[216:219], v[24:27]
    buffer_load_dwordx4 v[208:211], v4, s[32:35], s5 offen offset:0 sc1
    v_mfma_f32_16x16x32_bf16 v[24:27], a[168:171], v[220:223], v[24:27]
    v_lshl_add_u32 v0, v36, 3, v13
    v_and_b32 v37, 16, v1
    v_mfma_f32_16x16x32_bf16 v[28:31], a[172:175], v[220:223], v[28:31]
    v_lshl_add_u32 v0, v37, 26, v0
    v_lshl_add_u32 v13, v36, 5, v13
    v_mfma_f32_16x16x32_bf16 v[28:31], a[152:155], v[216:219], v[28:31]
    v_and_b32 v37, 1, v1
    v_mul_u32_u24 v37, 2544, v37
    v_mfma_f32_16x16x32_bf16 v[32:35], a[156:159], v[216:219], v[32:35]
    v_sub_u32 v13, v13, v37
    s_mul_i32 s71, s56, 256
    v_mfma_f32_16x16x32_bf16 v[32:35], a[176:179], v[220:223], v[32:35]
    s_waitcnt vmcnt(14)
    buffer_load_dwordx4 v[212:215], v4, s[32:35], s5 offen offset:512 sc1
    s_add_u32 s71, s71, 3232768
    v_mfma_f32_16x16x32_bf16 v[16:19], a[180:183], v[224:227], v[16:19]
    v_lshrrev_b32 v36, 5, v1
    v_mul_u32_u24 v36, 63, v36
    v_mfma_f32_16x16x32_bf16 v[16:19], a[200:203], v[228:231], v[16:19]
    v_lshl_add_u32 v36, s60, 6, v36
    v_mul_u32_u24 v36, 5958, v36
    v_mfma_f32_16x16x32_bf16 v[20:23], a[204:207], v[228:231], v[20:23]
    v_lshrrev_b32 v36, 20, v36
    v_and_b32 v14, 15, v1
    v_mfma_f32_16x16x32_bf16 v[20:23], a[184:187], v[224:227], v[20:23]
    v_min_u32 v14, 1, v14
    v_mad_u32_u24 v36, v36, 8, v14
    v_mfma_f32_16x16x32_bf16 v[24:27], a[188:191], v[224:227], v[24:27]
    buffer_load_dwordx4 v[216:219], v4, s[32:35], s5 offen offset:1024 sc1
    v_mfma_f32_16x16x32_bf16 v[24:27], a[208:211], v[228:231], v[24:27]
    v_lshl_add_u32 v14, v36, 7, s71
    s_mov_b32 s75, 0xbfb8aa3b
    v_mfma_f32_16x16x32_bf16 v[28:31], a[212:215], v[228:231], v[28:31]
    v_mfma_f32_16x16x32_bf16 v[28:31], a[192:195], v[224:227], v[28:31]
    v_mfma_f32_16x16x32_bf16 v[32:35], a[196:199], v[224:227], v[32:35]
    v_mfma_f32_16x16x32_bf16 v[32:35], a[216:219], v[228:231], v[32:35]
    s_waitcnt vmcnt(14)
    buffer_load_dwordx4 v[220:223], v5, s[32:35], s5 offen offset:0 sc1
    v_mfma_f32_16x16x32_bf16 v[16:19], a[220:223], v[232:235], v[16:19]
    v_mfma_f32_16x16x32_bf16 v[16:19], a[240:243], v[236:239], v[16:19]
    v_mfma_f32_16x16x32_bf16 v[20:23], a[244:247], v[236:239], v[20:23]
    v_mfma_f32_16x16x32_bf16 v[20:23], a[224:227], v[232:235], v[20:23]
    v_mfma_f32_16x16x32_bf16 v[24:27], a[228:231], v[232:235], v[24:27]
    buffer_load_dwordx4 v[224:227], v5, s[32:35], s5 offen offset:512 sc1
    v_mfma_f32_16x16x32_bf16 v[24:27], a[248:251], v[236:239], v[24:27]
    v_mfma_f32_16x16x32_bf16 v[28:31], a[252:255], v[236:239], v[28:31]
    buffer_load_dwordx4 v[180:183], v13, s[24:27], 0 offen
    v_mfma_f32_16x16x32_bf16 v[28:31], a[232:235], v[232:235], v[28:31]
    v_mfma_f32_16x16x32_bf16 v[32:35], a[236:239], v[232:235], v[32:35]
    v_mfma_f32_16x16x32_bf16 v[32:35], v[96:99], v[236:239], v[32:35]
    s_waitcnt vmcnt(15)
    buffer_load_dwordx4 v[228:231], v5, s[32:35], s5 offen offset:1024 sc1
    v_mfma_f32_16x16x32_bf16 v[16:19], v[100:103], v[240:243], v[16:19]
    v_mfma_f32_16x16x32_bf16 v[16:19], v[120:123], v[244:247], v[16:19]
    v_mfma_f32_16x16x32_bf16 v[20:23], v[124:127], v[244:247], v[20:23]
    v_mfma_f32_16x16x32_bf16 v[20:23], v[104:107], v[240:243], v[20:23]
    v_mfma_f32_16x16x32_bf16 v[24:27], v[108:111], v[240:243], v[24:27]
    buffer_load_dwordx4 v[232:235], v6, s[32:35], s5 offen offset:0 sc1
    v_mfma_f32_16x16x32_bf16 v[24:27], v[128:131], v[244:247], v[24:27]
    v_mfma_f32_16x16x32_bf16 v[28:31], v[132:135], v[244:247], v[28:31]
    buffer_load_dwordx4 v[184:187], v13, s[24:27], 0 offen offset:2560
    v_mfma_f32_16x16x32_bf16 v[28:31], v[112:115], v[240:243], v[28:31]
    v_mfma_f32_16x16x32_bf16 v[32:35], v[116:119], v[240:243], v[32:35]
    v_mfma_f32_16x16x32_bf16 v[32:35], v[136:139], v[244:247], v[32:35]
    s_waitcnt vmcnt(16)
    buffer_load_dwordx4 v[236:239], v6, s[32:35], s5 offen offset:512 sc1
    v_mfma_f32_16x16x32_bf16 v[16:19], v[140:143], v[248:251], v[16:19]
    v_mfma_f32_16x16x32_bf16 v[16:19], v[160:163], v[252:255], v[16:19]
    v_mfma_f32_16x16x32_bf16 v[20:23], v[164:167], v[252:255], v[20:23]
    v_mfma_f32_16x16x32_bf16 v[20:23], v[144:147], v[248:251], v[20:23]
    v_mfma_f32_16x16x32_bf16 v[24:27], v[148:151], v[248:251], v[24:27]
    buffer_load_dwordx4 v[240:243], v6, s[32:35], s5 offen offset:1024 sc1
    v_mfma_f32_16x16x32_bf16 v[24:27], v[168:171], v[252:255], v[24:27]
    v_mfma_f32_16x16x32_bf16 v[28:31], v[172:175], v[252:255], v[28:31]
    buffer_load_dwordx4 v[188:191], v0, s[24:27], 0 offen offset:128
    v_mfma_f32_16x16x32_bf16 v[28:31], v[152:155], v[248:251], v[28:31]
    s_waitcnt vmcnt(12)
    s_barrier
    v_mfma_f32_16x16x32_bf16 v[32:35], v[156:159], v[248:251], v[32:35]
    buffer_store_dword v15, v3, s[40:43], s70 offen sc1
    v_mfma_f32_16x16x32_bf16 v[32:35], v[176:179], v[252:255], v[32:35]
    s_waitcnt vmcnt(11)
    buffer_load_dwordx4 v[244:247], v7, s[32:35], s5 offen offset:0 sc1
    v_mfma_f32_16x16x32_bf16 v[56:59], a[100:103], v[208:211], 0
    v_mfma_f32_16x16x32_bf16 v[56:59], a[120:123], v[212:215], v[56:59]
    ds_write_b32 v8, v16 offset:0
    v_mfma_f32_16x16x32_bf16 v[60:63], a[124:127], v[212:215], 0
    ds_write_b32 v8, v17 offset:256
    v_mfma_f32_16x16x32_bf16 v[60:63], a[104:107], v[208:211], v[60:63]
    ds_write_b32 v8, v18 offset:512
    v_mfma_f32_16x16x32_bf16 v[64:67], a[108:111], v[208:211], 0
    buffer_load_dwordx4 v[248:251], v7, s[32:35], s5 offen offset:512 sc1
    v_mfma_f32_16x16x32_bf16 v[64:67], a[128:131], v[212:215], v[64:67]
    ds_write_b32 v8, v19 offset:768
    v_mfma_f32_16x16x32_bf16 v[68:71], a[132:135], v[212:215], 0
    ds_write_b32 v8, v20 offset:1024
    v_mfma_f32_16x16x32_bf16 v[68:71], a[112:115], v[208:211], v[68:71]
    ds_write_b32 v8, v21 offset:1280
    v_mfma_f32_16x16x32_bf16 v[72:75], a[116:119], v[208:211], 0
    ds_write_b32 v8, v22 offset:1536
    v_mfma_f32_16x16x32_bf16 v[72:75], a[136:139], v[212:215], v[72:75]
    s_waitcnt vmcnt(11)
    buffer_load_dwordx4 v[252:255], v7, s[32:35], s5 offen offset:1024 sc1
    v_mfma_f32_16x16x32_bf16 v[56:59], a[140:143], v[216:219], v[56:59]
    ds_write_b32 v8, v23 offset:1792
    v_mfma_f32_16x16x32_bf16 v[56:59], a[160:163], v[220:223], v[56:59]
    ds_write_b32 v8, v24 offset:2048
    v_mfma_f32_16x16x32_bf16 v[60:63], a[164:167], v[220:223], v[60:63]
    ds_write_b32 v8, v25 offset:2304
    v_mfma_f32_16x16x32_bf16 v[60:63], a[144:147], v[216:219], v[60:63]
    ds_write_b32 v8, v26 offset:2560
    v_mfma_f32_16x16x32_bf16 v[64:67], a[148:151], v[216:219], v[64:67]
    buffer_load_dwordx4 v[208:211], v4, s[32:35], s6 offen offset:0 sc1
    v_mfma_f32_16x16x32_bf16 v[64:67], a[168:171], v[220:223], v[64:67]
    ds_write_b32 v8, v27 offset:2816
    v_mfma_f32_16x16x32_bf16 v[68:71], a[172:175], v[220:223], v[68:71]
    ds_write_b32 v8, v28 offset:3072
    v_mfma_f32_16x16x32_bf16 v[68:71], a[152:155], v[216:219], v[68:71]
    ds_write_b32 v8, v29 offset:3328
    v_mfma_f32_16x16x32_bf16 v[72:75], a[156:159], v[216:219], v[72:75]
    ds_write_b32 v8, v30 offset:3584
    v_mfma_f32_16x16x32_bf16 v[72:75], a[176:179], v[220:223], v[72:75]
    s_waitcnt vmcnt(10)
    buffer_load_dwordx4 v[212:215], v4, s[32:35], s6 offen offset:512 sc1
    v_mfma_f32_16x16x32_bf16 v[56:59], a[180:183], v[224:227], v[56:59]
    ds_write_b32 v8, v31 offset:3840
    v_mfma_f32_16x16x32_bf16 v[56:59], a[200:203], v[228:231], v[56:59]
    ds_write_b32 v8, v32 offset:4096
    v_mfma_f32_16x16x32_bf16 v[60:63], a[204:207], v[228:231], v[60:63]
    ds_write_b32 v8, v33 offset:4352
    v_mfma_f32_16x16x32_bf16 v[60:63], a[184:187], v[224:227], v[60:63]
    ds_write_b32 v8, v34 offset:4608
    v_mfma_f32_16x16x32_bf16 v[64:67], a[188:191], v[224:227], v[64:67]
    buffer_load_dwordx4 v[216:219], v4, s[32:35], s6 offen offset:1024 sc1
    v_mfma_f32_16x16x32_bf16 v[64:67], a[208:211], v[228:231], v[64:67]
    ds_write_b32 v8, v35 offset:4864
    v_mfma_f32_16x16x32_bf16 v[68:71], a[212:215], v[228:231], v[68:71]
    v_mfma_f32_16x16x32_bf16 v[68:71], a[192:195], v[224:227], v[68:71]
    v_mfma_f32_16x16x32_bf16 v[72:75], a[196:199], v[224:227], v[72:75]
    v_mfma_f32_16x16x32_bf16 v[72:75], a[216:219], v[228:231], v[72:75]
    s_waitcnt vmcnt(9)
    buffer_load_dwordx4 v[220:223], v5, s[32:35], s6 offen offset:0 sc1
    v_mfma_f32_16x16x32_bf16 v[56:59], a[220:223], v[232:235], v[56:59]
    s_waitcnt lgkmcnt(0)
    s_barrier
    ds_read2st64_b32 v[16:17], v10 offset0:0 offset1:1
    v_mfma_f32_16x16x32_bf16 v[56:59], a[240:243], v[236:239], v[56:59]
    ds_read2st64_b32 v[18:19], v10 offset0:2 offset1:3
    v_mfma_f32_16x16x32_bf16 v[60:63], a[244:247], v[236:239], v[60:63]
    ds_read2st64_b32 v[20:21], v10 offset0:4 offset1:5
    v_mfma_f32_16x16x32_bf16 v[60:63], a[224:227], v[232:235], v[60:63]
    ds_read2st64_b32 v[22:23], v10 offset0:6 offset1:7
    v_mfma_f32_16x16x32_bf16 v[64:67], a[228:231], v[232:235], v[64:67]
    buffer_load_dwordx4 v[224:227], v5, s[32:35], s6 offen offset:512 sc1
    v_mfma_f32_16x16x32_bf16 v[64:67], a[248:251], v[236:239], v[64:67]
    ds_read2st64_b32 v[24:25], v10 offset0:8 offset1:9
    v_mfma_f32_16x16x32_bf16 v[68:71], a[252:255], v[236:239], v[68:71]
    ds_read2st64_b32 v[26:27], v10 offset0:10 offset1:11
    v_mfma_f32_16x16x32_bf16 v[68:71], a[232:235], v[232:235], v[68:71]
    ds_read2st64_b32 v[28:29], v10 offset0:12 offset1:13
    v_mfma_f32_16x16x32_bf16 v[72:75], a[236:239], v[232:235], v[72:75]
    ds_read2st64_b32 v[30:31], v10 offset0:14 offset1:15
    v_mfma_f32_16x16x32_bf16 v[72:75], v[96:99], v[236:239], v[72:75]
    s_waitcnt vmcnt(7)
    buffer_load_dwordx4 v[228:231], v5, s[32:35], s6 offen offset:1024 sc1
    v_mfma_f32_16x16x32_bf16 v[56:59], v[100:103], v[240:243], v[56:59]
    ds_read2st64_b32 v[32:33], v10 offset0:16 offset1:17
    v_mfma_f32_16x16x32_bf16 v[56:59], v[120:123], v[244:247], v[56:59]
    ds_read2st64_b32 v[34:35], v10 offset0:18 offset1:19
    v_mfma_f32_16x16x32_bf16 v[60:63], v[124:127], v[244:247], v[60:63]
    v_mfma_f32_16x16x32_bf16 v[60:63], v[104:107], v[240:243], v[60:63]
    v_mfma_f32_16x16x32_bf16 v[64:67], v[108:111], v[240:243], v[64:67]
    buffer_load_dwordx4 v[232:235], v6, s[32:35], s6 offen offset:0 sc1
    v_mfma_f32_16x16x32_bf16 v[64:67], v[128:131], v[244:247], v[64:67]
    v_mfma_f32_16x16x32_bf16 v[68:71], v[132:135], v[244:247], v[68:71]
    s_mov_b32 vcc_lo, 0x55555555
    v_mfma_f32_16x16x32_bf16 v[68:71], v[112:115], v[240:243], v[68:71]
    s_mov_b32 vcc_hi, 0x55555555
    v_permlane16_swap_b32 v188, v190
    v_permlane16_swap_b32 v189, v191
    v_mfma_f32_16x16x32_bf16 v[72:75], v[116:119], v[240:243], v[72:75]
    v_lshlrev_b32 v196, 16, v188
    v_and_b32 v197, 0xffff0000, v188
    v_mfma_f32_16x16x32_bf16 v[72:75], v[136:139], v[244:247], v[72:75]
    s_waitcnt vmcnt(7)
    buffer_load_dwordx4 v[236:239], v6, s[32:35], s6 offen offset:512 sc1
    v_mfma_f32_16x16x32_bf16 v[56:59], v[140:143], v[248:251], v[56:59]
    v_lshlrev_b32 v198, 16, v189
    v_and_b32 v199, 0xffff0000, v189
    v_mfma_f32_16x16x32_bf16 v[56:59], v[160:163], v[252:255], v[56:59]
    v_cndmask_b32_dpp v188, v184, v180, vcc quad_perm:[1,0,3,2] row_mask:0xf bank_mask:0xf
    v_cndmask_b32_dpp v189, v185, v181, vcc quad_perm:[1,0,3,2] row_mask:0xf bank_mask:0xf
    v_mfma_f32_16x16x32_bf16 v[60:63], v[164:167], v[252:255], v[60:63]
    v_cndmask_b32_dpp v190, v186, v182, vcc quad_perm:[1,0,3,2] row_mask:0xf bank_mask:0xf
    v_cndmask_b32_dpp v191, v187, v183, vcc quad_perm:[1,0,3,2] row_mask:0xf bank_mask:0xf
    v_mfma_f32_16x16x32_bf16 v[60:63], v[144:147], v[248:251], v[60:63]
    s_not_b64 vcc, vcc
    v_cndmask_b32_dpp v192, v180, v184, vcc quad_perm:[1,0,3,2] row_mask:0xf bank_mask:0xf
    v_cndmask_b32_dpp v193, v181, v185, vcc quad_perm:[1,0,3,2] row_mask:0xf bank_mask:0xf
    v_mfma_f32_16x16x32_bf16 v[64:67], v[148:151], v[248:251], v[64:67]
    buffer_load_dwordx4 v[240:243], v6, s[32:35], s6 offen offset:1024 sc1
    v_mfma_f32_16x16x32_bf16 v[64:67], v[168:171], v[252:255], v[64:67]
    v_cndmask_b32_dpp v194, v182, v186, vcc quad_perm:[1,0,3,2] row_mask:0xf bank_mask:0xf
    v_cndmask_b32_dpp v195, v183, v187, vcc quad_perm:[1,0,3,2] row_mask:0xf bank_mask:0xf
    v_mfma_f32_16x16x32_bf16 v[68:71], v[172:175], v[252:255], v[68:71]
    v_lshlrev_b32 v180, 16, v188
    v_and_b32 v181, 0xffff0000, v188
    v_mfma_f32_16x16x32_bf16 v[68:71], v[152:155], v[248:251], v[68:71]
    v_lshlrev_b32 v182, 16, v189
    v_and_b32 v183, 0xffff0000, v189
    v_mfma_f32_16x16x32_bf16 v[72:75], v[156:159], v[248:251], v[72:75]
    v_lshlrev_b32 v184, 16, v190
    v_and_b32 v185, 0xffff0000, v190
    v_mfma_f32_16x16x32_bf16 v[72:75], v[176:179], v[252:255], v[72:75]
    s_waitcnt lgkmcnt(0) vmcnt(7)
    buffer_load_dwordx4 v[244:247], v7, s[32:35], s6 offen offset:0 sc1
    v_mfma_f32_16x16x32_bf16 v[16:19], a[100:103], v[208:211], v[16:19]
    v_lshlrev_b32 v186, 16, v191
    v_and_b32 v187, 0xffff0000, v191
    v_mfma_f32_16x16x32_bf16 v[16:19], a[120:123], v[212:215], v[16:19]
    ds_write_b32 v9, v56 offset:5120
    v_mfma_f32_16x16x32_bf16 v[20:23], a[124:127], v[212:215], v[20:23]
    ds_write_b32 v9, v57 offset:5376
    v_mfma_f32_16x16x32_bf16 v[20:23], a[104:107], v[208:211], v[20:23]
    ds_write_b32 v9, v58 offset:5632
    v_mfma_f32_16x16x32_bf16 v[24:27], a[108:111], v[208:211], v[24:27]
    buffer_load_dwordx4 v[248:251], v7, s[32:35], s6 offen offset:512 sc1
    v_mfma_f32_16x16x32_bf16 v[24:27], a[128:131], v[212:215], v[24:27]
    ds_write_b32 v9, v59 offset:5888
    v_mfma_f32_16x16x32_bf16 v[28:31], a[132:135], v[212:215], v[28:31]
    ds_write_b32 v9, v60 offset:6144
    v_mfma_f32_16x16x32_bf16 v[28:31], a[112:115], v[208:211], v[28:31]
    ds_write_b32 v9, v61 offset:6400
    v_mfma_f32_16x16x32_bf16 v[32:35], a[116:119], v[208:211], v[32:35]
    ds_write_b32 v9, v62 offset:6656
    v_mfma_f32_16x16x32_bf16 v[32:35], a[136:139], v[212:215], v[32:35]
    s_waitcnt vmcnt(7)
    buffer_load_dwordx4 v[252:255], v7, s[32:35], s6 offen offset:1024 sc1
    v_mfma_f32_16x16x32_bf16 v[16:19], a[140:143], v[216:219], v[16:19]
    ds_write_b32 v9, v63 offset:6912
    v_mfma_f32_16x16x32_bf16 v[16:19], a[160:163], v[220:223], v[16:19]
    ds_write_b32 v9, v64 offset:7168
    v_mfma_f32_16x16x32_bf16 v[20:23], a[164:167], v[220:223], v[20:23]
    ds_write_b32 v9, v65 offset:7424
    v_mfma_f32_16x16x32_bf16 v[20:23], a[144:147], v[216:219], v[20:23]
    ds_write_b32 v9, v66 offset:7680
    v_mfma_f32_16x16x32_bf16 v[24:27], a[148:151], v[216:219], v[24:27]
    buffer_load_dwordx4 v[208:211], v4, s[32:35], s7 offen offset:0 sc1
    v_mfma_f32_16x16x32_bf16 v[24:27], a[168:171], v[220:223], v[24:27]
    ds_write_b32 v9, v67 offset:7936
    v_mfma_f32_16x16x32_bf16 v[28:31], a[172:175], v[220:223], v[28:31]
    ds_write_b32 v9, v68 offset:8192
    v_mfma_f32_16x16x32_bf16 v[28:31], a[152:155], v[216:219], v[28:31]
    ds_write_b32 v9, v69 offset:8448
    v_mfma_f32_16x16x32_bf16 v[32:35], a[156:159], v[216:219], v[32:35]
    ds_write_b32 v9, v70 offset:8704
    v_mfma_f32_16x16x32_bf16 v[32:35], a[176:179], v[220:223], v[32:35]
    s_waitcnt vmcnt(7)
    buffer_load_dwordx4 v[212:215], v4, s[32:35], s7 offen offset:512 sc1
    v_mfma_f32_16x16x32_bf16 v[16:19], a[180:183], v[224:227], v[16:19]
    ds_write_b32 v9, v71 offset:8960
    v_mfma_f32_16x16x32_bf16 v[16:19], a[200:203], v[228:231], v[16:19]
    ds_write_b32 v9, v72 offset:9216
    v_mfma_f32_16x16x32_bf16 v[20:23], a[204:207], v[228:231], v[20:23]
    ds_write_b32 v9, v73 offset:9472
    v_mfma_f32_16x16x32_bf16 v[20:23], a[184:187], v[224:227], v[20:23]
    ds_write_b32 v9, v74 offset:9728
    v_mfma_f32_16x16x32_bf16 v[24:27], a[188:191], v[224:227], v[24:27]
    buffer_load_dwordx4 v[216:219], v4, s[32:35], s7 offen offset:1024 sc1
    v_mfma_f32_16x16x32_bf16 v[24:27], a[208:211], v[228:231], v[24:27]
    ds_write_b32 v9, v75 offset:9984
    v_mfma_f32_16x16x32_bf16 v[28:31], a[212:215], v[228:231], v[28:31]
    buffer_load_dword v12, v14, s[40:43], 0 offen sc1
    v_mfma_f32_16x16x32_bf16 v[28:31], a[192:195], v[224:227], v[28:31]
    v_lshlrev_b32 v188, 16, v192
    v_and_b32 v189, 0xffff0000, v192
    v_mfma_f32_16x16x32_bf16 v[32:35], a[196:199], v[224:227], v[32:35]
    v_lshlrev_b32 v190, 16, v193
    v_and_b32 v191, 0xffff0000, v193
    v_mfma_f32_16x16x32_bf16 v[32:35], a[216:219], v[228:231], v[32:35]
    s_waitcnt vmcnt(8)
    buffer_load_dwordx4 v[220:223], v5, s[32:35], s7 offen offset:0 sc1
    v_mfma_f32_16x16x32_bf16 v[16:19], a[220:223], v[232:235], v[16:19]
    s_waitcnt lgkmcnt(0)
    s_barrier
    ds_read2st64_b32 v[56:57], v11 offset0:20 offset1:21
    v_mfma_f32_16x16x32_bf16 v[16:19], a[240:243], v[236:239], v[16:19]
    ds_read2st64_b32 v[58:59], v11 offset0:22 offset1:23
    v_lshlrev_b32 v192, 16, v194
    v_mfma_f32_16x16x32_bf16 v[20:23], a[244:247], v[236:239], v[20:23]
    ds_read2st64_b32 v[60:61], v11 offset0:24 offset1:25
    v_and_b32 v193, 0xffff0000, v194
    v_mfma_f32_16x16x32_bf16 v[20:23], a[224:227], v[232:235], v[20:23]
    ds_read2st64_b32 v[62:63], v11 offset0:26 offset1:27
    v_lshlrev_b32 v194, 16, v195
    v_mfma_f32_16x16x32_bf16 v[24:27], a[228:231], v[232:235], v[24:27]
    buffer_load_dwordx4 v[224:227], v5, s[32:35], s7 offen offset:512 sc1
    v_mfma_f32_16x16x32_bf16 v[24:27], a[248:251], v[236:239], v[24:27]
    ds_read2st64_b32 v[64:65], v11 offset0:28 offset1:29
    v_and_b32 v195, 0xffff0000, v195
    v_mfma_f32_16x16x32_bf16 v[28:31], a[252:255], v[236:239], v[28:31]
    ds_read2st64_b32 v[66:67], v11 offset0:30 offset1:31
    v_mad_u32_u24 v8, v1, 12, v8
    v_mfma_f32_16x16x32_bf16 v[28:31], a[232:235], v[232:235], v[28:31]
    ds_read2st64_b32 v[68:69], v11 offset0:32 offset1:33
    v_mad_u32_u24 v9, v1, 12, v9
    v_mfma_f32_16x16x32_bf16 v[32:35], a[236:239], v[232:235], v[32:35]
    ds_read2st64_b32 v[70:71], v11 offset0:34 offset1:35
    v_mfma_f32_16x16x32_bf16 v[32:35], v[96:99], v[236:239], v[32:35]
    s_waitcnt vmcnt(8)
    buffer_load_dwordx4 v[228:231], v5, s[32:35], s7 offen offset:1024 sc1
    v_mfma_f32_16x16x32_bf16 v[16:19], v[100:103], v[240:243], v[16:19]
    ds_read2st64_b32 v[72:73], v11 offset0:36 offset1:37
    v_mfma_f32_16x16x32_bf16 v[16:19], v[120:123], v[244:247], v[16:19]
    ds_read2st64_b32 v[74:75], v11 offset0:38 offset1:39
    v_mfma_f32_16x16x32_bf16 v[20:23], v[124:127], v[244:247], v[20:23]
    v_mfma_f32_16x16x32_bf16 v[20:23], v[104:107], v[240:243], v[20:23]
    v_mfma_f32_16x16x32_bf16 v[24:27], v[108:111], v[240:243], v[24:27]
    buffer_load_dwordx4 v[232:235], v6, s[32:35], s7 offen offset:0 sc1
    v_mfma_f32_16x16x32_bf16 v[24:27], v[128:131], v[244:247], v[24:27]
    v_mfma_f32_16x16x32_bf16 v[28:31], v[132:135], v[244:247], v[28:31]
Q_PG6:
    s_cbranch_execz Q_TRET
    v_mfma_f32_16x16x32_bf16 v[28:31], v[112:115], v[240:243], v[28:31]
    v_mfma_f32_16x16x32_bf16 v[32:35], v[116:119], v[240:243], v[32:35]
    v_mfma_f32_16x16x32_bf16 v[32:35], v[136:139], v[244:247], v[32:35]
    s_waitcnt vmcnt(8)
    buffer_load_dwordx4 v[236:239], v6, s[32:35], s7 offen offset:512 sc1
    v_mfma_f32_16x16x32_bf16 v[16:19], v[140:143], v[248:251], v[16:19]
    v_mfma_f32_16x16x32_bf16 v[16:19], v[160:163], v[252:255], v[16:19]
    v_mfma_f32_16x16x32_bf16 v[20:23], v[164:167], v[252:255], v[20:23]
    v_mfma_f32_16x16x32_bf16 v[20:23], v[144:147], v[248:251], v[20:23]
    v_mfma_f32_16x16x32_bf16 v[24:27], v[148:151], v[248:251], v[24:27]
    buffer_load_dwordx4 v[240:243], v6, s[32:35], s7 offen offset:1024 sc1
    v_mfma_f32_16x16x32_bf16 v[24:27], v[168:171], v[252:255], v[24:27]
    v_mfma_f32_16x16x32_bf16 v[28:31], v[172:175], v[252:255], v[28:31]
    v_mfma_f32_16x16x32_bf16 v[28:31], v[152:155], v[248:251], v[28:31]
    v_mfma_f32_16x16x32_bf16 v[32:35], v[156:159], v[248:251], v[32:35]
    v_mfma_f32_16x16x32_bf16 v[32:35], v[176:179], v[252:255], v[32:35]
    s_waitcnt lgkmcnt(0) vmcnt(8)
    buffer_load_dwordx4 v[244:247], v7, s[32:35], s7 offen offset:0 sc1
    v_mfma_f32_16x16x32_bf16 v[56:59], a[100:103], v[208:211], v[56:59]
    v_mfma_f32_16x16x32_bf16 v[56:59], a[120:123], v[212:215], v[56:59]
    ds_write_b32 v10, v16 offset:10240
    v_mfma_f32_16x16x32_bf16 v[60:63], a[124:127], v[212:215], v[60:63]
    ds_write_b32 v10, v17 offset:10496
    v_mfma_f32_16x16x32_bf16 v[60:63], a[104:107], v[208:211], v[60:63]
    ds_write_b32 v10, v18 offset:10752
    v_mfma_f32_16x16x32_bf16 v[64:67], a[108:111], v[208:211], v[64:67]
    buffer_load_dwordx4 v[248:251], v7, s[32:35], s7 offen offset:512 sc1
    v_mfma_f32_16x16x32_bf16 v[64:67], a[128:131], v[212:215], v[64:67]
    s_waitcnt vmcnt(8)
    ds_write_b32 v10, v19 offset:11008
    v_cmp_eq_u32 vcc, 0, v12
    v_mfma_f32_16x16x32_bf16 v[68:71], a[132:135], v[212:215], v[68:71]
    s_cbranch_vccnz Q_SPIN_O
Q_BACK_O:
    ds_write_b32 v10, v20 offset:11264
    s_mov_b32 vcc_lo, 0xaaaaaaaa
    v_mfma_f32_16x16x32_bf16 v[68:71], a[112:115], v[208:211], v[68:71]
    s_mov_b32 vcc_hi, 0xaaaaaaaa
    ds_write_b32 v10, v21 offset:11520
    v_mfma_f32_16x16x32_bf16 v[72:75], a[116:119], v[208:211], v[72:75]
    ds_write_b32 v10, v22 offset:11776
    v_mfma_f32_16x16x32_bf16 v[72:75], a[136:139], v[212:215], v[72:75]
    s_waitcnt vmcnt(7)
    buffer_load_dwordx4 v[252:255], v7, s[32:35], s7 offen offset:1024 sc1
    v_mfma_f32_16x16x32_bf16 v[56:59], a[140:143], v[216:219], v[56:59]
    ds_write_b32 v10, v23 offset:12032
    v_mfma_f32_16x16x32_bf16 v[56:59], a[160:163], v[220:223], v[56:59]
    ds_write_b32 v10, v24 offset:12288
    v_mfma_f32_16x16x32_bf16 v[60:63], a[164:167], v[220:223], v[60:63]
    ds_write_b32 v10, v25 offset:12544
    v_mfma_f32_16x16x32_bf16 v[60:63], a[144:147], v[216:219], v[60:63]
    ds_write_b32 v10, v26 offset:12800
    v_mfma_f32_16x16x32_bf16 v[64:67], a[148:151], v[216:219], v[64:67]
    buffer_load_dwordx4 v[208:211], v4, s[32:35], s8 offen offset:0 sc1
    v_mfma_f32_16x16x32_bf16 v[64:67], a[168:171], v[220:223], v[64:67]
    ds_write_b32 v10, v27 offset:13056
    v_mfma_f32_16x16x32_bf16 v[68:71], a[172:175], v[220:223], v[68:71]
    ds_write_b32 v10, v28 offset:13312
    v_mfma_f32_16x16x32_bf16 v[68:71], a[152:155], v[216:219], v[68:71]
    ds_write_b32 v10, v29 offset:13568
    v_mfma_f32_16x16x32_bf16 v[72:75], a[156:159], v[216:219], v[72:75]
    ds_write_b32 v10, v30 offset:13824
    v_mfma_f32_16x16x32_bf16 v[72:75], a[176:179], v[220:223], v[72:75]
    s_waitcnt vmcnt(7)
    buffer_load_dwordx4 v[212:215], v4, s[32:35], s8 offen offset:512 sc1
    v_mfma_f32_16x16x32_bf16 v[56:59], a[180:183], v[224:227], v[56:59]
    ds_write_b32 v10, v31 offset:14080
    v_mfma_f32_16x16x32_bf16 v[56:59], a[200:203], v[228:231], v[56:59]
    ds_write_b32 v10, v32 offset:14336
    v_mfma_f32_16x16x32_bf16 v[60:63], a[204:207], v[228:231], v[60:63]
    ds_write_b32 v10, v33 offset:14592
    v_mfma_f32_16x16x32_bf16 v[60:63], a[184:187], v[224:227], v[60:63]
    ds_write_b32 v10, v34 offset:14848
    v_mfma_f32_16x16x32_bf16 v[64:67], a[188:191], v[224:227], v[64:67]
    buffer_load_dwordx4 v[216:219], v4, s[32:35], s8 offen offset:1024 sc1
    v_mfma_f32_16x16x32_bf16 v[64:67], a[208:211], v[228:231], v[64:67]
    ds_write_b32 v10, v35 offset:15104
    v_mfma_f32_16x16x32_bf16 v[68:71], a[212:215], v[228:231], v[68:71]
    v_mfma_f32_16x16x32_bf16 v[68:71], a[192:195], v[224:227], v[68:71]
    v_mfma_f32_16x16x32_bf16 v[72:75], a[196:199], v[224:227], v[72:75]
    v_mfma_f32_16x16x32_bf16 v[72:75], a[216:219], v[228:231], v[72:75]
    s_waitcnt vmcnt(7)
    buffer_load_dwordx4 v[220:223], v4, s[32:35], s8 offen offset:1536 sc1
    v_mfma_f32_16x16x32_bf16 v[56:59], a[220:223], v[232:235], v[56:59]
    s_waitcnt lgkmcnt(0)
    s_barrier
    ds_read2st64_b32 v[16:17], v11 offset0:40 offset1:41
    v_mfma_f32_16x16x32_bf16 v[56:59], a[240:243], v[236:239], v[56:59]
    ds_read2st64_b32 v[18:19], v11 offset0:42 offset1:43
    v_mad_u32_u24 v10, v1, 12, v10
    v_mfma_f32_16x16x32_bf16 v[60:63], a[244:247], v[236:239], v[60:63]
    ds_read2st64_b32 v[20:21], v11 offset0:44 offset1:45
    v_mfma_f32_16x16x32_bf16 v[60:63], a[224:227], v[232:235], v[60:63]
    ds_read2st64_b32 v[22:23], v11 offset0:46 offset1:47
    v_mfma_f32_16x16x32_bf16 v[64:67], a[228:231], v[232:235], v[64:67]
    buffer_load_dwordx4 v[224:227], v4, s[32:35], s8 offen offset:2048 sc1
    v_mfma_f32_16x16x32_bf16 v[64:67], a[248:251], v[236:239], v[64:67]
    ds_read2st64_b32 v[24:25], v11 offset0:48 offset1:49
    v_mfma_f32_16x16x32_bf16 v[68:71], a[252:255], v[236:239], v[68:71]
    ds_read2st64_b32 v[26:27], v11 offset0:50 offset1:51
    v_mfma_f32_16x16x32_bf16 v[68:71], a[232:235], v[232:235], v[68:71]
    ds_read2st64_b32 v[28:29], v11 offset0:52 offset1:53
    v_mfma_f32_16x16x32_bf16 v[72:75], a[236:239], v[232:235], v[72:75]
    s_waitcnt lgkmcnt(5)
    ds_read2st64_b32 v[30:31], v11 offset0:54 offset1:55
    v_mul_f32 v16, s75, v16
    v_mfma_f32_16x16x32_bf16 v[72:75], v[96:99], v[236:239], v[72:75]
    s_waitcnt vmcnt(7)
    buffer_load_dwordx4 v[228:231], v4, s[32:35], s9 offen offset:0 sc1
    v_mfma_f32_16x16x32_bf16 v[56:59], v[100:103], v[240:243], v[56:59]
    ds_read2st64_b32 v[32:33], v11 offset0:56 offset1:57
    v_mul_f32 v17, s75, v17
    v_mfma_f32_16x16x32_bf16 v[56:59], v[120:123], v[244:247], v[56:59]
    ds_read2st64_b32 v[34:35], v11 offset0:58 offset1:59
    v_mul_f32 v18, s75, v18
    v_mfma_f32_16x16x32_bf16 v[60:63], v[124:127], v[244:247], v[60:63]
    v_mul_f32 v19, s75, v19
    s_waitcnt lgkmcnt(6)
    v_mfma_f32_16x16x32_bf16 v[60:63], v[104:107], v[240:243], v[60:63]
    v_mad_u32_u24 v11, v1, 12, v11
    v_mul_f32 v20, s75, v20
    v_mfma_f32_16x16x32_bf16 v[64:67], v[108:111], v[240:243], v[64:67]
    buffer_load_dwordx4 v[232:235], v4, s[32:35], s9 offen offset:512 sc1
    v_mfma_f32_16x16x32_bf16 v[64:67], v[128:131], v[244:247], v[64:67]
    v_mul_f32 v21, s75, v21
    v_mul_f32 v22, s75, v22
    v_mfma_f32_16x16x32_bf16 v[68:71], v[132:135], v[244:247], v[68:71]
    v_mul_f32 v23, s75, v23
    s_waitcnt lgkmcnt(4)
    v_mfma_f32_16x16x32_bf16 v[68:71], v[112:115], v[240:243], v[68:71]
    v_mul_f32 v24, s75, v24
    v_mul_f32 v25, s75, v25
    v_mfma_f32_16x16x32_bf16 v[72:75], v[116:119], v[240:243], v[72:75]
    v_mul_f32 v26, s75, v26
    v_mul_f32 v27, s75, v27
    v_mfma_f32_16x16x32_bf16 v[72:75], v[136:139], v[244:247], v[72:75]
    s_waitcnt vmcnt(7)
    buffer_load_dwordx4 v[236:239], v4, s[32:35], s9 offen offset:1024 sc1
    s_waitcnt lgkmcnt(2)
    v_mfma_f32_16x16x32_bf16 v[56:59], v[140:143], v[248:251], v[56:59]
    v_mul_f32 v28, s75, v28
    v_mul_f32 v29, s75, v29
    v_mfma_f32_16x16x32_bf16 v[56:59], v[160:163], v[252:255], v[56:59]
    v_mul_f32 v30, s75, v30
    v_mul_f32 v31, s75, v31
    v_mfma_f32_16x16x32_bf16 v[60:63], v[164:167], v[252:255], v[60:63]
    s_waitcnt lgkmcnt(0)
    v_mul_f32 v32, s75, v32
    v_mul_f32 v33, s75, v33
    v_mfma_f32_16x16x32_bf16 v[60:63], v[144:147], v[248:251], v[60:63]
    v_mul_f32 v34, s75, v34
    v_mul_f32 v35, s75, v35
    v_mfma_f32_16x16x32_bf16 v[64:67], v[148:151], v[248:251], v[64:67]
    buffer_load_dwordx4 v[240:243], v4, s[32:35], s9 offen offset:1536 sc1
    v_mfma_f32_16x16x32_bf16 v[64:67], v[168:171], v[252:255], v[64:67]
    v_mfma_f32_16x16x32_bf16 v[68:71], v[172:175], v[252:255], v[68:71]
    v_mfma_f32_16x16x32_bf16 v[68:71], v[152:155], v[248:251], v[68:71]
    v_mfma_f32_16x16x32_bf16 v[72:75], v[156:159], v[248:251], v[72:75]
    v_mfma_f32_16x16x32_bf16 v[72:75], v[176:179], v[252:255], v[72:75]
    s_waitcnt vmcnt(7)
    buffer_load_dwordx4 v[244:247], v4, s[32:35], s9 offen offset:2048 sc1
    v_mfma_f32_16x16x32_bf16 v[36:39], a[0:3], v[208:211], 0
    v_fma_f32 v56, v56, s75, v16
    v_fma_f32 v57, v57, s75, v17
    v_mfma_f32_16x16x32_bf16 v[36:39], a[20:23], v[212:215], v[36:39]
    v_exp_f32 v16, v56
    v_mfma_f32_16x16x32_bf16 v[40:43], a[24:27], v[212:215], 0
    v_exp_f32 v17, v57
    v_mfma_f32_16x16x32_bf16 v[40:43], a[4:7], v[208:211], v[40:43]
    v_fma_f32 v16, v16, s75, s75
    v_fma_f32 v17, v17, s75, s75
    v_mfma_f32_16x16x32_bf16 v[44:47], a[8:11], v[208:211], 0
    buffer_load_dwordx4 v[248:251], v4, s[32:35], s10 offen offset:0 sc1
    v_mfma_f32_16x16x32_bf16 v[44:47], a[28:31], v[212:215], v[44:47]
    v_rcp_f32 v16, v16
    v_mfma_f32_16x16x32_bf16 v[48:51], a[32:35], v[212:215], 0
    v_rcp_f32 v17, v17
    v_mfma_f32_16x16x32_bf16 v[48:51], a[12:15], v[208:211], v[48:51]
    v_mul_f32 v56, v56, v16
    v_mul_f32 v57, v57, v17
    v_mfma_f32_16x16x32_bf16 v[52:55], a[16:19], v[208:211], 0
    v_fma_f32 v60, v60, s75, v20
    v_fma_f32 v61, v61, s75, v21
    v_mfma_f32_16x16x32_bf16 v[52:55], a[36:39], v[212:215], v[52:55]
    s_waitcnt vmcnt(6)
    buffer_load_dwordx4 v[252:255], v4, s[32:35], s10 offen offset:512 sc1
    v_mfma_f32_16x16x32_bf16 v[36:39], a[40:43], v[216:219], v[36:39]
    v_exp_f32 v20, v60
    v_mfma_f32_16x16x32_bf16 v[36:39], a[60:63], v[220:223], v[36:39]
    v_exp_f32 v21, v61
    v_mfma_f32_16x16x32_bf16 v[36:39], a[80:83], v[224:227], v[36:39]
    v_fma_f32 v20, v20, s75, s75
    v_fma_f32 v21, v21, s75, s75
    v_mfma_f32_16x16x32_bf16 v[40:43], a[84:87], v[224:227], v[40:43]
    v_rcp_f32 v20, v20
    v_mfma_f32_16x16x32_bf16 v[40:43], a[64:67], v[220:223], v[40:43]
    buffer_load_dwordx4 v[208:211], v4, s[32:35], s10 offen offset:1024 sc1
    v_mfma_f32_16x16x32_bf16 v[40:43], a[44:47], v[216:219], v[40:43]
    v_rcp_f32 v21, v21
    v_mfma_f32_16x16x32_bf16 v[44:47], a[48:51], v[216:219], v[44:47]
    v_mul_f32 v60, v60, v20
    v_mul_f32 v61, v61, v21
    v_mfma_f32_16x16x32_bf16 v[44:47], a[68:71], v[220:223], v[44:47]
    ds_write_b128 v8, v[36:39] offset:0
    v_mfma_f32_16x16x32_bf16 v[44:47], a[88:91], v[224:227], v[44:47]
    v_fma_f32 v64, v64, s75, v24
    v_fma_f32 v65, v65, s75, v25
    v_mfma_f32_16x16x32_bf16 v[48:51], a[92:95], v[224:227], v[48:51]
    buffer_load_dwordx4 v[212:215], v4, s[32:35], s10 offen offset:1536 sc1
    v_mfma_f32_16x16x32_bf16 v[48:51], a[72:75], v[220:223], v[48:51]
    ds_write_b128 v8, v[40:43] offset:1024
    v_mfma_f32_16x16x32_bf16 v[48:51], a[52:55], v[216:219], v[48:51]
    v_exp_f32 v24, v64
    v_mfma_f32_16x16x32_bf16 v[52:55], a[56:59], v[216:219], v[52:55]
    v_exp_f32 v25, v65
    v_mfma_f32_16x16x32_bf16 v[52:55], a[76:79], v[220:223], v[52:55]
    ds_write_b128 v8, v[44:47] offset:2048
    v_mfma_f32_16x16x32_bf16 v[52:55], a[96:99], v[224:227], v[52:55]
    s_waitcnt vmcnt(7)
    buffer_load_dwordx4 v[216:219], v4, s[32:35], s10 offen offset:2048 sc1
    v_mfma_f32_16x16x32_bf16 v[76:79], a[0:3], v[228:231], 0
    v_fma_f32 v24, v24, s75, s75
    v_fma_f32 v25, v25, s75, s75
    v_mfma_f32_16x16x32_bf16 v[76:79], a[20:23], v[232:235], v[76:79]
    ds_write_b128 v8, v[48:51] offset:3072
    v_mfma_f32_16x16x32_bf16 v[80:83], a[24:27], v[232:235], 0
    v_rcp_f32 v24, v24
    v_mfma_f32_16x16x32_bf16 v[80:83], a[4:7], v[228:231], v[80:83]
    v_rcp_f32 v25, v25
    v_mfma_f32_16x16x32_bf16 v[84:87], a[8:11], v[228:231], 0
    buffer_load_dwordx4 v[220:223], v4, s[32:35], s11 offen offset:0 sc1
    v_mfma_f32_16x16x32_bf16 v[84:87], a[28:31], v[232:235], v[84:87]
    ds_write_b128 v8, v[52:55] offset:4096
    v_mfma_f32_16x16x32_bf16 v[88:91], a[32:35], v[232:235], 0
    v_mul_f32 v64, v64, v24
    v_mul_f32 v65, v65, v25
    v_mfma_f32_16x16x32_bf16 v[88:91], a[12:15], v[228:231], v[88:91]
    v_fma_f32 v68, v68, s75, v28
    v_fma_f32 v69, v69, s75, v29
    v_mfma_f32_16x16x32_bf16 v[92:95], a[16:19], v[228:231], 0
    v_exp_f32 v28, v68
    v_mfma_f32_16x16x32_bf16 v[92:95], a[36:39], v[232:235], v[92:95]
    s_waitcnt vmcnt(6)
    buffer_load_dwordx4 v[224:227], v4, s[32:35], s11 offen offset:512 sc1
    v_mfma_f32_16x16x32_bf16 v[76:79], a[40:43], v[236:239], v[76:79]
    v_exp_f32 v29, v69
    v_mfma_f32_16x16x32_bf16 v[76:79], a[60:63], v[240:243], v[76:79]
    v_fma_f32 v28, v28, s75, s75
    v_fma_f32 v29, v29, s75, s75
    v_mfma_f32_16x16x32_bf16 v[76:79], a[80:83], v[244:247], v[76:79]
    s_waitcnt lgkmcnt(0)
    s_barrier
    ds_read_b128 v[36:39], v10 offset:0
    v_mfma_f32_16x16x32_bf16 v[80:83], a[84:87], v[244:247], v[80:83]
    ds_read_b128 v[40:43], v10 offset:1024
    v_fma_f32 v58, v58, s75, v18
    v_mfma_f32_16x16x32_bf16 v[80:83], a[64:67], v[240:243], v[80:83]
    buffer_load_dwordx4 v[228:231], v4, s[32:35], s11 offen offset:1024 sc1
    v_mfma_f32_16x16x32_bf16 v[80:83], a[44:47], v[236:239], v[80:83]
    ds_read_b128 v[44:47], v10 offset:2048
    v_fma_f32 v59, v59, s75, v19
    v_mfma_f32_16x16x32_bf16 v[84:87], a[48:51], v[236:239], v[84:87]
    ds_read_b128 v[48:51], v10 offset:3072
    v_mfma_f32_16x16x32_bf16 v[84:87], a[68:71], v[240:243], v[84:87]
    ds_read_b128 v[52:55], v10 offset:4096
    v_mfma_f32_16x16x32_bf16 v[84:87], a[88:91], v[244:247], v[84:87]
    ds_write_b128 v9, v[76:79] offset:5120
    v_mfma_f32_16x16x32_bf16 v[88:91], a[92:95], v[244:247], v[88:91]
    buffer_load_dwordx4 v[232:235], v4, s[32:35], s11 offen offset:1536 sc1
    v_mfma_f32_16x16x32_bf16 v[88:91], a[72:75], v[240:243], v[88:91]
    ds_write_b128 v9, v[80:83] offset:6144
    v_mfma_f32_16x16x32_bf16 v[88:91], a[52:55], v[236:239], v[88:91]
    v_rcp_f32 v28, v28
    v_mfma_f32_16x16x32_bf16 v[92:95], a[56:59], v[236:239], v[92:95]
    v_rcp_f32 v29, v29
    v_mfma_f32_16x16x32_bf16 v[92:95], a[76:79], v[240:243], v[92:95]
    ds_write_b128 v9, v[84:87] offset:7168
    v_mfma_f32_16x16x32_bf16 v[92:95], a[96:99], v[244:247], v[92:95]
    s_waitcnt lgkmcnt(6) vmcnt(7)
    buffer_load_dwordx4 v[236:239], v4, s[32:35], s11 offen offset:2048 sc1
    v_mfma_f32_16x16x32_bf16 v[36:39], a[0:3], v[248:251], v[36:39]
    v_mul_f32 v68, v68, v28
    v_mul_f32 v69, v69, v29
    v_mfma_f32_16x16x32_bf16 v[36:39], a[20:23], v[252:255], v[36:39]
    ds_write_b128 v9, v[88:91] offset:8192
    v_mfma_f32_16x16x32_bf16 v[40:43], a[24:27], v[252:255], v[40:43]
    v_fma_f32 v72, v72, s75, v32
    v_fma_f32 v73, v73, s75, v33
    v_mfma_f32_16x16x32_bf16 v[40:43], a[4:7], v[248:251], v[40:43]
    s_waitcnt lgkmcnt(5)
    v_exp_f32 v32, v72
    v_mfma_f32_16x16x32_bf16 v[44:47], a[8:11], v[248:251], v[44:47]
    ds_write_b128 v9, v[92:95] offset:9216
    v_mfma_f32_16x16x32_bf16 v[44:47], a[28:31], v[252:255], v[44:47]
    v_exp_f32 v33, v73
    v_mfma_f32_16x16x32_bf16 v[48:51], a[32:35], v[252:255], v[48:51]
    v_fma_f32 v32, v32, s75, s75
    v_fma_f32 v33, v33, s75, s75
    v_mfma_f32_16x16x32_bf16 v[48:51], a[12:15], v[248:251], v[48:51]
    s_waitcnt lgkmcnt(5)
    v_rcp_f32 v32, v32
    v_mfma_f32_16x16x32_bf16 v[52:55], a[16:19], v[248:251], v[52:55]
    v_rcp_f32 v33, v33
    v_mfma_f32_16x16x32_bf16 v[52:55], a[36:39], v[252:255], v[52:55]
    s_waitcnt vmcnt(5)
    v_mul_f32 v72, v72, v32
    v_mul_f32 v73, v73, v33
    v_mfma_f32_16x16x32_bf16 v[36:39], a[40:43], v[208:211], v[36:39]
    v_exp_f32 v18, v58
    v_mfma_f32_16x16x32_bf16 v[36:39], a[60:63], v[212:215], v[36:39]
    v_exp_f32 v19, v59
    v_mfma_f32_16x16x32_bf16 v[36:39], a[80:83], v[216:219], v[36:39]
    s_waitcnt lgkmcnt(0)
    s_barrier
    ds_read_b128 v[76:79], v11 offset:5120
    v_mfma_f32_16x16x32_bf16 v[40:43], a[84:87], v[216:219], v[40:43]
    ds_read_b128 v[80:83], v11 offset:6144
    v_fma_f32 v18, v18, s75, s75
    v_mfma_f32_16x16x32_bf16 v[40:43], a[64:67], v[212:215], v[40:43]
    ds_read_b128 v[84:87], v11 offset:7168
    v_fma_f32 v19, v19, s75, s75
    v_mfma_f32_16x16x32_bf16 v[40:43], a[44:47], v[208:211], v[40:43]
    ds_read_b128 v[88:91], v11 offset:8192
    v_mfma_f32_16x16x32_bf16 v[44:47], a[48:51], v[208:211], v[44:47]
    ds_read_b128 v[92:95], v11 offset:9216
    v_mfma_f32_16x16x32_bf16 v[44:47], a[68:71], v[212:215], v[44:47]
    ds_write_b128 v10, v[36:39] offset:10240
    v_mfma_f32_16x16x32_bf16 v[44:47], a[88:91], v[216:219], v[44:47]
    v_rcp_f32 v18, v18
    v_mfma_f32_16x16x32_bf16 v[48:51], a[92:95], v[216:219], v[48:51]
    v_rcp_f32 v19, v19
    v_mfma_f32_16x16x32_bf16 v[48:51], a[72:75], v[212:215], v[48:51]
    ds_write_b128 v10, v[40:43] offset:11264
    v_mfma_f32_16x16x32_bf16 v[48:51], a[52:55], v[208:211], v[48:51]
    v_mul_f32 v58, v58, v18
    v_mul_f32 v59, v59, v19
    v_mfma_f32_16x16x32_bf16 v[52:55], a[56:59], v[208:211], v[52:55]
    v_fma_f32 v62, v62, s75, v22
    v_fma_f32 v63, v63, s75, v23
    v_mfma_f32_16x16x32_bf16 v[52:55], a[76:79], v[212:215], v[52:55]
    ds_write_b128 v10, v[44:47] offset:12288
    v_mfma_f32_16x16x32_bf16 v[52:55], a[96:99], v[216:219], v[52:55]
    s_waitcnt lgkmcnt(6) vmcnt(3)
    v_exp_f32 v22, v62
    v_mfma_f32_16x16x32_bf16 v[76:79], a[0:3], v[220:223], v[76:79]
    v_exp_f32 v23, v63
    v_mfma_f32_16x16x32_bf16 v[76:79], a[20:23], v[224:227], v[76:79]
    ds_write_b128 v10, v[48:51] offset:13312
    v_mfma_f32_16x16x32_bf16 v[80:83], a[24:27], v[224:227], v[80:83]
    v_fma_f32 v22, v22, s75, s75
    v_fma_f32 v23, v23, s75, s75
    v_mfma_f32_16x16x32_bf16 v[80:83], a[4:7], v[220:223], v[80:83]
    s_waitcnt lgkmcnt(5)
    v_rcp_f32 v22, v22
    v_mfma_f32_16x16x32_bf16 v[84:87], a[8:11], v[220:223], v[84:87]
    ds_write_b128 v10, v[52:55] offset:14336
    v_mfma_f32_16x16x32_bf16 v[84:87], a[28:31], v[224:227], v[84:87]
    v_rcp_f32 v23, v23
    v_mfma_f32_16x16x32_bf16 v[88:91], a[32:35], v[224:227], v[88:91]
    v_mul_f32 v62, v62, v22
    v_mul_f32 v63, v63, v23
    v_mfma_f32_16x16x32_bf16 v[88:91], a[12:15], v[220:223], v[88:91]
    s_waitcnt lgkmcnt(5)
    v_fma_f32 v66, v66, s75, v26
    v_fma_f32 v67, v67, s75, v27
    v_mfma_f32_16x16x32_bf16 v[92:95], a[16:19], v[220:223], v[92:95]
    v_exp_f32 v26, v66
    v_mfma_f32_16x16x32_bf16 v[92:95], a[36:39], v[224:227], v[92:95]
    s_waitcnt vmcnt(0)
    v_exp_f32 v27, v67
    v_mfma_f32_16x16x32_bf16 v[92:95], a[56:59], v[228:231], v[92:95]
    v_fma_f32 v26, v26, s75, s75
    v_fma_f32 v27, v27, s75, s75
    v_mfma_f32_16x16x32_bf16 v[92:95], a[76:79], v[232:235], v[92:95]
    v_rcp_f32 v26, v26
    v_mfma_f32_16x16x32_bf16 v[92:95], a[96:99], v[236:239], v[92:95]
    s_waitcnt lgkmcnt(0)
    s_barrier
    ds_read_b128 v[36:39], v11 offset:10240
    v_mfma_f32_16x16x32_bf16 v[76:79], a[80:83], v[236:239], v[76:79]
    ds_read_b128 v[40:43], v11 offset:11264
    v_mfma_f32_16x16x32_bf16 v[76:79], a[60:63], v[232:235], v[76:79]
    ds_read_b128 v[44:47], v11 offset:12288
    v_mfma_f32_16x16x32_bf16 v[76:79], a[40:43], v[228:231], v[76:79]
    ds_read_b128 v[48:51], v11 offset:13312
    v_mfma_f32_16x16x32_bf16 v[80:83], a[44:47], v[228:231], v[80:83]
    ds_read_b128 v[52:55], v11 offset:14336
    v_mfma_f32_16x16x32_bf16 v[80:83], a[64:67], v[232:235], v[80:83]
    v_rcp_f32 v27, v27
    v_mfma_f32_16x16x32_bf16 v[80:83], a[84:87], v[236:239], v[80:83]
    v_mul_f32 v66, v66, v26
    v_mul_f32 v67, v67, v27
    v_mfma_f32_16x16x32_bf16 v[84:87], a[88:91], v[236:239], v[84:87]
    v_fma_f32 v70, v70, s75, v30
    v_fma_f32 v71, v71, s75, v31
    v_mfma_f32_16x16x32_bf16 v[84:87], a[68:71], v[232:235], v[84:87]
    v_exp_f32 v30, v70
    v_mfma_f32_16x16x32_bf16 v[84:87], a[48:51], v[228:231], v[84:87]
    v_exp_f32 v31, v71
    v_mfma_f32_16x16x32_bf16 v[88:91], a[52:55], v[228:231], v[88:91]
    v_fma_f32 v30, v30, s75, s75
    v_fma_f32 v31, v31, s75, s75
    v_mfma_f32_16x16x32_bf16 v[88:91], a[72:75], v[232:235], v[88:91]
    v_rcp_f32 v30, v30
    v_mfma_f32_16x16x32_bf16 v[88:91], a[92:95], v[236:239], v[88:91]
    v_rcp_f32 v31, v31
    v_mul_f32 v70, v70, v30
    v_mul_f32 v71, v71, v31
    v_fma_f32 v74, v74, s75, v34
    v_fma_f32 v75, v75, s75, v35
    v_exp_f32 v34, v74
    v_exp_f32 v35, v75
    v_fma_f32 v34, v34, s75, s75
    v_fma_f32 v35, v35, s75, s75
    v_rcp_f32 v34, v34
    v_rcp_f32 v35, v35
    v_mul_f32 v74, v74, v34
    v_mul_f32 v75, v75, v35
    s_waitcnt lgkmcnt(0)
    v_pk_add_f32 v[92:93], v[92:93], v[52:53]
    v_pk_fma_f32 v[92:93], v[92:93], v[72:73], v[196:197]
    v_cvt_pk_bf16_f32 v24, v92, v93
    v_pk_add_f32 v[94:95], v[94:95], v[54:55]
    v_pk_fma_f32 v[94:95], v[94:95], v[74:75], v[198:199]
    v_cvt_pk_bf16_f32 v25, v94, v95
    v_pk_add_f32 v[76:77], v[76:77], v[36:37]
    v_pk_fma_f32 v[76:77], v[76:77], v[56:57], v[180:181]
    v_permlane16_swap_b32 v24, v26
    v_permlane16_swap_b32 v25, v27
    buffer_store_dwordx4 v[24:27], v0, s[44:47], 0 offen offset:128
    v_cvt_pk_bf16_f32 v16, v76, v77
    v_pk_add_f32 v[78:79], v[78:79], v[38:39]
    v_pk_fma_f32 v[78:79], v[78:79], v[58:59], v[182:183]
    v_cvt_pk_bf16_f32 v17, v78, v79
    v_pk_add_f32 v[80:81], v[80:81], v[40:41]
    v_pk_fma_f32 v[80:81], v[80:81], v[60:61], v[184:185]
    v_cvt_pk_bf16_f32 v18, v80, v81
    v_pk_add_f32 v[82:83], v[82:83], v[42:43]
    v_pk_fma_f32 v[82:83], v[82:83], v[62:63], v[186:187]
    v_cvt_pk_bf16_f32 v19, v82, v83
    v_pk_add_f32 v[84:85], v[84:85], v[44:45]
    v_pk_fma_f32 v[84:85], v[84:85], v[64:65], v[188:189]
    v_cvt_pk_bf16_f32 v20, v84, v85
    v_pk_add_f32 v[86:87], v[86:87], v[46:47]
    v_pk_fma_f32 v[86:87], v[86:87], v[66:67], v[190:191]
    v_cvt_pk_bf16_f32 v21, v86, v87
    v_pk_add_f32 v[88:89], v[88:89], v[48:49]
    v_pk_fma_f32 v[88:89], v[88:89], v[68:69], v[192:193]
    v_cvt_pk_bf16_f32 v22, v88, v89
    v_pk_add_f32 v[90:91], v[90:91], v[50:51]
    v_pk_fma_f32 v[90:91], v[90:91], v[70:71], v[194:195]
    v_cvt_pk_bf16_f32 v23, v90, v91
    v_cndmask_b32_dpp v32, v16, v20, vcc quad_perm:[1,0,3,2] row_mask:0xf bank_mask:0xf
    v_cndmask_b32_dpp v33, v17, v21, vcc quad_perm:[1,0,3,2] row_mask:0xf bank_mask:0xf
    v_cndmask_b32_dpp v34, v18, v22, vcc quad_perm:[1,0,3,2] row_mask:0xf bank_mask:0xf
    v_cndmask_b32_dpp v35, v19, v23, vcc quad_perm:[1,0,3,2] row_mask:0xf bank_mask:0xf
    s_not_b64 vcc, vcc
    v_cndmask_b32_dpp v28, v20, v16, vcc quad_perm:[1,0,3,2] row_mask:0xf bank_mask:0xf
    v_cndmask_b32_dpp v29, v21, v17, vcc quad_perm:[1,0,3,2] row_mask:0xf bank_mask:0xf
    v_cndmask_b32_dpp v30, v22, v18, vcc quad_perm:[1,0,3,2] row_mask:0xf bank_mask:0xf
    v_cndmask_b32_dpp v31, v23, v19, vcc quad_perm:[1,0,3,2] row_mask:0xf bank_mask:0xf
    buffer_store_dwordx4 v[32:35], v13, s[44:47], 0 offen offset:2560
    buffer_store_dwordx4 v[28:31], v13, s[44:47], 0 offen
    s_endpgm
Q_SPIN_D:
    buffer_load_dword v20, off, s[52:55], 0 offset:0 sc1
    s_waitcnt vmcnt(0)
    v_cmp_gt_u32 vcc, 4, v20
    s_cbranch_vccz Q_BACK_D
    s_sub_u32 s68, s68, 1
    s_cbranch_scc0 Q_SPIN_D
    s_mov_b32 s68, 0
    s_branch Q_BACK_D
Q_SPIN_S:
    buffer_load_dword v22, v21, s[40:43], 0 offen sc1
    s_waitcnt vmcnt(0)
    v_cmp_eq_u32 vcc, 0, v22
    s_cbranch_vccz Q_BACK_S
    s_sub_u32 s68, s68, 1
    s_cbranch_scc0 Q_SPIN_S
    s_mov_b32 s68, 0
    s_branch Q_BACK_S
Q_SPIN_T:
    buffer_load_dword v20, v26, s[40:43], 0 offen sc1
    s_waitcnt vmcnt(0)
    v_cmp_eq_u32 vcc, 0, v20
    s_cbranch_vccz Q_BACK_T
    s_sub_u32 s68, s68, 1
    s_cbranch_scc0 Q_SPIN_T
    s_mov_b32 s68, 0
    s_branch Q_BACK_T
Q_SLOW:
    s_waitcnt vmcnt(6)
    v_cmp_eq_u32 vcc, 0, v74
    s_cbranch_vccz Q_GO
Q_POLL:
    buffer_load_dword v12, v8, s[40:43], 0 offen sc1
    s_waitcnt vmcnt(0)
    v_cmp_eq_u32 vcc, 0, v12
    s_cbranch_vccz Q_GO
    s_sub_u32 s68, s68, 1
    s_cbranch_scc0 Q_POLL
    s_mov_b32 s68, 0
Q_GO:
    buffer_load_dwordx4 v[208:211], v4, s[36:39], s4 offen offset:0 sc1
    buffer_load_dwordx4 v[212:215], v4, s[36:39], s4 offen offset:512 sc1
    buffer_load_dwordx4 v[216:219], v4, s[36:39], s4 offen offset:1024 sc1
    buffer_load_dwordx4 v[220:223], v5, s[36:39], s4 offen offset:0 sc1
    buffer_load_dwordx4 v[224:227], v5, s[36:39], s4 offen offset:512 sc1
    buffer_load_dwordx4 v[228:231], v5, s[36:39], s4 offen offset:1024 sc1
    buffer_load_dwordx4 v[232:235], v6, s[36:39], s4 offen offset:0 sc1
    buffer_load_dwordx4 v[236:239], v6, s[36:39], s4 offen offset:512 sc1
    buffer_load_dwordx4 v[240:243], v6, s[36:39], s4 offen offset:1024 sc1
    buffer_load_dwordx4 v[244:247], v7, s[36:39], s4 offen offset:0 sc1
    buffer_load_dwordx4 v[248:251], v7, s[36:39], s4 offen offset:512 sc1
    buffer_load_dwordx4 v[252:255], v7, s[36:39], s4 offen offset:1024 sc1
    buffer_load_dword v74, off, s[32:35], 0
    buffer_load_dword v74, off, s[32:35], 0
    buffer_load_dword v74, off, s[32:35], 0
    buffer_load_dword v74, off, s[32:35], 0
    buffer_load_dword v74, off, s[32:35], 0
    buffer_load_dword v74, off, s[32:35], 0
    buffer_load_dword v74, off, s[32:35], 0
    s_mov_b32 s34, s38
    s_branch Q_FAST
Q_SPIN_O:
    buffer_load_dword v12, v14, s[40:43], 0 offen sc1
    s_waitcnt vmcnt(0)
    v_cmp_eq_u32 vcc, 0, v12
    s_cbranch_vccz Q_BACK_O
    s_sub_u32 s68, s68, 1
    s_cbranch_scc0 Q_SPIN_O
    s_mov_b32 s68, 0
    s_branch Q_BACK_O
K_LAST:
.section .rodata,"a"
.p2align 6
.amdhsa_kernel recurrent_scan__sliding_local_dilated__swiglu_ffn__prompt_kernel
  .amdhsa_next_free_vgpr 512
  .amdhsa_next_free_sgpr 102
  .amdhsa_accum_offset 256
  .amdhsa_group_segment_fixed_size 0
  .amdhsa_kernarg_size 80
  .amdhsa_user_sgpr_count 2
  .amdhsa_user_sgpr_kernarg_segment_ptr 1
  .amdhsa_system_sgpr_workgroup_id_x 1
  .amdhsa_float_denorm_mode_32 3
.end_amdhsa_kernel
```
